```python
import torch

def _softmax(x, axis=-1):
    return torch.softmax(x, dim=axis)
def _gelu(x):
    return torch.nn.functional.gelu(x, approximate="tanh")
def _silu(x):
    return torch.nn.functional.silu(x)
def _sigmoid(x):
    return torch.sigmoid(x)
def _layernorm(x, axis=-1, eps=1e-5):
    m = x.mean(dim=axis, keepdim=True)
    v = x.var(dim=axis, keepdim=True, unbiased=False)
    return (x - m) / torch.sqrt(v + eps)
def _scatter_add(tgt, idx, src, axis=0):
    return tgt.clone().index_add_(axis, idx, src)
def _segment_sum(src, seg, n):
    out = torch.zeros((n,) + src.shape[1:], dtype=src.dtype)
    return out.index_add_(0, seg, src)
def _pad(x, pw):
    flat = tuple(v for pair in reversed(pw) for v in pair)
    return torch.nn.functional.pad(x, flat)

kernel_name = 'gated_mix__linear_attn_block__sliding_local_dilated__prompt'

def setup_inputs():

    _w = (lambda a: (lambda t: t.to(torch.bfloat16) if t.is_floating_point() else t)(torch.as_tensor(a)))
    def _A_setup():
        B, S, D = 1, 2048, 640
        return {
            "x": _w((lambda *s: torch.randn(*s, dtype=torch.bfloat16) * 0.05)(B, S, D)),
            "wqkv": _w((lambda *s: torch.randn(*s, dtype=torch.bfloat16) * 1.6)(D, 3 * D)),
            "wo": _w((lambda *s: torch.randn(*s, dtype=torch.bfloat16) * 0.8)(D, D)),
        }
    _A_in = _A_setup()

    def _B_setup():
        B, S, D = 1, 2048, 640
        return {
            "x": _w((lambda *s: torch.randn(*s, dtype=torch.bfloat16) * 0.05)(B, S, D)),
            "wqkv": _w((lambda *s: torch.randn(*s, dtype=torch.bfloat16) * 0.8)(D, 3 * D)),
            "wo": _w((lambda *s: torch.randn(*s, dtype=torch.bfloat16) * 0.05)(D, D)),
        }
    _B_in = _B_setup()

    return {
        "A_x": _A_in["x"],
        "A_wqkv": _A_in["wqkv"],
        "A_wo": _A_in["wo"],
        "B_x": _B_in["x"],
        "B_wqkv": _B_in["wqkv"],
        "B_wo": _B_in["wo"],
        "gate_w": _w((lambda *s: torch.randn(*s, dtype=torch.bfloat16) * 0.05)(640) * 16.0),
    }

def reference(A_x, A_wqkv, A_wo, B_x, B_wqkv, B_wo, gate_w):
    def _A_ref(x, wqkv, wo):
        B, S, D = x.shape
        H = 32; Dh = D // H
        qkv = (lambda x, *d: x.permute(*d))((x @ wqkv).reshape(B, S, 3, H, Dh), 2, 0, 3, 1, 4)
        q, k, v = qkv[0], qkv[1], qkv[2]
        phi = lambda t: torch.where(t > 0, t + 1, torch.exp(t)) + 1e-6
        pq, pk = phi(q), phi(k)
        kv = torch.einsum("bhsd,bhse->bhde", pk, v)
        z = torch.einsum("bhsd->bhd", pk)
        num = torch.einsum("bhqd,bhde->bhqe", pq, kv)
        den = torch.einsum("bhqd,bhd->bhq", pq, z)[..., None] + 1e-6
        o = num / den
        return (lambda x, *d: x.permute(*d))(o, 0, 2, 1, 3).reshape(B, S, D) @ wo

    def _B_ref(x, wqkv, wo):
        B, S, D = x.shape
        H = 32; Dh = D // H
        W, dil = 8, 2
        qkv = (lambda x, *d: x.permute(*d))((x @ wqkv).reshape(B, S, 3, H, Dh), 2, 0, 3, 1, 4)
        q, k, v = qkv[0], qkv[1], qkv[2]
        scale = Dh ** -0.5
        pos = torch.arange(S)
        off = torch.arange(W) * dil
        idx = pos[:, None] - off[None, :]
        mask = idx >= 0
        idx_c = torch.where(mask, idx, 0).reshape(-1)
        kg = k[:, :, idx_c, :].reshape(B, H, S, W, Dh)
        vg = v[:, :, idx_c, :].reshape(B, H, S, W, Dh)
        logits = torch.einsum("bhsd,bhswd->bhsw", q, kg) * scale
        logits = torch.where(mask[None, None, :, :], logits, -1e9)
        attn = _softmax(logits, axis=-1)
        o = torch.einsum("bhsw,bhswd->bhsd", attn, vg)
        return (lambda x, *d: x.permute(*d))(o, 0, 2, 1, 3).reshape(B, S, D) @ wo

    x = A_x
    g = _sigmoid((x * gate_w).sum(-1, keepdims=True))
    a = _A_ref(x, A_wqkv, A_wo)
    b = _B_ref(x, B_wqkv, B_wo)
    return g * a + (1 - g) * b
```

```asm
; @launch grid=(256,1,1) block=(256,1,1) lds=163840
.amdgcn_target "amdgcn-amd-amdhsa--gfx950"
.text
.globl gated_mix__linear_attn_block__sliding_local_dilated__prompt_kernel
.p2align 8
.type gated_mix__linear_attn_block__sliding_local_dilated__prompt_kernel,@function
gated_mix__linear_attn_block__sliding_local_dilated__prompt_kernel:
    s_cmp_ge_u32 s2, 0x100
    s_cbranch_scc1 K1_END
    s_load_dwordx4 s[56:59], s[0:1], 0
    s_load_dwordx2 s[62:63], s[0:1], 32
    s_load_dwordx2 s[60:61], s[0:1], 56
    s_load_dwordx4 s[64:67], s[0:1], 64
    s_load_dwordx2 s[68:69], s[0:1], 48
    s_load_dwordx2 s[70:71], s[0:1], 16
    s_load_dwordx2 s[54:55], s[0:1], 40
    s_memrealtime s[100:101]
    s_getpc_b64 s[98:99]
LPC:
    s_bitcmp1_b32 s2, 2
    s_cselect_b32 s36, K1_B-LPC, 0
    s_bfe_u32 s37, s2, 0x20003
    s_lshl_b32 s37, s37, 13
    s_add_u32 s36, s36, s37
    v_lshlrev_b32 v2, 5, v0
    v_add_u32 v2, s36, v2
    v_min_u32 v2, K1_END-LPC, v2
    v_mov_b32 v3, s99
    v_add_co_u32 v2, vcc, s98, v2
    s_nop 1
    v_addc_co_u32 v3, vcc, 0, v3, vcc
    global_load_dword v188, v[2:3], off
    s_mov_b32 s94, s2
    v_mov_b32 v191, v0
    v_and_b32 v190, 63, v0
    v_lshrrev_b32 v180, 6, v0
    s_nop 0
    v_readfirstlane_b32 s33, v180
    s_and_b32 s28, s94, 7
    s_lshr_b32 s29, s94, 3
    s_lshr_b32 s30, s28, 2
    s_lshr_b32 s36, s28, 1
    s_and_b32 s36, s36, 1
    s_lshl_b32 s36, s36, 3
    s_and_b32 s37, s29, 7
    s_add_u32 s31, s36, s37
    s_and_b32 s36, s28, 1
    s_lshl_b32 s36, s36, 2
    s_lshr_b32 s37, s29, 3
    s_add_u32 s32, s36, s37
    s_lshr_b32 s34, s33, 1
    s_and_b32 s35, s33, 1
    s_and_b32 s36, s29, 7
    s_lshr_b32 s37, s36, 2
    s_add_u32 s36, s36, s37
    s_lshr_b32 s37, s29, 3
    s_mul_i32 s37, s37, 5
    s_add_u32 s37, s37, 1
    s_lshr_b32 s37, s37, 1
    s_add_u32 s93, s36, s37
    s_sub_u32 s36, s93, 10
    s_cmp_lt_u32 s93, 10
    s_cselect_b32 s93, s93, s36
    s_mov_b32 s92, s93
    s_lshl_b32 s36, s31, 7
    s_lshl_b32 s37, s33, 5
    s_add_u32 s82, s36, s37
    s_movk_i32 s83, 0x500
    s_mul_i32 s36, s33, 0xf000
    s_mul_i32 s37, s32, 0xa0
    s_add_u32 s36, s36, s37
    s_add_u32 s84, s36, 0x500
    s_movk_i32 s85, 0xcd
    s_movk_i32 s86, 0xf00
    v_lshrrev_b32 v20, 3, v190
    v_add_u32 v0, 0, v190
    v_add_u32 v4, 64, v190
    v_add_u32 v8, 0x80, v190
    v_add_u32 v12, 0xc0, v190
    v_add_u32 v16, 0x100, v190
    v_and_b32 v21, 7, v190
    v_mul_lo_u32 v1, v0, s85
    v_mul_lo_u32 v5, v4, s85
    v_mul_lo_u32 v9, v8, s85
    v_mul_lo_u32 v13, v12, s85
    v_mul_lo_u32 v17, v16, s85
    v_xor_b32 v21, v21, v20
    v_lshrrev_b32 v1, 12, v1
    v_lshrrev_b32 v5, 12, v5
    v_lshrrev_b32 v9, 12, v9
    v_lshrrev_b32 v13, 12, v13
    v_lshrrev_b32 v17, 12, v17
    v_lshlrev_b32 v21, 4, v21
    v_mul_u32_u24 v2, 20, v1
    v_mul_u32_u24 v6, 20, v5
    v_mul_u32_u24 v10, 20, v9
    v_mul_u32_u24 v14, 20, v13
    v_mul_u32_u24 v18, 20, v17
    v_lshlrev_b32 v20, 1, v20
    v_sub_u32 v2, v0, v2
    v_sub_u32 v6, v4, v6
    v_sub_u32 v10, v8, v10
    v_sub_u32 v14, v12, v14
    v_sub_u32 v18, v16, v18
    v_add_u32 v20, s82, v20
    v_lshrrev_b32 v3, 2, v1
    v_lshrrev_b32 v7, 2, v5
    v_lshrrev_b32 v11, 2, v9
    v_lshrrev_b32 v15, 2, v13
    v_lshrrev_b32 v19, 2, v17
    v_mul_lo_u32 v20, v20, s83
    v_and_b32 v3, 2, v3
    v_and_b32 v7, 2, v7
    v_and_b32 v11, 2, v11
    v_and_b32 v15, 2, v15
    v_and_b32 v19, 2, v19
    v_add_u32 v176, v20, v21
    v_sub_u32 v2, v2, v3
    v_sub_u32 v6, v6, v7
    v_sub_u32 v10, v10, v11
    v_sub_u32 v14, v14, v15
    v_sub_u32 v18, v18, v19
    v_add_u32 v177, 0x4c00, v176
    v_add_u32 v3, 20, v2
    v_add_u32 v7, 20, v6
    v_add_u32 v11, 20, v10
    v_add_u32 v15, 20, v14
    v_add_u32 v19, 20, v18
    v_add_u32 v178, 0x500, v176
    v_cmp_gt_i32 s[72:73], 0, v2
    v_cmp_gt_i32 s[74:75], 0, v6
    v_cmp_gt_i32 s[76:77], 0, v10
    v_cmp_gt_i32 s[78:79], 0, v14
    v_cmp_gt_i32 s[80:81], 0, v18
    v_add_u32 v179, 0x5100, v176
    v_mul_u32_u24 v1, 0xf00, v1
    v_mul_u32_u24 v5, 0xf00, v5
    v_mul_u32_u24 v9, 0xf00, v9
    v_mul_u32_u24 v13, 0xf00, v13
    v_mul_u32_u24 v17, 0xf00, v17
    v_cndmask_b32 v2, v2, v3, s[72:73]
    v_cndmask_b32 v6, v6, v7, s[74:75]
    v_cndmask_b32 v10, v10, v11, s[76:77]
    v_cndmask_b32 v14, v14, v15, s[78:79]
    v_cndmask_b32 v18, v18, v19, s[80:81]
    v_cmp_lt_u32 s[44:45], 9, v2
    v_cmp_lt_u32 s[46:47], 9, v6
    v_cmp_lt_u32 s[48:49], 9, v10
    v_cmp_lt_u32 s[50:51], 9, v14
    v_cmp_lt_u32 s[52:53], 9, v18
    v_subrev_u32 v3, 11, v2
    v_subrev_u32 v7, 11, v6
    v_subrev_u32 v11, 11, v10
    v_subrev_u32 v15, 11, v14
    v_subrev_u32 v19, 11, v18
    v_cmp_eq_u32 s[72:73], 10, v2
    v_cmp_eq_u32 s[74:75], 10, v6
    v_cmp_eq_u32 s[76:77], 10, v10
    v_cmp_eq_u32 s[78:79], 10, v14
    v_cmp_eq_u32 s[80:81], 10, v18
    v_add_u32 v1, s84, v1
    v_add_u32 v5, s84, v5
    v_add_u32 v9, s84, v9
    v_add_u32 v13, s84, v13
    v_add_u32 v17, s84, v17
    v_add_u32 v0, 0x500, v1
    v_add_u32 v4, 0x500, v5
    v_add_u32 v8, 0x500, v9
    v_add_u32 v12, 0x500, v13
    v_add_u32 v16, 0x500, v17
    v_cndmask_b32 v3, v3, 9, s[72:73]
    v_cndmask_b32 v7, v7, 9, s[74:75]
    v_cndmask_b32 v11, v11, 9, s[76:77]
    v_cndmask_b32 v15, v15, 9, s[78:79]
    v_cndmask_b32 v19, v19, 9, s[80:81]
    v_cndmask_b32 v1, v1, v0, s[44:45]
    v_cndmask_b32 v5, v5, v4, s[46:47]
    v_cndmask_b32 v9, v9, v8, s[48:49]
    v_cndmask_b32 v13, v13, v12, s[50:51]
    v_cndmask_b32 v17, v17, v16, s[52:53]
    v_cndmask_b32 v2, v2, v3, s[44:45]
    v_cndmask_b32 v6, v6, v7, s[46:47]
    v_cndmask_b32 v10, v10, v11, s[48:49]
    v_cndmask_b32 v14, v14, v15, s[50:51]
    v_cndmask_b32 v18, v18, v19, s[52:53]
    v_lshlrev_b32 v2, 4, v2
    v_lshlrev_b32 v6, 4, v6
    v_lshlrev_b32 v10, 4, v10
    v_lshlrev_b32 v14, 4, v14
    v_lshlrev_b32 v18, 4, v18
    v_add_u32 v171, v1, v2
    v_add_u32 v172, v5, v6
    v_add_u32 v173, v9, v10
    v_add_u32 v174, v13, v14
    v_add_u32 v175, v17, v18
    v_subrev_u32 v172, 0x400, v172
    v_subrev_u32 v173, 0x800, v173
    v_subrev_u32 v174, 0xc00, v174
    s_lshl_b32 s40, s33, 12
    s_add_u32 s40, s40, 0xf000
    s_mul_i32 s41, s33, 0x1400
    s_mov_b32 s10, 0x280000
    s_mov_b32 s11, 0x20000
    s_mov_b32 s14, 0x258000
    s_mov_b32 s15, 0x20000
    s_cmp_eq_u32 s30, 0
    s_waitcnt lgkmcnt(0)
    s_mov_b32 s8, s56
    s_mov_b32 s9, s57
    s_cselect_b32 s12, s58, s62
    s_cselect_b32 s13, s59, s63
    s_cmp_eq_u32 s30, 0
    s_cbranch_scc0 K1_B
    s_add_u32 m0, s40, 0
    s_lshl_b32 s38, s92, 7
    buffer_load_dwordx4 v176, s[8:11], s38 offen lds
    buffer_load_dwordx4 v177, s[8:11], s38 offen offset:1024 lds
    s_add_u32 m0, s40, 0x800
    s_nop 0
    buffer_load_dwordx4 v178, s[8:11], s38 offen lds
    buffer_load_dwordx4 v179, s[8:11], s38 offen offset:1024 lds
    s_add_u32 m0, s41, 0
    s_mul_i32 s39, s92, 0x3c000
    s_add_u32 s92, s92, 1
    s_sub_u32 s36, s92, 10
    s_cmp_lt_u32 s92, 10
    s_cselect_b32 s92, s92, s36
    buffer_load_dwordx4 v171, s[12:15], s39 offen offset:0 lds
    buffer_load_dwordx4 v172, s[12:15], s39 offen offset:1024 lds
    buffer_load_dwordx4 v173, s[12:15], s39 offen offset:2048 lds
    buffer_load_dwordx4 v174, s[12:15], s39 offen offset:3072 lds
    s_add_u32 m0, s41, 0x1000
    s_nop 0
    buffer_load_dwordx4 v175, s[12:15], s39 offen lds
    s_lshr_b32 s36, s29, 3
    s_and_b32 s37, s36, 1
    s_mul_i32 s37, s37, 0x12c000
    s_cmp_lt_u32 s36, 2
    s_cselect_b32 s36, 0x77e00, 0
    s_add_u32 s37, s37, s36
    s_add_u32 s37, s37, 0x78700
    s_and_b32 s36, s29, 7
    s_mul_i32 s36, s36, 0x7800
    s_add_u32 s37, s37, s36
    s_and_b32 s36, s28, 1
    s_mul_i32 s36, s36, 0x280
    s_add_u32 s37, s37, s36
    s_lshl_b32 s36, s33, 2
    v_add_u32 v252, s36, v190
    v_and_b32 v253, 7, v252
    v_mul_u32_u24 v253, 0xf00, v253
    v_lshrrev_b32 v252, 3, v252
    v_mul_u32_u24 v252, 0x500, v252
    v_add_u32 v252, v252, v253
    v_mov_b32 v253, 0x7ffffff0
    v_cmp_gt_u32 vcc, 4, v190
    s_nop 1
    v_cndmask_b32 v252, v253, v252, vcc
    buffer_load_dword v254, v252, s[12:15], s37 offen
    s_mov_b32 s16, s66
    s_mov_b32 s17, s67
    s_mov_b32 s18, 0x1000000
    s_mov_b32 s19, 0x20000
    s_mov_b32 s20, s64
    s_mov_b32 s21, s65
    s_mov_b32 s22, 0x100
    s_mov_b32 s23, 0x20000
    s_mov_b32 s24, s68
    s_mov_b32 s25, s69
    s_mov_b32 s26, 0x500
    s_mov_b32 s27, 0x20000
    s_bitcmp0_b32 s94, 3
    s_cselect_b32 s4, s70, s54
    s_cselect_b32 s5, s71, s55
    s_mov_b32 s6, 0xc8000
    s_mov_b32 s7, 0x20000
    s_mov_b32 s70, s60
    s_mov_b32 s71, s61
    s_mov_b32 s88, 0x3fb8aa3b
    s_mov_b32 s89, 0x358637bd
    s_mov_b32 s90, 0x3f803f80
    s_mov_b32 s91, 0x7ffffff0
    v_lshlrev_b32 v105, 4, v190
    s_mov_b32 m0, 0x1b000
    s_nop 0
    buffer_load_dwordx4 v105, s[24:27], 0 offen lds
    v_add_u32 v107, 0x400, v105
    v_subrev_u32 v108, 0x100, v105
    v_cmp_gt_u32 vcc, 16, v190
    s_nop 1
    v_cndmask_b32 v107, v108, v107, vcc
    s_mov_b32 m0, 0x1b400
    s_nop 0
    buffer_load_dwordx4 v107, s[24:27], 0 offen lds
    v_add_u32 v107, 0x300, v105
    v_subrev_u32 v108, 0x200, v105
    v_cmp_gt_u32 vcc, 32, v190
    s_nop 1
    v_cndmask_b32 v107, v108, v107, vcc
    s_mov_b32 m0, 0x1b800
    s_nop 0
    buffer_load_dwordx4 v107, s[24:27], 0 offen lds
    v_lshrrev_b32 v104, 4, v190
    v_lshlrev_b32 v104, 4, v104
    v_add_u32 v104, 0x1b000, v104
    s_lshl_b32 s36, s93, 7
    v_add_u32 v104, s36, v104
    s_add_u32 m0, s40, 0x4000
    s_lshl_b32 s38, s92, 7
    buffer_load_dwordx4 v176, s[8:11], s38 offen lds
    buffer_load_dwordx4 v177, s[8:11], s38 offen offset:1024 lds
    s_add_u32 m0, s40, 0x4800
    s_nop 0
    buffer_load_dwordx4 v178, s[8:11], s38 offen lds
    buffer_load_dwordx4 v179, s[8:11], s38 offen offset:1024 lds
    s_add_u32 m0, s40, 0x8000
    s_add_u32 s36, s92, 1
    s_sub_u32 s37, s36, 10
    s_cmp_lt_u32 s36, 10
    s_cselect_b32 s36, s36, s37
    s_lshl_b32 s38, s36, 7
    buffer_load_dwordx4 v176, s[8:11], s38 offen lds
    buffer_load_dwordx4 v177, s[8:11], s38 offen offset:1024 lds
    s_add_u32 m0, s40, 0x8800
    s_nop 0
    buffer_load_dwordx4 v178, s[8:11], s38 offen lds
    buffer_load_dwordx4 v179, s[8:11], s38 offen offset:1024 lds
    s_or_b32 s36, s100, 1
    v_mov_b32 v33, s36
    s_cmp_eq_u32 s94, 0
    s_cselect_b32 s36, 0, s91
    v_mov_b32 v32, s91
    v_cmp_eq_u32 vcc, 0, v191
    s_nop 1
    v_cndmask_b32 v32, v32, 0, vcc
    buffer_store_dword v33, v32, s[20:23], s36 offen sc1
    v_lshrrev_b32 v41, 4, v190
    v_lshrrev_b32 v40, 2, v190
    v_and_b32 v40, 3, v40
    v_lshlrev_b32 v42, 3, v41
    v_add_u32 v40, v40, v42
    v_mul_u32_u24 v47, 0x140, v40
    v_and_b32 v46, 1, v41
    v_lshlrev_b32 v46, 1, v46
    s_mul_i32 s43, s35, 0x50
    s_lshl_b32 s42, s35, 1
    v_and_b32 v48, 3, v190
    v_lshlrev_b32 v0, 3, v48
    v_lshlrev_b32 v4, 3, v48
    v_lshlrev_b32 v8, 3, v48
    v_lshlrev_b32 v12, 3, v48
    v_and_b32 v16, 1, v48
    v_xor_b32 v20, s42, v48
    v_xor_b32 v24, s42, v48
    v_and_b32 v40, 15, v190
    v_add_u32 v0, s43, v0
    v_add_u32 v4, s43, v4
    v_add_u32 v8, s43, v8
    v_add_u32 v12, s43, v12
    v_mul_u32_u24 v16, 40, v16
    v_mul_u32_u24 v20, 40, v20
    v_mul_u32_u24 v24, 40, v24
    s_lshl_b32 s36, s34, 6
    v_lshrrev_b32 v1, 4, v0
    v_add_u32 v4, 40, v4
    v_lshrrev_b32 v9, 4, v8
    v_add_u32 v12, 40, v12
    v_add_u32 v16, s43, v16
    v_add_u32 v20, 32, v20
    v_add_u32 v24, 32, v24
    v_add_u32 v40, s36, v40
    v_and_b32 v0, 8, v0
    v_lshrrev_b32 v5, 4, v4
    v_add_u32 v10, 11, v9
    v_lshrrev_b32 v13, 4, v12
    v_add_u32 v16, 32, v16
    v_lshrrev_b32 v21, 4, v20
    v_lshrrev_b32 v25, 4, v24
    v_lshlrev_b32 v40, 7, v40
    v_add_u32 v1, v1, v46
    v_and_b32 v4, 8, v4
    v_cmp_eq_u32 s[76:77], 9, v9
    v_add_u32 v14, 11, v13
    v_lshrrev_b32 v17, 4, v16
    v_and_b32 v20, 8, v20
    v_add_u32 v26, 11, v25
    v_lshrrev_b32 v41, 4, v190
    v_subrev_u32 v2, 20, v1
    v_add_u32 v5, v5, v46
    v_and_b32 v11, 2, v48
    v_cmp_eq_u32 s[78:79], 9, v13
    v_add_u32 v18, 11, v17
    v_add_u32 v21, v21, v46
    v_cmp_eq_u32 s[84:85], 9, v25
    v_and_b32 v42, 7, v190
    v_cmp_lt_u32 s[72:73], 19, v1
    v_subrev_u32 v6, 20, v5
    v_and_b32 v8, 8, v8
    v_and_b32 v15, 2, v48
    v_cmp_eq_u32 s[80:81], 9, v17
    v_subrev_u32 v22, 20, v21
    v_and_b32 v27, 2, v48
    v_xor_b32 v41, v41, v42
    v_add_u32 v0, v0, v47
    v_cmp_lt_u32 s[74:75], 19, v5
    v_cndmask_b32 v10, v10, 10, s[76:77]
    v_and_b32 v12, 8, v12
    v_and_b32 v19, 2, v48
    v_cmp_lt_u32 s[82:83], 19, v21
    v_and_b32 v24, 8, v24
    v_lshlrev_b32 v41, 4, v41
    v_cndmask_b32 v1, v1, v2, s[72:73]
    v_add_u32 v4, v4, v47
    v_mov_b32 v9, v10
    v_cndmask_b32 v14, v14, 10, s[78:79]
    v_and_b32 v16, 8, v16
    v_add_u32 v20, v20, v47
    v_cndmask_b32 v26, v26, 10, s[84:85]
    v_add_u32 v40, v40, v41
    v_lshlrev_b32 v1, 4, v1
    v_cndmask_b32 v5, v5, v6, s[74:75]
    v_add_u32 v9, v9, v46
    v_mov_b32 v13, v14
    v_cndmask_b32 v18, v18, 10, s[80:81]
    v_cndmask_b32 v21, v21, v22, s[82:83]
    v_mov_b32 v25, v26
    s_lshl_b32 s36, s35, 12
    v_add_u32 v160, v1, v0
    v_lshlrev_b32 v5, 4, v5
    v_subrev_u32 v10, 20, v9
    v_add_u32 v13, v13, v46
    v_cmp_ne_u32 s[80:81], 0, v19
    v_lshlrev_b32 v21, 4, v21
    v_add_u32 v25, v25, v46
    s_add_u32 s37, s36, 0xf000
    v_add_u32 v161, v5, v4
    v_cmp_lt_u32 s[76:77], 19, v9
    v_subrev_u32 v14, 20, v13
    v_cndmask_b32 v17, v17, v18, s[80:81]
    v_add_u32 v165, v21, v20
    v_subrev_u32 v26, 20, v25
    v_add_u32 v167, s37, v40
    v_add_u32 v8, v8, v47
    v_cmp_lt_u32 s[78:79], 19, v13
    v_add_u32 v17, v17, v46
    v_cmp_lt_u32 s[84:85], 19, v25
    s_sub_u32 s37, 0x10000, s36
    v_cndmask_b32 v9, v9, v10, s[76:77]
    v_add_u32 v12, v12, v47
    v_subrev_u32 v18, 20, v17
    v_add_u32 v24, v24, v47
    v_add_u32 v168, s37, v40
    v_lshlrev_b32 v9, 4, v9
    v_cndmask_b32 v13, v13, v14, s[78:79]
    v_cmp_lt_u32 s[80:81], 19, v17
    v_cndmask_b32 v25, v25, v26, s[84:85]
    v_xor_b32 v169, 64, v167
    v_add_u32 v162, v9, v8
    v_lshlrev_b32 v13, 4, v13
    v_add_u32 v16, v16, v47
    v_lshlrev_b32 v25, 4, v25
    v_xor_b32 v170, 64, v168
    v_add_u32 v163, v13, v12
    v_cndmask_b32 v17, v17, v18, s[80:81]
    v_add_u32 v166, v25, v24
    v_lshlrev_b32 v17, 4, v17
    v_add_u32 v164, v17, v16
    v_and_b32 v40, 15, v190
    v_cmp_gt_u32 s[72:73], 8, v40
    v_and_b32 v40, 4, v190
    v_cmp_ne_u32 s[74:75], 0, v40
    v_and_b32 v40, 16, v190
    v_cmp_ne_u32 s[76:77], 0, v40
    v_lshrrev_b32 v40, 4, v190
    v_cmp_eq_u32 s[78:79], 0, v40
    v_cmp_eq_u32 s[80:81], 1, v40
    s_add_u32 m0, s41, 0x5000
    s_mul_i32 s39, s92, 0x3c000
    s_add_u32 s92, s92, 1
    s_sub_u32 s36, s92, 10
    s_cmp_lt_u32 s92, 10
    s_cselect_b32 s92, s92, s36
    buffer_load_dwordx4 v171, s[12:15], s39 offen offset:0 lds
    buffer_load_dwordx4 v172, s[12:15], s39 offen offset:1024 lds
    buffer_load_dwordx4 v173, s[12:15], s39 offen offset:2048 lds
    buffer_load_dwordx4 v174, s[12:15], s39 offen offset:3072 lds
    s_add_u32 m0, s41, 0x6000
    s_nop 0
    buffer_load_dwordx4 v175, s[12:15], s39 offen lds
    s_add_u32 m0, s41, 0xa000
    s_mul_i32 s39, s92, 0x3c000
    s_add_u32 s92, s92, 1
    s_sub_u32 s36, s92, 10
    s_cmp_lt_u32 s92, 10
    s_cselect_b32 s92, s92, s36
    buffer_load_dwordx4 v171, s[12:15], s39 offen offset:0 lds
    buffer_load_dwordx4 v172, s[12:15], s39 offen offset:1024 lds
    buffer_load_dwordx4 v173, s[12:15], s39 offen offset:2048 lds
    buffer_load_dwordx4 v174, s[12:15], s39 offen offset:3072 lds
    s_add_u32 m0, s41, 0xb000
    s_nop 0
    buffer_load_dwordx4 v175, s[12:15], s39 offen lds
    v_mov_b32 v36, -1
    v_mov_b32 v37, -1
    v_mov_b32 v38, -1
    v_mov_b32 v39, -1
    s_lshl_b32 s36, s32, 1
    s_add_u32 s36, s36, s35
    s_lshl_b32 s36, s36, 1
    s_add_u32 s36, s36, s34
    s_lshl_b32 s36, s36, 4
    s_add_u32 s36, s36, s31
    s_lshl_b32 s36, s36, 10
    s_add_u32 s36, s36, 0x900000
    v_lshlrev_b32 v35, 4, v190
    buffer_store_dwordx4 v[36:39], v35, s[16:19], s36 offen sc1
    s_nop 1
    v_lshlrev_b32 v35, 3, v190
    v_cmp_lt_u32 vcc, 15, v190
    v_mov_b32 v34, s91
    s_nop 0
    v_cndmask_b32 v35, v35, v34, vcc
    s_lshl_b32 s36, s31, 7
    s_lshr_b32 s37, s32, 1
    s_lshl_b32 s37, s37, 5
    s_add_u32 s36, s36, s37
    s_and_b32 s37, s32, 1
    s_add_u32 s36, s36, s37
    s_lshl_b32 s36, s36, 2
    s_add_u32 s36, s36, 0x800000
    s_lshr_b32 s37, s32, 2
    s_lshl_b32 s37, s37, 1
    s_cmp_eq_u32 s37, s33
    s_cselect_b32 s42, s36, s91
    buffer_store_dword v36, v35, s[16:19], s42 offen sc1
    s_waitcnt vmcnt(21)
    s_barrier
    ds_read_b64_tr_b16 v[120:121], v160 offset:0
    ds_read_b64_tr_b16 v[122:123], v160 offset:1280
    ds_read_b128 a[0:3], v167 offset:0
    ds_read_b128 a[4:7], v167 offset:2048
    ds_read_b128 a[8:11], v168 offset:0
    ds_read_b128 a[12:15], v168 offset:2048
    ds_read_b64_tr_b16 v[124:125], v161 offset:0
    ds_read_b64_tr_b16 v[126:127], v161 offset:1280
    ds_read_b64_tr_b16 v[128:129], v162 offset:0
    ds_read_b64_tr_b16 v[130:131], v162 offset:1280
    ds_read_b64_tr_b16 v[132:133], v163 offset:0
    ds_read_b64_tr_b16 v[134:135], v163 offset:1280
    ds_read_b64_tr_b16 v[136:137], v164 offset:0
    ds_read_b64_tr_b16 v[138:139], v164 offset:1280
    ds_read_b128 v[96:99], v104 offset:0
    s_waitcnt lgkmcnt(12)
    v_mfma_f32_16x16x32_bf16 v[0:3], a[0:3], v[120:123], 0
    ds_read_b64_tr_b16 v[140:141], v160 offset:10240
    s_waitcnt lgkmcnt(12)
    v_mfma_f32_16x16x32_bf16 v[4:7], a[4:7], v[120:123], 0
    ds_read_b64_tr_b16 v[142:143], v160 offset:11520
    s_waitcnt lgkmcnt(12)
    v_mfma_f32_16x16x32_bf16 v[8:11], a[8:11], v[120:123], 0
    s_waitcnt lgkmcnt(11)
    v_mfma_f32_16x16x32_bf16 v[12:15], a[12:15], v[120:123], 0
    ds_read_b128 a[16:19], v169 offset:0
    s_waitcnt lgkmcnt(10)
    v_mfma_f32_16x16x32_bf16 v[16:19], a[0:3], v[124:127], 0
    ds_read_b128 a[20:23], v169 offset:2048
    s_waitcnt lgkmcnt(4)
    v_mfma_f32_16x16x32_bf16 v[80:83], v[96:99], a[0:3], 0
    v_mfma_f32_16x16x32_bf16 v[20:23], a[4:7], v[124:127], 0
    ds_read_b128 a[24:27], v170 offset:0
    v_mfma_f32_16x16x32_bf16 v[24:27], a[8:11], v[124:127], 0
    ds_read_b128 a[28:31], v170 offset:2048
    v_mfma_f32_16x16x32_bf16 v[28:31], a[12:15], v[124:127], 0
    v_mfma_f32_16x16x32_bf16 v[32:35], a[0:3], v[128:131], 0
    ds_read_b64_tr_b16 v[144:145], v161 offset:10240
    v_mfma_f32_16x16x32_bf16 v[36:39], a[4:7], v[128:131], 0
    ds_read_b64_tr_b16 v[146:147], v161 offset:11520
    v_mfma_f32_16x16x32_bf16 v[84:87], v[96:99], a[4:7], 0
    v_mfma_f32_16x16x32_bf16 v[40:43], a[8:11], v[128:131], 0
    ds_read_b64_tr_b16 v[148:149], v162 offset:10240
    v_mfma_f32_16x16x32_bf16 v[44:47], a[12:15], v[128:131], 0
    ds_read_b64_tr_b16 v[150:151], v162 offset:11520
    v_mfma_f32_16x16x32_bf16 v[48:51], a[0:3], v[132:135], 0
    v_mfma_f32_16x16x32_bf16 v[52:55], a[4:7], v[132:135], 0
    ds_read_b64_tr_b16 v[152:153], v163 offset:10240
    v_mfma_f32_16x16x32_bf16 v[56:59], a[8:11], v[132:135], 0
    ds_read_b64_tr_b16 v[154:155], v163 offset:11520
    v_mfma_f32_16x16x32_bf16 v[88:91], v[96:99], a[8:11], 0
    v_mfma_f32_16x16x32_bf16 v[60:63], a[12:15], v[132:135], 0
    ds_read_b64_tr_b16 v[156:157], v164 offset:10240
    v_mfma_f32_16x16x32_bf16 v[64:67], a[0:3], v[136:139], 0
    ds_read_b64_tr_b16 v[158:159], v164 offset:11520
    v_mfma_f32_16x16x32_bf16 v[68:71], a[4:7], v[136:139], 0
    v_mfma_f32_16x16x32_bf16 v[72:75], a[8:11], v[136:139], 0
    ds_read_b128 v[100:103], v104 offset:64
    v_mfma_f32_16x16x32_bf16 v[76:79], a[12:15], v[136:139], 0
    s_lshl_b32 s36, s33, 4
    s_lshr_b32 s37, s94, 4
    s_add_u32 s36, s36, s37
    s_cmp_lt_u32 s36, 20
    s_cbranch_scc0 Lwp_1
    s_and_b32 s37, s94, 15
    s_mul_i32 s37, s37, 0x64
    s_mul_i32 s42, s36, 5
    s_add_u32 s37, s37, s42
    s_lshl_b32 s37, s37, 10
    s_add_u32 s99, s37, 0xc00000
    s_mul_i32 s37, s36, 0xcd
    s_lshr_b32 s37, s37, 10
    s_mul_i32 s42, s37, 5
    s_sub_u32 s42, s36, s42
    s_mul_i32 s37, s37, 0xa0
    s_mul_i32 s43, s42, 40
    s_cmp_eq_u32 s42, 4
    s_cselect_b32 s43, 16, s43
    s_cselect_b32 s100, 0x50, 4
    s_cselect_b32 s101, 40, 8
    s_add_u32 s37, s37, s43
    s_mul_i32 s37, s37, 0x500
    s_and_b32 s42, s94, 15
    s_and_b32 s42, s42, 7
    s_mul_i32 s42, s42, 0xa0
    s_add_u32 s98, s37, s42
    s_mul_i32 s100, s100, 0x500
    s_mul_i32 s101, s101, 0x500
    s_movk_i32 s43, 0x500
    s_movk_i32 s42, 0x6400
    v_add_u32 v224, 0, v190
    v_add_u32 v228, 64, v190
    v_add_u32 v232, 0x80, v190
    v_add_u32 v236, 0xc0, v190
    v_add_u32 v240, 0x100, v190
    v_mul_u32_u24 v225, 0xcd, v224
    v_mul_u32_u24 v229, 0xcd, v228
    v_mul_u32_u24 v233, 0xcd, v232
    v_mul_u32_u24 v237, 0xcd, v236
    v_mul_u32_u24 v241, 0xcd, v240
    v_lshrrev_b32 v225, 11, v225
    v_lshrrev_b32 v229, 11, v229
    v_lshrrev_b32 v233, 11, v233
    v_lshrrev_b32 v237, 11, v237
    v_lshrrev_b32 v241, 11, v241
    v_mul_u32_u24 v226, 10, v225
    v_mul_u32_u24 v230, 10, v229
    v_mul_u32_u24 v234, 10, v233
    v_mul_u32_u24 v238, 10, v237
    v_mul_u32_u24 v242, 10, v241
    v_sub_u32 v224, v224, v226
    v_sub_u32 v228, v228, v230
    v_sub_u32 v232, v232, v234
    v_sub_u32 v236, v236, v238
    v_sub_u32 v240, v240, v242
    v_lshlrev_b32 v224, 4, v224
    v_lshlrev_b32 v228, 4, v228
    v_lshlrev_b32 v232, 4, v232
    v_lshlrev_b32 v236, 4, v236
    v_lshlrev_b32 v240, 4, v240
    v_lshrrev_b32 v226, 4, v225
    v_lshrrev_b32 v230, 4, v229
    v_lshrrev_b32 v234, 4, v233
    v_lshrrev_b32 v238, 4, v237
    v_lshrrev_b32 v242, 4, v241
    v_mad_u32_u24 v224, v226, s101, v224
    v_mad_u32_u24 v228, v230, s101, v228
    v_mad_u32_u24 v232, v234, s101, v232
    v_mad_u32_u24 v236, v238, s101, v236
    v_mad_u32_u24 v240, v242, s101, v240
    v_bfe_u32 v226, v225, 3, 1
    v_bfe_u32 v230, v229, 3, 1
    v_bfe_u32 v234, v233, 3, 1
    v_bfe_u32 v238, v237, 3, 1
    v_bfe_u32 v242, v241, 3, 1
    v_mad_u32_u24 v224, v226, s100, v224
    v_mad_u32_u24 v228, v230, s100, v228
    v_mad_u32_u24 v232, v234, s100, v232
    v_mad_u32_u24 v236, v238, s100, v236
    v_mad_u32_u24 v240, v242, s100, v240
    v_bfe_u32 v226, v225, 2, 1
    v_bfe_u32 v230, v229, 2, 1
    v_bfe_u32 v234, v233, 2, 1
    v_bfe_u32 v238, v237, 2, 1
    v_bfe_u32 v242, v241, 2, 1
    v_mad_u32_u24 v224, v226, s42, v224
    v_mad_u32_u24 v228, v230, s42, v228
    v_mad_u32_u24 v232, v234, s42, v232
    v_mad_u32_u24 v236, v238, s42, v236
    v_mad_u32_u24 v240, v242, s42, v240
    v_and_b32 v226, 3, v225
    v_and_b32 v230, 3, v229
    v_and_b32 v234, 3, v233
    v_and_b32 v238, 3, v237
    v_and_b32 v242, 3, v241
    v_mad_u32_u24 v224, v226, s43, v224
    v_mad_u32_u24 v228, v230, s43, v228
    v_mad_u32_u24 v232, v234, s43, v232
    v_mad_u32_u24 v236, v238, s43, v236
    v_mad_u32_u24 v240, v242, s43, v240
    s_mul_i32 s36, s33, 0x1400
    s_add_u32 s36, s36, 0x1e000
    s_add_u32 m0, s36, 0
    s_nop 0
    buffer_load_dwordx4 v224, s[4:7], s98 offen lds
    s_add_u32 m0, s36, 0x400
    s_nop 0
    buffer_load_dwordx4 v228, s[4:7], s98 offen lds
    s_add_u32 m0, s36, 0x800
    s_nop 0
    buffer_load_dwordx4 v232, s[4:7], s98 offen lds
    s_add_u32 m0, s36, 0xc00
    s_nop 0
    buffer_load_dwordx4 v236, s[4:7], s98 offen lds
    s_add_u32 m0, s36, 0x1000
    s_nop 0
    buffer_load_dwordx4 v240, s[4:7], s98 offen lds
Lwp_1:
    v_mfma_f32_16x16x32_bf16 v[92:95], v[96:99], a[12:15], 0
    s_waitcnt vmcnt(7)
    s_waitcnt lgkmcnt(0)
    s_barrier
    v_mfma_f32_16x16x32_bf16 v[0:3], a[16:19], v[140:143], v[0:3]
    ds_read_b64_tr_b16 v[120:121], v160 offset:20480
    v_mfma_f32_16x16x32_bf16 v[4:7], a[20:23], v[140:143], v[4:7]
    s_add_u32 m0, s41, 0
    s_lshl_b32 s38, s92, 7
    s_mul_i32 s39, s92, 0x3c000
    s_add_u32 s92, s92, 1
    s_sub_u32 s36, s92, 10
    s_cmp_lt_u32 s92, 10
    s_cselect_b32 s92, s92, s36
    v_mfma_f32_16x16x32_bf16 v[8:11], a[24:27], v[140:143], v[8:11]
    ds_read_b64_tr_b16 v[122:123], v160 offset:21760
    v_mfma_f32_16x16x32_bf16 v[12:15], a[28:31], v[140:143], v[12:15]
    ds_read_b128 a[32:35], v167 offset:16384
    v_mfma_f32_16x16x32_bf16 v[16:19], a[16:19], v[144:147], v[16:19]
    buffer_load_dwordx4 v171, s[12:15], s39 offen offset:0 lds
    v_mfma_f32_16x16x32_bf16 v[80:83], v[100:103], a[16:19], v[80:83]
    ds_read_b128 a[36:39], v167 offset:18432
    v_mfma_f32_16x16x32_bf16 v[20:23], a[20:23], v[144:147], v[20:23]
    ds_read_b128 a[40:43], v168 offset:16384
    v_mfma_f32_16x16x32_bf16 v[24:27], a[24:27], v[144:147], v[24:27]
    buffer_load_dwordx4 v172, s[12:15], s39 offen offset:1024 lds
    v_mfma_f32_16x16x32_bf16 v[28:31], a[28:31], v[144:147], v[28:31]
    ds_read_b128 a[44:47], v168 offset:18432
    v_mfma_f32_16x16x32_bf16 v[32:35], a[16:19], v[148:151], v[32:35]
    ds_read_b64_tr_b16 v[124:125], v161 offset:20480
    v_mfma_f32_16x16x32_bf16 v[36:39], a[20:23], v[148:151], v[36:39]
    buffer_load_dwordx4 v173, s[12:15], s39 offen offset:2048 lds
    v_mfma_f32_16x16x32_bf16 v[84:87], v[100:103], a[20:23], v[84:87]
    v_mfma_f32_16x16x32_bf16 v[40:43], a[24:27], v[148:151], v[40:43]
    ds_read_b64_tr_b16 v[126:127], v161 offset:21760
    v_mfma_f32_16x16x32_bf16 v[44:47], a[28:31], v[148:151], v[44:47]
    ds_read_b64_tr_b16 v[128:129], v162 offset:20480
    v_mfma_f32_16x16x32_bf16 v[48:51], a[16:19], v[152:155], v[48:51]
    buffer_load_dwordx4 v174, s[12:15], s39 offen offset:3072 lds
    v_mfma_f32_16x16x32_bf16 v[52:55], a[20:23], v[152:155], v[52:55]
    ds_read_b64_tr_b16 v[130:131], v162 offset:21760
    v_mfma_f32_16x16x32_bf16 v[56:59], a[24:27], v[152:155], v[56:59]
    ds_read_b64_tr_b16 v[132:133], v163 offset:20480
    v_mfma_f32_16x16x32_bf16 v[88:91], v[100:103], a[24:27], v[88:91]
    s_add_u32 m0, s41, 0x1000
    v_mfma_f32_16x16x32_bf16 v[60:63], a[28:31], v[152:155], v[60:63]
    ds_read_b64_tr_b16 v[134:135], v163 offset:21760
    v_mfma_f32_16x16x32_bf16 v[64:67], a[16:19], v[156:159], v[64:67]
    ds_read_b64_tr_b16 v[136:137], v164 offset:20480
    v_mfma_f32_16x16x32_bf16 v[68:71], a[20:23], v[156:159], v[68:71]
    buffer_load_dwordx4 v175, s[12:15], s39 offen lds
    v_mfma_f32_16x16x32_bf16 v[72:75], a[24:27], v[156:159], v[72:75]
    ds_read_b64_tr_b16 v[138:139], v164 offset:21760
    v_mfma_f32_16x16x32_bf16 v[76:79], a[28:31], v[156:159], v[76:79]
    ds_read_b128 v[96:99], v104 offset:128
    v_mfma_f32_16x16x32_bf16 v[92:95], v[100:103], a[28:31], v[92:95]
    s_waitcnt lgkmcnt(12)
    v_mfma_f32_16x16x32_bf16 v[0:3], a[32:35], v[120:123], v[0:3]
    ds_read_b64_tr_b16 v[140:141], v160 offset:30720
    s_waitcnt lgkmcnt(12)
    v_mfma_f32_16x16x32_bf16 v[4:7], a[36:39], v[120:123], v[4:7]
    s_add_u32 m0, s40, 0
    s_waitcnt lgkmcnt(11)
    v_mfma_f32_16x16x32_bf16 v[8:11], a[40:43], v[120:123], v[8:11]
    ds_read_b64_tr_b16 v[142:143], v160 offset:32000
    s_waitcnt lgkmcnt(11)
    v_mfma_f32_16x16x32_bf16 v[12:15], a[44:47], v[120:123], v[12:15]
    ds_read_b128 a[48:51], v169 offset:16384
    s_waitcnt lgkmcnt(10)
    v_mfma_f32_16x16x32_bf16 v[16:19], a[32:35], v[124:127], v[16:19]
    buffer_load_dwordx4 v176, s[8:11], s38 offen lds
    s_waitcnt lgkmcnt(3)
    v_mfma_f32_16x16x32_bf16 v[80:83], v[96:99], a[32:35], v[80:83]
    ds_read_b128 a[52:55], v169 offset:18432
    v_mfma_f32_16x16x32_bf16 v[20:23], a[36:39], v[124:127], v[20:23]
    ds_read_b128 a[56:59], v170 offset:16384
    v_mfma_f32_16x16x32_bf16 v[24:27], a[40:43], v[124:127], v[24:27]
    buffer_load_dwordx4 v177, s[8:11], s38 offen offset:1024 lds
    v_mfma_f32_16x16x32_bf16 v[28:31], a[44:47], v[124:127], v[28:31]
    ds_read_b128 a[60:63], v170 offset:18432
    v_mfma_f32_16x16x32_bf16 v[32:35], a[32:35], v[128:131], v[32:35]
    ds_read_b64_tr_b16 v[144:145], v161 offset:30720
    v_mfma_f32_16x16x32_bf16 v[36:39], a[36:39], v[128:131], v[36:39]
    s_add_u32 m0, s40, 0x800
    v_mfma_f32_16x16x32_bf16 v[84:87], v[96:99], a[36:39], v[84:87]
    v_mfma_f32_16x16x32_bf16 v[40:43], a[40:43], v[128:131], v[40:43]
    ds_read_b64_tr_b16 v[146:147], v161 offset:32000
    v_mfma_f32_16x16x32_bf16 v[44:47], a[44:47], v[128:131], v[44:47]
    ds_read_b64_tr_b16 v[148:149], v162 offset:30720
    v_mfma_f32_16x16x32_bf16 v[48:51], a[32:35], v[132:135], v[48:51]
    buffer_load_dwordx4 v178, s[8:11], s38 offen lds
    v_mfma_f32_16x16x32_bf16 v[52:55], a[36:39], v[132:135], v[52:55]
    ds_read_b64_tr_b16 v[150:151], v162 offset:32000
    v_mfma_f32_16x16x32_bf16 v[56:59], a[40:43], v[132:135], v[56:59]
    ds_read_b64_tr_b16 v[152:153], v163 offset:30720
    v_mfma_f32_16x16x32_bf16 v[88:91], v[96:99], a[40:43], v[88:91]
    buffer_load_dwordx4 v179, s[8:11], s38 offen offset:1024 lds
    v_mfma_f32_16x16x32_bf16 v[60:63], a[44:47], v[132:135], v[60:63]
    ds_read_b64_tr_b16 v[154:155], v163 offset:32000
    v_mfma_f32_16x16x32_bf16 v[64:67], a[32:35], v[136:139], v[64:67]
    ds_read_b64_tr_b16 v[156:157], v164 offset:30720
    v_mfma_f32_16x16x32_bf16 v[68:71], a[36:39], v[136:139], v[68:71]
    v_mfma_f32_16x16x32_bf16 v[72:75], a[40:43], v[136:139], v[72:75]
    ds_read_b64_tr_b16 v[158:159], v164 offset:32000
    v_mfma_f32_16x16x32_bf16 v[76:79], a[44:47], v[136:139], v[76:79]
    ds_read_b128 v[100:103], v104 offset:192
    v_mfma_f32_16x16x32_bf16 v[92:95], v[96:99], a[44:47], v[92:95]
    s_waitcnt vmcnt(11)
    s_waitcnt lgkmcnt(0)
    s_barrier
    v_mfma_f32_16x16x32_bf16 v[0:3], a[48:51], v[140:143], v[0:3]
    ds_read_b64_tr_b16 v[120:121], v160 offset:40960
    v_mfma_f32_16x16x32_bf16 v[4:7], a[52:55], v[140:143], v[4:7]
    s_add_u32 m0, s41, 0x5000
    s_lshl_b32 s38, s92, 7
    s_mul_i32 s39, s92, 0x3c000
    s_add_u32 s92, s92, 1
    s_sub_u32 s36, s92, 10
    s_cmp_lt_u32 s92, 10
    s_cselect_b32 s92, s92, s36
    v_mfma_f32_16x16x32_bf16 v[8:11], a[56:59], v[140:143], v[8:11]
    ds_read_b64_tr_b16 v[122:123], v160 offset:42240
    v_mfma_f32_16x16x32_bf16 v[12:15], a[60:63], v[140:143], v[12:15]
    ds_read_b128 a[64:67], v167 offset:32768
    v_mfma_f32_16x16x32_bf16 v[16:19], a[48:51], v[144:147], v[16:19]
    buffer_load_dwordx4 v171, s[12:15], s39 offen offset:0 lds
    v_mfma_f32_16x16x32_bf16 v[80:83], v[100:103], a[48:51], v[80:83]
    ds_read_b128 a[68:71], v167 offset:34816
    v_mfma_f32_16x16x32_bf16 v[20:23], a[52:55], v[144:147], v[20:23]
    ds_read_b128 a[72:75], v168 offset:32768
    v_mfma_f32_16x16x32_bf16 v[24:27], a[56:59], v[144:147], v[24:27]
    buffer_load_dwordx4 v172, s[12:15], s39 offen offset:1024 lds
    v_mfma_f32_16x16x32_bf16 v[28:31], a[60:63], v[144:147], v[28:31]
    ds_read_b128 a[76:79], v168 offset:34816
    v_mfma_f32_16x16x32_bf16 v[32:35], a[48:51], v[148:151], v[32:35]
    ds_read_b64_tr_b16 v[124:125], v161 offset:40960
    v_mfma_f32_16x16x32_bf16 v[36:39], a[52:55], v[148:151], v[36:39]
    buffer_load_dwordx4 v173, s[12:15], s39 offen offset:2048 lds
    v_mfma_f32_16x16x32_bf16 v[84:87], v[100:103], a[52:55], v[84:87]
    v_mfma_f32_16x16x32_bf16 v[40:43], a[56:59], v[148:151], v[40:43]
    ds_read_b64_tr_b16 v[126:127], v161 offset:42240
    v_mfma_f32_16x16x32_bf16 v[44:47], a[60:63], v[148:151], v[44:47]
    ds_read_b64_tr_b16 v[128:129], v162 offset:40960
    v_mfma_f32_16x16x32_bf16 v[48:51], a[48:51], v[152:155], v[48:51]
    buffer_load_dwordx4 v174, s[12:15], s39 offen offset:3072 lds
    v_mfma_f32_16x16x32_bf16 v[52:55], a[52:55], v[152:155], v[52:55]
    ds_read_b64_tr_b16 v[130:131], v162 offset:42240
    v_mfma_f32_16x16x32_bf16 v[56:59], a[56:59], v[152:155], v[56:59]
    ds_read_b64_tr_b16 v[132:133], v163 offset:40960
    v_mfma_f32_16x16x32_bf16 v[88:91], v[100:103], a[56:59], v[88:91]
    s_add_u32 m0, s41, 0x6000
    v_mfma_f32_16x16x32_bf16 v[60:63], a[60:63], v[152:155], v[60:63]
    ds_read_b64_tr_b16 v[134:135], v163 offset:42240
    v_mfma_f32_16x16x32_bf16 v[64:67], a[48:51], v[156:159], v[64:67]
    ds_read_b64_tr_b16 v[136:137], v164 offset:40960
    v_mfma_f32_16x16x32_bf16 v[68:71], a[52:55], v[156:159], v[68:71]
    buffer_load_dwordx4 v175, s[12:15], s39 offen lds
    v_mfma_f32_16x16x32_bf16 v[72:75], a[56:59], v[156:159], v[72:75]
    ds_read_b64_tr_b16 v[138:139], v164 offset:42240
    v_mfma_f32_16x16x32_bf16 v[76:79], a[60:63], v[156:159], v[76:79]
    ds_read_b128 v[96:99], v104 offset:256
    v_mfma_f32_16x16x32_bf16 v[92:95], v[100:103], a[60:63], v[92:95]
    s_waitcnt lgkmcnt(12)
    v_mfma_f32_16x16x32_bf16 v[0:3], a[64:67], v[120:123], v[0:3]
    ds_read_b64_tr_b16 v[140:141], v160 offset:51200
    s_waitcnt lgkmcnt(12)
    v_mfma_f32_16x16x32_bf16 v[4:7], a[68:71], v[120:123], v[4:7]
    s_add_u32 m0, s40, 0x4000
    s_waitcnt lgkmcnt(11)
    v_mfma_f32_16x16x32_bf16 v[8:11], a[72:75], v[120:123], v[8:11]
    ds_read_b64_tr_b16 v[142:143], v160 offset:52480
    s_waitcnt lgkmcnt(11)
    v_mfma_f32_16x16x32_bf16 v[12:15], a[76:79], v[120:123], v[12:15]
    ds_read_b128 a[80:83], v169 offset:32768
    s_waitcnt lgkmcnt(10)
    v_mfma_f32_16x16x32_bf16 v[16:19], a[64:67], v[124:127], v[16:19]
    buffer_load_dwordx4 v176, s[8:11], s38 offen lds
    s_waitcnt lgkmcnt(3)
    v_mfma_f32_16x16x32_bf16 v[80:83], v[96:99], a[64:67], v[80:83]
    ds_read_b128 a[84:87], v169 offset:34816
    v_mfma_f32_16x16x32_bf16 v[20:23], a[68:71], v[124:127], v[20:23]
    ds_read_b128 a[88:91], v170 offset:32768
    v_mfma_f32_16x16x32_bf16 v[24:27], a[72:75], v[124:127], v[24:27]
    buffer_load_dwordx4 v177, s[8:11], s38 offen offset:1024 lds
    v_mfma_f32_16x16x32_bf16 v[28:31], a[76:79], v[124:127], v[28:31]
    ds_read_b128 a[92:95], v170 offset:34816
    v_mfma_f32_16x16x32_bf16 v[32:35], a[64:67], v[128:131], v[32:35]
    ds_read_b64_tr_b16 v[144:145], v161 offset:51200
    v_mfma_f32_16x16x32_bf16 v[36:39], a[68:71], v[128:131], v[36:39]
    s_add_u32 m0, s40, 0x4800
    v_mfma_f32_16x16x32_bf16 v[84:87], v[96:99], a[68:71], v[84:87]
    v_mfma_f32_16x16x32_bf16 v[40:43], a[72:75], v[128:131], v[40:43]
    ds_read_b64_tr_b16 v[146:147], v161 offset:52480
    v_mfma_f32_16x16x32_bf16 v[44:47], a[76:79], v[128:131], v[44:47]
    ds_read_b64_tr_b16 v[148:149], v162 offset:51200
    v_mfma_f32_16x16x32_bf16 v[48:51], a[64:67], v[132:135], v[48:51]
    buffer_load_dwordx4 v178, s[8:11], s38 offen lds
    v_mfma_f32_16x16x32_bf16 v[52:55], a[68:71], v[132:135], v[52:55]
    ds_read_b64_tr_b16 v[150:151], v162 offset:52480
    v_mfma_f32_16x16x32_bf16 v[56:59], a[72:75], v[132:135], v[56:59]
    ds_read_b64_tr_b16 v[152:153], v163 offset:51200
    v_mfma_f32_16x16x32_bf16 v[88:91], v[96:99], a[72:75], v[88:91]
    buffer_load_dwordx4 v179, s[8:11], s38 offen offset:1024 lds
    v_mfma_f32_16x16x32_bf16 v[60:63], a[76:79], v[132:135], v[60:63]
    ds_read_b64_tr_b16 v[154:155], v163 offset:52480
    v_mfma_f32_16x16x32_bf16 v[64:67], a[64:67], v[136:139], v[64:67]
    ds_read_b64_tr_b16 v[156:157], v164 offset:51200
    v_mfma_f32_16x16x32_bf16 v[68:71], a[68:71], v[136:139], v[68:71]
    v_mfma_f32_16x16x32_bf16 v[72:75], a[72:75], v[136:139], v[72:75]
    ds_read_b64_tr_b16 v[158:159], v164 offset:52480
    v_mfma_f32_16x16x32_bf16 v[76:79], a[76:79], v[136:139], v[76:79]
    ds_read_b128 v[100:103], v104 offset:320
    v_mfma_f32_16x16x32_bf16 v[92:95], v[96:99], a[76:79], v[92:95]
    s_waitcnt vmcnt(9)
    s_waitcnt lgkmcnt(0)
    s_barrier
    v_mfma_f32_16x16x32_bf16 v[0:3], a[80:83], v[140:143], v[0:3]
    ds_read_b64_tr_b16 v[120:121], v160 offset:0
    v_mfma_f32_16x16x32_bf16 v[4:7], a[84:87], v[140:143], v[4:7]
    ds_read_b64_tr_b16 v[122:123], v160 offset:1280
    v_mfma_f32_16x16x32_bf16 v[8:11], a[88:91], v[140:143], v[8:11]
    ds_read_b128 a[96:99], v167 offset:0
    v_mfma_f32_16x16x32_bf16 v[12:15], a[92:95], v[140:143], v[12:15]
    ds_read_b128 a[100:103], v167 offset:2048
    v_mfma_f32_16x16x32_bf16 v[16:19], a[80:83], v[144:147], v[16:19]
    ds_read_b128 a[104:107], v168 offset:0
    v_mfma_f32_16x16x32_bf16 v[80:83], v[100:103], a[80:83], v[80:83]
    ds_read_b128 a[108:111], v168 offset:2048
    v_mfma_f32_16x16x32_bf16 v[20:23], a[84:87], v[144:147], v[20:23]
    ds_read_b64_tr_b16 v[124:125], v161 offset:0
    v_mfma_f32_16x16x32_bf16 v[24:27], a[88:91], v[144:147], v[24:27]
    ds_read_b64_tr_b16 v[126:127], v161 offset:1280
    v_mfma_f32_16x16x32_bf16 v[28:31], a[92:95], v[144:147], v[28:31]
    ds_read_b64_tr_b16 v[128:129], v162 offset:0
    v_mfma_f32_16x16x32_bf16 v[32:35], a[80:83], v[148:151], v[32:35]
    ds_read_b64_tr_b16 v[130:131], v162 offset:1280
    v_mfma_f32_16x16x32_bf16 v[36:39], a[84:87], v[148:151], v[36:39]
    ds_read_b64_tr_b16 v[132:133], v163 offset:0
    v_mfma_f32_16x16x32_bf16 v[84:87], v[100:103], a[84:87], v[84:87]
    ds_read_b64_tr_b16 v[134:135], v163 offset:1280
    v_mfma_f32_16x16x32_bf16 v[40:43], a[88:91], v[148:151], v[40:43]
    ds_read_b64_tr_b16 v[136:137], v164 offset:0
    v_mfma_f32_16x16x32_bf16 v[44:47], a[92:95], v[148:151], v[44:47]
    ds_read_b64_tr_b16 v[138:139], v164 offset:1280
    v_mfma_f32_16x16x32_bf16 v[48:51], a[80:83], v[152:155], v[48:51]
    ds_read_b128 v[96:99], v104 offset:384
    v_mfma_f32_16x16x32_bf16 v[52:55], a[84:87], v[152:155], v[52:55]
    s_add_u32 m0, s41, 0xa000
    s_lshl_b32 s38, s92, 7
    s_mul_i32 s39, s92, 0x3c000
    s_add_u32 s92, s92, 1
    s_sub_u32 s36, s92, 10
    s_cmp_lt_u32 s92, 10
    s_cselect_b32 s92, s92, s36
    v_mfma_f32_16x16x32_bf16 v[56:59], a[88:91], v[152:155], v[56:59]
    buffer_load_dwordx4 v171, s[12:15], s39 offen offset:0 lds
    v_mfma_f32_16x16x32_bf16 v[88:91], v[100:103], a[88:91], v[88:91]
    buffer_load_dwordx4 v172, s[12:15], s39 offen offset:1024 lds
    v_mfma_f32_16x16x32_bf16 v[60:63], a[92:95], v[152:155], v[60:63]
    buffer_load_dwordx4 v173, s[12:15], s39 offen offset:2048 lds
    v_mfma_f32_16x16x32_bf16 v[64:67], a[80:83], v[156:159], v[64:67]
    buffer_load_dwordx4 v174, s[12:15], s39 offen offset:3072 lds
    v_mfma_f32_16x16x32_bf16 v[68:71], a[84:87], v[156:159], v[68:71]
    s_add_u32 m0, s41, 0xb000
    v_mfma_f32_16x16x32_bf16 v[72:75], a[88:91], v[156:159], v[72:75]
    buffer_load_dwordx4 v175, s[12:15], s39 offen lds
    v_mfma_f32_16x16x32_bf16 v[76:79], a[92:95], v[156:159], v[76:79]
    s_lshl_b32 s36, s33, 4
    s_lshr_b32 s37, s94, 4
    s_add_u32 s36, s36, s37
    s_cmp_lt_u32 s36, 20
    s_cbranch_scc0 Lwq_2
    s_waitcnt vmcnt(23)
    v_lshrrev_b32 v224, 4, v190
    v_lshlrev_b32 v224, 3, v224
    v_bfe_u32 v225, v190, 2, 2
    v_add_u32 v224, v224, v225
    v_mul_u32_u24 v224, 0xa0, v224
    v_and_b32 v225, 3, v190
    v_mul_u32_u24 v225, 40, v225
    s_mul_i32 s36, s33, 0x1400
    s_add_u32 s36, s36, 0x1e000
    v_add3_u32 v224, v224, v225, s36
    ds_read_b64_tr_b16 v[228:229], v224 offset:0
    ds_read_b64_tr_b16 v[230:231], v224 offset:640
    ds_read_b64_tr_b16 v[232:233], v224 offset:8
    ds_read_b64_tr_b16 v[234:235], v224 offset:648
    ds_read_b64_tr_b16 v[236:237], v224 offset:16
    ds_read_b64_tr_b16 v[238:239], v224 offset:656
    ds_read_b64_tr_b16 v[240:241], v224 offset:24
    ds_read_b64_tr_b16 v[242:243], v224 offset:664
    ds_read_b64_tr_b16 v[244:245], v224 offset:32
    ds_read_b64_tr_b16 v[246:247], v224 offset:672
    v_lshlrev_b32 v225, 4, v190
    s_add_u32 s37, s99, 0x1000
    s_waitcnt lgkmcnt(8)
    buffer_store_dwordx4 v[228:231], v225, s[16:19], s99 offen offset:0 sc1
    s_waitcnt lgkmcnt(6)
    buffer_store_dwordx4 v[232:235], v225, s[16:19], s99 offen offset:1024 sc1
    s_waitcnt lgkmcnt(4)
    buffer_store_dwordx4 v[236:239], v225, s[16:19], s99 offen offset:2048 sc1
    s_waitcnt lgkmcnt(2)
    buffer_store_dwordx4 v[240:243], v225, s[16:19], s99 offen offset:3072 sc1
    s_waitcnt lgkmcnt(0)
    buffer_store_dwordx4 v[244:247], v225, s[16:19], s37 offen offset:0 sc1
    s_waitcnt lgkmcnt(0)
Lwq_2:
    v_mfma_f32_16x16x32_bf16 v[92:95], v[100:103], a[92:95], v[92:95]
    s_waitcnt lgkmcnt(12)
    v_mfma_f32_16x16x32_bf16 v[0:3], a[96:99], v[120:123], v[0:3]
    ds_read_b64_tr_b16 v[140:141], v160 offset:10240
    s_waitcnt lgkmcnt(12)
    v_mfma_f32_16x16x32_bf16 v[4:7], a[100:103], v[120:123], v[4:7]
    ds_read_b64_tr_b16 v[142:143], v160 offset:11520
    s_waitcnt lgkmcnt(12)
    v_mfma_f32_16x16x32_bf16 v[8:11], a[104:107], v[120:123], v[8:11]
    ds_read_b128 a[112:115], v169 offset:0
    s_waitcnt lgkmcnt(12)
    v_mfma_f32_16x16x32_bf16 v[12:15], a[108:111], v[120:123], v[12:15]
    ds_read_b128 a[116:119], v169 offset:2048
    s_waitcnt lgkmcnt(11)
    v_mfma_f32_16x16x32_bf16 v[16:19], a[96:99], v[124:127], v[16:19]
    ds_read_b128 a[120:123], v170 offset:0
    s_waitcnt lgkmcnt(5)
    v_mfma_f32_16x16x32_bf16 v[80:83], v[96:99], a[96:99], v[80:83]
    ds_read_b128 a[124:127], v170 offset:2048
    v_mfma_f32_16x16x32_bf16 v[20:23], a[100:103], v[124:127], v[20:23]
    ds_read_b64_tr_b16 v[144:145], v161 offset:10240
    v_mfma_f32_16x16x32_bf16 v[24:27], a[104:107], v[124:127], v[24:27]
    ds_read_b64_tr_b16 v[146:147], v161 offset:11520
    v_mfma_f32_16x16x32_bf16 v[28:31], a[108:111], v[124:127], v[28:31]
    ds_read_b64_tr_b16 v[148:149], v162 offset:10240
    v_mfma_f32_16x16x32_bf16 v[32:35], a[96:99], v[128:131], v[32:35]
    ds_read_b64_tr_b16 v[150:151], v162 offset:11520
    v_mfma_f32_16x16x32_bf16 v[36:39], a[100:103], v[128:131], v[36:39]
    ds_read_b64_tr_b16 v[152:153], v163 offset:10240
    v_mfma_f32_16x16x32_bf16 v[84:87], v[96:99], a[100:103], v[84:87]
    ds_read_b64_tr_b16 v[154:155], v163 offset:11520
    v_mfma_f32_16x16x32_bf16 v[40:43], a[104:107], v[128:131], v[40:43]
    ds_read_b64_tr_b16 v[156:157], v164 offset:10240
    v_mfma_f32_16x16x32_bf16 v[44:47], a[108:111], v[128:131], v[44:47]
    ds_read_b64_tr_b16 v[158:159], v164 offset:11520
    v_mfma_f32_16x16x32_bf16 v[48:51], a[96:99], v[132:135], v[48:51]
    ds_read_b128 v[100:103], v104 offset:448
    v_mfma_f32_16x16x32_bf16 v[52:55], a[100:103], v[132:135], v[52:55]
    v_mov_b32 v189, 0
    buffer_load_dword v189, v189, s[20:23], 0 offen sc1
    v_mfma_f32_16x16x32_bf16 v[56:59], a[104:107], v[132:135], v[56:59]
    s_add_u32 m0, s40, 0x8000
    v_mfma_f32_16x16x32_bf16 v[88:91], v[96:99], a[104:107], v[88:91]
    buffer_load_dwordx4 v176, s[8:11], s38 offen lds
    v_mfma_f32_16x16x32_bf16 v[60:63], a[108:111], v[132:135], v[60:63]
    buffer_load_dwordx4 v177, s[8:11], s38 offen offset:1024 lds
    v_mfma_f32_16x16x32_bf16 v[64:67], a[96:99], v[136:139], v[64:67]
    s_add_u32 m0, s40, 0x8800
    v_mfma_f32_16x16x32_bf16 v[68:71], a[100:103], v[136:139], v[68:71]
    buffer_load_dwordx4 v178, s[8:11], s38 offen lds
    v_mfma_f32_16x16x32_bf16 v[72:75], a[104:107], v[136:139], v[72:75]
    buffer_load_dwordx4 v179, s[8:11], s38 offen offset:1024 lds
    v_mfma_f32_16x16x32_bf16 v[76:79], a[108:111], v[136:139], v[76:79]
    v_mfma_f32_16x16x32_bf16 v[92:95], v[96:99], a[108:111], v[92:95]
    s_waitcnt vmcnt(10)
    s_waitcnt lgkmcnt(0)
    s_barrier
    v_mfma_f32_16x16x32_bf16 v[0:3], a[112:115], v[140:143], v[0:3]
    ds_read_b64_tr_b16 v[120:121], v160 offset:20480
    v_mfma_f32_16x16x32_bf16 v[4:7], a[116:119], v[140:143], v[4:7]
    s_add_u32 m0, s41, 0
    s_lshl_b32 s38, s92, 7
    s_mul_i32 s39, s92, 0x3c000
    s_add_u32 s92, s92, 1
    s_sub_u32 s36, s92, 10
    s_cmp_lt_u32 s92, 10
    s_cselect_b32 s92, s92, s36
    v_mfma_f32_16x16x32_bf16 v[8:11], a[120:123], v[140:143], v[8:11]
    ds_read_b64_tr_b16 v[122:123], v160 offset:21760
    v_mfma_f32_16x16x32_bf16 v[12:15], a[124:127], v[140:143], v[12:15]
    ds_read_b128 a[128:131], v167 offset:16384
    v_mfma_f32_16x16x32_bf16 v[16:19], a[112:115], v[144:147], v[16:19]
    buffer_load_dwordx4 v171, s[12:15], s39 offen offset:0 lds
    v_mfma_f32_16x16x32_bf16 v[80:83], v[100:103], a[112:115], v[80:83]
    ds_read_b128 a[132:135], v167 offset:18432
    v_mfma_f32_16x16x32_bf16 v[20:23], a[116:119], v[144:147], v[20:23]
    ds_read_b128 a[136:139], v168 offset:16384
    v_mfma_f32_16x16x32_bf16 v[24:27], a[120:123], v[144:147], v[24:27]
    buffer_load_dwordx4 v172, s[12:15], s39 offen offset:1024 lds
    v_mfma_f32_16x16x32_bf16 v[28:31], a[124:127], v[144:147], v[28:31]
    ds_read_b128 a[140:143], v168 offset:18432
    v_mfma_f32_16x16x32_bf16 v[32:35], a[112:115], v[148:151], v[32:35]
    ds_read_b64_tr_b16 v[124:125], v161 offset:20480
    v_mfma_f32_16x16x32_bf16 v[36:39], a[116:119], v[148:151], v[36:39]
    buffer_load_dwordx4 v173, s[12:15], s39 offen offset:2048 lds
    v_mfma_f32_16x16x32_bf16 v[84:87], v[100:103], a[116:119], v[84:87]
    v_mfma_f32_16x16x32_bf16 v[40:43], a[120:123], v[148:151], v[40:43]
    ds_read_b64_tr_b16 v[126:127], v161 offset:21760
    v_mfma_f32_16x16x32_bf16 v[44:47], a[124:127], v[148:151], v[44:47]
    ds_read_b64_tr_b16 v[128:129], v162 offset:20480
    v_mfma_f32_16x16x32_bf16 v[48:51], a[112:115], v[152:155], v[48:51]
    buffer_load_dwordx4 v174, s[12:15], s39 offen offset:3072 lds
    v_mfma_f32_16x16x32_bf16 v[52:55], a[116:119], v[152:155], v[52:55]
    ds_read_b64_tr_b16 v[130:131], v162 offset:21760
    v_mfma_f32_16x16x32_bf16 v[56:59], a[120:123], v[152:155], v[56:59]
    ds_read_b64_tr_b16 v[132:133], v163 offset:20480
    v_mfma_f32_16x16x32_bf16 v[88:91], v[100:103], a[120:123], v[88:91]
    s_add_u32 m0, s41, 0x1000
    v_mfma_f32_16x16x32_bf16 v[60:63], a[124:127], v[152:155], v[60:63]
    ds_read_b64_tr_b16 v[134:135], v163 offset:21760
    v_mfma_f32_16x16x32_bf16 v[64:67], a[112:115], v[156:159], v[64:67]
    ds_read_b64_tr_b16 v[136:137], v164 offset:20480
    v_mfma_f32_16x16x32_bf16 v[68:71], a[116:119], v[156:159], v[68:71]
    buffer_load_dwordx4 v175, s[12:15], s39 offen lds
    v_mfma_f32_16x16x32_bf16 v[72:75], a[120:123], v[156:159], v[72:75]
    ds_read_b64_tr_b16 v[138:139], v164 offset:21760
    v_mfma_f32_16x16x32_bf16 v[76:79], a[124:127], v[156:159], v[76:79]
    ds_read_b128 v[96:99], v104 offset:512
    v_mfma_f32_16x16x32_bf16 v[92:95], v[100:103], a[124:127], v[92:95]
    s_waitcnt lgkmcnt(12)
    v_mfma_f32_16x16x32_bf16 v[0:3], a[128:131], v[120:123], v[0:3]
    ds_read_b64_tr_b16 v[140:141], v160 offset:30720
    s_waitcnt lgkmcnt(12)
    v_mfma_f32_16x16x32_bf16 v[4:7], a[132:135], v[120:123], v[4:7]
    s_add_u32 m0, s40, 0
    s_waitcnt lgkmcnt(11)
    v_mfma_f32_16x16x32_bf16 v[8:11], a[136:139], v[120:123], v[8:11]
    ds_read_b64_tr_b16 v[142:143], v160 offset:32000
    s_waitcnt lgkmcnt(11)
    v_mfma_f32_16x16x32_bf16 v[12:15], a[140:143], v[120:123], v[12:15]
    ds_read_b128 a[144:147], v169 offset:16384
    s_waitcnt lgkmcnt(10)
    v_mfma_f32_16x16x32_bf16 v[16:19], a[128:131], v[124:127], v[16:19]
    buffer_load_dwordx4 v176, s[8:11], s38 offen lds
    s_waitcnt lgkmcnt(3)
    v_mfma_f32_16x16x32_bf16 v[80:83], v[96:99], a[128:131], v[80:83]
    ds_read_b128 a[148:151], v169 offset:18432
    v_mfma_f32_16x16x32_bf16 v[20:23], a[132:135], v[124:127], v[20:23]
    ds_read_b128 a[152:155], v170 offset:16384
    v_mfma_f32_16x16x32_bf16 v[24:27], a[136:139], v[124:127], v[24:27]
    buffer_load_dwordx4 v177, s[8:11], s38 offen offset:1024 lds
    v_mfma_f32_16x16x32_bf16 v[28:31], a[140:143], v[124:127], v[28:31]
    ds_read_b128 a[156:159], v170 offset:18432
    v_mfma_f32_16x16x32_bf16 v[32:35], a[128:131], v[128:131], v[32:35]
    ds_read_b64_tr_b16 v[144:145], v161 offset:30720
    v_mfma_f32_16x16x32_bf16 v[36:39], a[132:135], v[128:131], v[36:39]
    s_add_u32 m0, s40, 0x800
    v_mfma_f32_16x16x32_bf16 v[84:87], v[96:99], a[132:135], v[84:87]
    v_mfma_f32_16x16x32_bf16 v[40:43], a[136:139], v[128:131], v[40:43]
    ds_read_b64_tr_b16 v[146:147], v161 offset:32000
    v_mfma_f32_16x16x32_bf16 v[44:47], a[140:143], v[128:131], v[44:47]
    ds_read_b64_tr_b16 v[148:149], v162 offset:30720
    v_mfma_f32_16x16x32_bf16 v[48:51], a[128:131], v[132:135], v[48:51]
    buffer_load_dwordx4 v178, s[8:11], s38 offen lds
    v_mfma_f32_16x16x32_bf16 v[52:55], a[132:135], v[132:135], v[52:55]
    ds_read_b64_tr_b16 v[150:151], v162 offset:32000
    v_mfma_f32_16x16x32_bf16 v[56:59], a[136:139], v[132:135], v[56:59]
    ds_read_b64_tr_b16 v[152:153], v163 offset:30720
    v_mfma_f32_16x16x32_bf16 v[88:91], v[96:99], a[136:139], v[88:91]
    buffer_load_dwordx4 v179, s[8:11], s38 offen offset:1024 lds
    v_mfma_f32_16x16x32_bf16 v[60:63], a[140:143], v[132:135], v[60:63]
    ds_read_b64_tr_b16 v[154:155], v163 offset:32000
    v_mfma_f32_16x16x32_bf16 v[64:67], a[128:131], v[136:139], v[64:67]
    ds_read_b64_tr_b16 v[156:157], v164 offset:30720
    v_mfma_f32_16x16x32_bf16 v[68:71], a[132:135], v[136:139], v[68:71]
    v_mfma_f32_16x16x32_bf16 v[72:75], a[136:139], v[136:139], v[72:75]
    ds_read_b64_tr_b16 v[158:159], v164 offset:32000
    v_mfma_f32_16x16x32_bf16 v[76:79], a[140:143], v[136:139], v[76:79]
    ds_read_b128 v[100:103], v104 offset:576
    v_mfma_f32_16x16x32_bf16 v[92:95], v[96:99], a[140:143], v[92:95]
    s_waitcnt vmcnt(9)
    s_waitcnt lgkmcnt(0)
    s_barrier
    v_mfma_f32_16x16x32_bf16 v[0:3], a[144:147], v[140:143], v[0:3]
    ds_read_b64_tr_b16 v[120:121], v160 offset:40960
    v_mfma_f32_16x16x32_bf16 v[4:7], a[148:151], v[140:143], v[4:7]
    s_add_u32 m0, s41, 0x5000
    s_lshl_b32 s38, s92, 7
    s_mul_i32 s39, s92, 0x3c000
    s_add_u32 s92, s92, 1
    s_sub_u32 s36, s92, 10
    s_cmp_lt_u32 s92, 10
    s_cselect_b32 s92, s92, s36
    v_mfma_f32_16x16x32_bf16 v[8:11], a[152:155], v[140:143], v[8:11]
    ds_read_b64_tr_b16 v[122:123], v160 offset:42240
    v_mfma_f32_16x16x32_bf16 v[12:15], a[156:159], v[140:143], v[12:15]
    buffer_load_dwordx4 v171, s[12:15], s39 offen offset:0 lds
    v_mfma_f32_16x16x32_bf16 v[16:19], a[144:147], v[144:147], v[16:19]
    ds_read_b128 a[160:163], v167 offset:32768
    v_mfma_f32_16x16x32_bf16 v[80:83], v[100:103], a[144:147], v[80:83]
    ds_read_b128 a[164:167], v167 offset:34816
    v_mfma_f32_16x16x32_bf16 v[20:23], a[148:151], v[144:147], v[20:23]
    buffer_load_dwordx4 v172, s[12:15], s39 offen offset:1024 lds
    v_mfma_f32_16x16x32_bf16 v[24:27], a[152:155], v[144:147], v[24:27]
    ds_read_b128 a[168:171], v168 offset:32768
    v_mfma_f32_16x16x32_bf16 v[28:31], a[156:159], v[144:147], v[28:31]
    ds_read_b128 a[172:175], v168 offset:34816
    v_mfma_f32_16x16x32_bf16 v[32:35], a[144:147], v[148:151], v[32:35]
    buffer_load_dwordx4 v173, s[12:15], s39 offen offset:2048 lds
    v_mfma_f32_16x16x32_bf16 v[36:39], a[148:151], v[148:151], v[36:39]
    ds_read_b64_tr_b16 v[124:125], v161 offset:40960
    v_mfma_f32_16x16x32_bf16 v[84:87], v[100:103], a[148:151], v[84:87]
    ds_read_b64_tr_b16 v[126:127], v161 offset:42240
    v_mfma_f32_16x16x32_bf16 v[40:43], a[152:155], v[148:151], v[40:43]
    buffer_load_dwordx4 v174, s[12:15], s39 offen offset:3072 lds
    v_mfma_f32_16x16x32_bf16 v[44:47], a[156:159], v[148:151], v[44:47]
    ds_read_b64_tr_b16 v[128:129], v162 offset:40960
    v_mfma_f32_16x16x32_bf16 v[48:51], a[144:147], v[152:155], v[48:51]
    ds_read_b64_tr_b16 v[130:131], v162 offset:42240
    v_mfma_f32_16x16x32_bf16 v[52:55], a[148:151], v[152:155], v[52:55]
    s_add_u32 m0, s41, 0x6000
    v_mfma_f32_16x16x32_bf16 v[56:59], a[152:155], v[152:155], v[56:59]
    ds_read_b64_tr_b16 v[132:133], v163 offset:40960
    v_mfma_f32_16x16x32_bf16 v[88:91], v[100:103], a[152:155], v[88:91]
    ds_read_b64_tr_b16 v[134:135], v163 offset:42240
    v_mfma_f32_16x16x32_bf16 v[60:63], a[156:159], v[152:155], v[60:63]
    buffer_load_dwordx4 v175, s[12:15], s39 offen lds
    v_mfma_f32_16x16x32_bf16 v[64:67], a[144:147], v[156:159], v[64:67]
    ds_read_b64_tr_b16 v[136:137], v164 offset:40960
    v_mfma_f32_16x16x32_bf16 v[68:71], a[148:151], v[156:159], v[68:71]
    ds_read_b64_tr_b16 v[138:139], v164 offset:42240
    v_mfma_f32_16x16x32_bf16 v[72:75], a[152:155], v[156:159], v[72:75]
    v_readfirstlane_b32 s28, v189
    s_nop 0
    s_cmp_lg_u32 s28, 0
    s_cbranch_scc1 Lnnd_4
    s_mov_b32 s43, 0
Lnn_3:
    v_mov_b32 v189, 0
    buffer_load_dword v189, v189, s[20:23], 0 offen sc1
    s_waitcnt vmcnt(0)
    v_readfirstlane_b32 s28, v189
    s_nop 0
    s_cmp_lg_u32 s28, 0
    s_cbranch_scc1 Lnnd_4
    s_add_u32 s43, s43, 1
    s_cmp_lt_u32 s43, 0x8000
    s_cbranch_scc1 Lnn_3
Lnnd_4:
    s_lshr_b32 s36, s94, 4
    s_lshl_b32 s36, s36, 7
    s_and_b32 s37, s94, 15
    s_lshl_b32 s37, s37, 2
    s_add_u32 s36, s36, s37
    s_add_u32 s36, s36, 0xb00000
    v_mov_b32 v180, s36
    v_mov_b32 v181, s91
    v_cmp_eq_u32 vcc, 0, v191
    s_nop 1
    v_cndmask_b32 v180, v181, v180, vcc
    v_mov_b32 v181, s28
    buffer_store_dword v181, v180, s[16:19], 0 offen sc1
    v_mfma_f32_16x16x32_bf16 v[76:79], a[156:159], v[156:159], v[76:79]
    ds_read_b128 v[96:99], v104 offset:640
    v_mfma_f32_16x16x32_bf16 v[92:95], v[100:103], a[156:159], v[92:95]
    s_waitcnt lgkmcnt(12)
    v_mfma_f32_16x16x32_bf16 v[0:3], a[160:163], v[120:123], v[0:3]
    ds_read_b64_tr_b16 v[140:141], v160 offset:51200
    s_waitcnt lgkmcnt(12)
    v_mfma_f32_16x16x32_bf16 v[4:7], a[164:167], v[120:123], v[4:7]
    s_add_u32 m0, s40, 0x4000
    s_waitcnt lgkmcnt(11)
    v_mfma_f32_16x16x32_bf16 v[8:11], a[168:171], v[120:123], v[8:11]
    ds_read_b64_tr_b16 v[142:143], v160 offset:52480
    s_waitcnt lgkmcnt(11)
    v_mfma_f32_16x16x32_bf16 v[12:15], a[172:175], v[120:123], v[12:15]
    ds_read_b128 a[176:179], v169 offset:32768
    s_waitcnt lgkmcnt(10)
    v_mfma_f32_16x16x32_bf16 v[16:19], a[160:163], v[124:127], v[16:19]
    buffer_load_dwordx4 v176, s[8:11], s38 offen lds
    s_waitcnt lgkmcnt(3)
    v_mfma_f32_16x16x32_bf16 v[80:83], v[96:99], a[160:163], v[80:83]
    ds_read_b128 a[180:183], v169 offset:34816
    v_mfma_f32_16x16x32_bf16 v[20:23], a[164:167], v[124:127], v[20:23]
    ds_read_b128 a[184:187], v170 offset:32768
    v_mfma_f32_16x16x32_bf16 v[24:27], a[168:171], v[124:127], v[24:27]
    buffer_load_dwordx4 v177, s[8:11], s38 offen offset:1024 lds
    v_mfma_f32_16x16x32_bf16 v[28:31], a[172:175], v[124:127], v[28:31]
    ds_read_b128 a[188:191], v170 offset:34816
    v_mfma_f32_16x16x32_bf16 v[32:35], a[160:163], v[128:131], v[32:35]
    ds_read_b64_tr_b16 v[144:145], v161 offset:51200
    v_mfma_f32_16x16x32_bf16 v[36:39], a[164:167], v[128:131], v[36:39]
    s_add_u32 m0, s40, 0x4800
    v_mfma_f32_16x16x32_bf16 v[84:87], v[96:99], a[164:167], v[84:87]
    v_mfma_f32_16x16x32_bf16 v[40:43], a[168:171], v[128:131], v[40:43]
    ds_read_b64_tr_b16 v[146:147], v161 offset:52480
    v_mfma_f32_16x16x32_bf16 v[44:47], a[172:175], v[128:131], v[44:47]
    ds_read_b64_tr_b16 v[148:149], v162 offset:51200
    v_mfma_f32_16x16x32_bf16 v[48:51], a[160:163], v[132:135], v[48:51]
    buffer_load_dwordx4 v178, s[8:11], s38 offen lds
    v_mfma_f32_16x16x32_bf16 v[52:55], a[164:167], v[132:135], v[52:55]
    ds_read_b64_tr_b16 v[150:151], v162 offset:52480
    v_mfma_f32_16x16x32_bf16 v[56:59], a[168:171], v[132:135], v[56:59]
    ds_read_b64_tr_b16 v[152:153], v163 offset:51200
    v_mfma_f32_16x16x32_bf16 v[88:91], v[96:99], a[168:171], v[88:91]
    buffer_load_dwordx4 v179, s[8:11], s38 offen offset:1024 lds
    v_mfma_f32_16x16x32_bf16 v[60:63], a[172:175], v[132:135], v[60:63]
    ds_read_b64_tr_b16 v[154:155], v163 offset:52480
    v_mfma_f32_16x16x32_bf16 v[64:67], a[160:163], v[136:139], v[64:67]
    ds_read_b64_tr_b16 v[156:157], v164 offset:51200
    v_mfma_f32_16x16x32_bf16 v[68:71], a[164:167], v[136:139], v[68:71]
    v_mfma_f32_16x16x32_bf16 v[72:75], a[168:171], v[136:139], v[72:75]
    ds_read_b64_tr_b16 v[158:159], v164 offset:52480
    v_mfma_f32_16x16x32_bf16 v[76:79], a[172:175], v[136:139], v[76:79]
    ds_read_b128 v[100:103], v104 offset:704
    v_mfma_f32_16x16x32_bf16 v[92:95], v[96:99], a[172:175], v[92:95]
    s_waitcnt vmcnt(10)
    s_waitcnt lgkmcnt(0)
    s_barrier
    v_mfma_f32_16x16x32_bf16 v[0:3], a[176:179], v[140:143], v[0:3]
    ds_read_b64_tr_b16 v[120:121], v160 offset:0
    v_mfma_f32_16x16x32_bf16 v[4:7], a[180:183], v[140:143], v[4:7]
    s_add_u32 m0, s41, 0xa000
    s_lshl_b32 s38, s92, 7
    s_mul_i32 s39, s92, 0x3c000
    s_add_u32 s92, s92, 1
    s_sub_u32 s36, s92, 10
    s_cmp_lt_u32 s92, 10
    s_cselect_b32 s92, s92, s36
    v_mfma_f32_16x16x32_bf16 v[8:11], a[184:187], v[140:143], v[8:11]
    ds_read_b64_tr_b16 v[122:123], v160 offset:1280
    v_mfma_f32_16x16x32_bf16 v[12:15], a[188:191], v[140:143], v[12:15]
    ds_read_b128 a[192:195], v167 offset:0
    v_mfma_f32_16x16x32_bf16 v[16:19], a[176:179], v[144:147], v[16:19]
    buffer_load_dwordx4 v171, s[12:15], s39 offen offset:0 lds
    v_mfma_f32_16x16x32_bf16 v[80:83], v[100:103], a[176:179], v[80:83]
    ds_read_b128 a[196:199], v167 offset:2048
    v_mfma_f32_16x16x32_bf16 v[20:23], a[180:183], v[144:147], v[20:23]
    ds_read_b128 a[200:203], v168 offset:0
    v_mfma_f32_16x16x32_bf16 v[24:27], a[184:187], v[144:147], v[24:27]
    buffer_load_dwordx4 v172, s[12:15], s39 offen offset:1024 lds
    v_mfma_f32_16x16x32_bf16 v[28:31], a[188:191], v[144:147], v[28:31]
    ds_read_b128 a[204:207], v168 offset:2048
    v_mfma_f32_16x16x32_bf16 v[32:35], a[176:179], v[148:151], v[32:35]
    ds_read_b64_tr_b16 v[124:125], v161 offset:0
    v_mfma_f32_16x16x32_bf16 v[36:39], a[180:183], v[148:151], v[36:39]
    buffer_load_dwordx4 v173, s[12:15], s39 offen offset:2048 lds
    v_mfma_f32_16x16x32_bf16 v[84:87], v[100:103], a[180:183], v[84:87]
    v_mfma_f32_16x16x32_bf16 v[40:43], a[184:187], v[148:151], v[40:43]
    ds_read_b64_tr_b16 v[126:127], v161 offset:1280
    v_mfma_f32_16x16x32_bf16 v[44:47], a[188:191], v[148:151], v[44:47]
    ds_read_b64_tr_b16 v[128:129], v162 offset:0
    v_mfma_f32_16x16x32_bf16 v[48:51], a[176:179], v[152:155], v[48:51]
    buffer_load_dwordx4 v174, s[12:15], s39 offen offset:3072 lds
    v_mfma_f32_16x16x32_bf16 v[52:55], a[180:183], v[152:155], v[52:55]
    ds_read_b64_tr_b16 v[130:131], v162 offset:1280
    v_mfma_f32_16x16x32_bf16 v[56:59], a[184:187], v[152:155], v[56:59]
    ds_read_b64_tr_b16 v[132:133], v163 offset:0
    v_mfma_f32_16x16x32_bf16 v[88:91], v[100:103], a[184:187], v[88:91]
    s_add_u32 m0, s41, 0xb000
    v_mfma_f32_16x16x32_bf16 v[60:63], a[188:191], v[152:155], v[60:63]
    ds_read_b64_tr_b16 v[134:135], v163 offset:1280
    v_mfma_f32_16x16x32_bf16 v[64:67], a[176:179], v[156:159], v[64:67]
    ds_read_b64_tr_b16 v[136:137], v164 offset:0
    v_mfma_f32_16x16x32_bf16 v[68:71], a[180:183], v[156:159], v[68:71]
    buffer_load_dwordx4 v175, s[12:15], s39 offen lds
    v_mfma_f32_16x16x32_bf16 v[72:75], a[184:187], v[156:159], v[72:75]
    ds_read_b64_tr_b16 v[138:139], v164 offset:1280
    v_mfma_f32_16x16x32_bf16 v[76:79], a[188:191], v[156:159], v[76:79]
    ds_read_b128 v[96:99], v104 offset:768
    v_mfma_f32_16x16x32_bf16 v[92:95], v[100:103], a[188:191], v[92:95]
    s_waitcnt lgkmcnt(12)
    v_mfma_f32_16x16x32_bf16 v[0:3], a[192:195], v[120:123], v[0:3]
    ds_read_b64_tr_b16 v[140:141], v160 offset:10240
    s_waitcnt lgkmcnt(12)
    v_mfma_f32_16x16x32_bf16 v[4:7], a[196:199], v[120:123], v[4:7]
    s_add_u32 m0, s40, 0x8000
    s_waitcnt lgkmcnt(11)
    v_mfma_f32_16x16x32_bf16 v[8:11], a[200:203], v[120:123], v[8:11]
    ds_read_b64_tr_b16 v[142:143], v160 offset:11520
    s_waitcnt lgkmcnt(11)
    v_mfma_f32_16x16x32_bf16 v[12:15], a[204:207], v[120:123], v[12:15]
    ds_read_b128 a[208:211], v169 offset:0
    s_waitcnt lgkmcnt(10)
    v_mfma_f32_16x16x32_bf16 v[16:19], a[192:195], v[124:127], v[16:19]
    buffer_load_dwordx4 v176, s[8:11], s38 offen lds
    s_waitcnt lgkmcnt(3)
    v_mfma_f32_16x16x32_bf16 v[80:83], v[96:99], a[192:195], v[80:83]
    ds_read_b128 a[212:215], v169 offset:2048
    v_mfma_f32_16x16x32_bf16 v[20:23], a[196:199], v[124:127], v[20:23]
    ds_read_b128 a[216:219], v170 offset:0
    v_mfma_f32_16x16x32_bf16 v[24:27], a[200:203], v[124:127], v[24:27]
    buffer_load_dwordx4 v177, s[8:11], s38 offen offset:1024 lds
    v_mfma_f32_16x16x32_bf16 v[28:31], a[204:207], v[124:127], v[28:31]
    ds_read_b128 a[220:223], v170 offset:2048
    v_mfma_f32_16x16x32_bf16 v[32:35], a[192:195], v[128:131], v[32:35]
    ds_read_b64_tr_b16 v[144:145], v161 offset:10240
    v_mfma_f32_16x16x32_bf16 v[36:39], a[196:199], v[128:131], v[36:39]
    s_add_u32 m0, s40, 0x8800
    v_mfma_f32_16x16x32_bf16 v[84:87], v[96:99], a[196:199], v[84:87]
    v_mfma_f32_16x16x32_bf16 v[40:43], a[200:203], v[128:131], v[40:43]
    ds_read_b64_tr_b16 v[146:147], v161 offset:11520
    v_mfma_f32_16x16x32_bf16 v[44:47], a[204:207], v[128:131], v[44:47]
    ds_read_b64_tr_b16 v[148:149], v162 offset:10240
    v_mfma_f32_16x16x32_bf16 v[48:51], a[192:195], v[132:135], v[48:51]
    buffer_load_dwordx4 v178, s[8:11], s38 offen lds
    v_mfma_f32_16x16x32_bf16 v[52:55], a[196:199], v[132:135], v[52:55]
    ds_read_b64_tr_b16 v[150:151], v162 offset:11520
    v_mfma_f32_16x16x32_bf16 v[56:59], a[200:203], v[132:135], v[56:59]
    ds_read_b64_tr_b16 v[152:153], v163 offset:10240
    v_mfma_f32_16x16x32_bf16 v[88:91], v[96:99], a[200:203], v[88:91]
    buffer_load_dwordx4 v179, s[8:11], s38 offen offset:1024 lds
    v_mfma_f32_16x16x32_bf16 v[60:63], a[204:207], v[132:135], v[60:63]
    ds_read_b64_tr_b16 v[154:155], v163 offset:11520
    v_mfma_f32_16x16x32_bf16 v[64:67], a[192:195], v[136:139], v[64:67]
    ds_read_b64_tr_b16 v[156:157], v164 offset:10240
    v_mfma_f32_16x16x32_bf16 v[68:71], a[196:199], v[136:139], v[68:71]
    v_mfma_f32_16x16x32_bf16 v[72:75], a[200:203], v[136:139], v[72:75]
    ds_read_b64_tr_b16 v[158:159], v164 offset:11520
    v_mfma_f32_16x16x32_bf16 v[76:79], a[204:207], v[136:139], v[76:79]
    ds_read_b128 v[100:103], v104 offset:832
    v_mfma_f32_16x16x32_bf16 v[92:95], v[96:99], a[204:207], v[92:95]
    s_waitcnt vmcnt(9)
    s_waitcnt lgkmcnt(0)
    s_barrier
    v_mfma_f32_16x16x32_bf16 v[0:3], a[208:211], v[140:143], v[0:3]
    ds_read_b64_tr_b16 v[120:121], v160 offset:20480
    v_mfma_f32_16x16x32_bf16 v[4:7], a[212:215], v[140:143], v[4:7]
    s_add_u32 m0, s41, 0
    s_lshl_b32 s38, s92, 7
    s_mul_i32 s39, s92, 0x3c000
    s_add_u32 s92, s92, 1
    s_sub_u32 s36, s92, 10
    s_cmp_lt_u32 s92, 10
    s_cselect_b32 s92, s92, s36
    v_mfma_f32_16x16x32_bf16 v[8:11], a[216:219], v[140:143], v[8:11]
    ds_read_b64_tr_b16 v[122:123], v160 offset:21760
    v_mfma_f32_16x16x32_bf16 v[12:15], a[220:223], v[140:143], v[12:15]
    ds_read_b128 a[224:227], v167 offset:16384
    v_mfma_f32_16x16x32_bf16 v[16:19], a[208:211], v[144:147], v[16:19]
    buffer_load_dwordx4 v171, s[12:15], s39 offen offset:0 lds
    v_mfma_f32_16x16x32_bf16 v[80:83], v[100:103], a[208:211], v[80:83]
    ds_read_b128 a[228:231], v167 offset:18432
    v_mfma_f32_16x16x32_bf16 v[20:23], a[212:215], v[144:147], v[20:23]
    ds_read_b128 a[232:235], v168 offset:16384
    v_mfma_f32_16x16x32_bf16 v[24:27], a[216:219], v[144:147], v[24:27]
    buffer_load_dwordx4 v172, s[12:15], s39 offen offset:1024 lds
    v_mfma_f32_16x16x32_bf16 v[28:31], a[220:223], v[144:147], v[28:31]
    ds_read_b128 a[236:239], v168 offset:18432
    v_mfma_f32_16x16x32_bf16 v[32:35], a[208:211], v[148:151], v[32:35]
    ds_read_b64_tr_b16 v[124:125], v161 offset:20480
    v_mfma_f32_16x16x32_bf16 v[36:39], a[212:215], v[148:151], v[36:39]
    buffer_load_dwordx4 v173, s[12:15], s39 offen offset:2048 lds
    v_mfma_f32_16x16x32_bf16 v[84:87], v[100:103], a[212:215], v[84:87]
    v_mfma_f32_16x16x32_bf16 v[40:43], a[216:219], v[148:151], v[40:43]
    ds_read_b64_tr_b16 v[126:127], v161 offset:21760
    v_mfma_f32_16x16x32_bf16 v[44:47], a[220:223], v[148:151], v[44:47]
    ds_read_b64_tr_b16 v[128:129], v162 offset:20480
    v_mfma_f32_16x16x32_bf16 v[48:51], a[208:211], v[152:155], v[48:51]
    buffer_load_dwordx4 v174, s[12:15], s39 offen offset:3072 lds
    v_mfma_f32_16x16x32_bf16 v[52:55], a[212:215], v[152:155], v[52:55]
    ds_read_b64_tr_b16 v[130:131], v162 offset:21760
    v_mfma_f32_16x16x32_bf16 v[56:59], a[216:219], v[152:155], v[56:59]
    ds_read_b64_tr_b16 v[132:133], v163 offset:20480
    v_mfma_f32_16x16x32_bf16 v[88:91], v[100:103], a[216:219], v[88:91]
    s_add_u32 m0, s41, 0x1000
    v_mfma_f32_16x16x32_bf16 v[60:63], a[220:223], v[152:155], v[60:63]
    ds_read_b64_tr_b16 v[134:135], v163 offset:21760
    v_mfma_f32_16x16x32_bf16 v[64:67], a[208:211], v[156:159], v[64:67]
    ds_read_b64_tr_b16 v[136:137], v164 offset:20480
    v_mfma_f32_16x16x32_bf16 v[68:71], a[212:215], v[156:159], v[68:71]
    buffer_load_dwordx4 v175, s[12:15], s39 offen lds
    v_mfma_f32_16x16x32_bf16 v[72:75], a[216:219], v[156:159], v[72:75]
    ds_read_b64_tr_b16 v[138:139], v164 offset:21760
    v_mfma_f32_16x16x32_bf16 v[76:79], a[220:223], v[156:159], v[76:79]
    ds_read_b128 v[96:99], v104 offset:896
    v_mfma_f32_16x16x32_bf16 v[92:95], v[100:103], a[220:223], v[92:95]
    s_waitcnt lgkmcnt(12)
    v_mfma_f32_16x16x32_bf16 v[0:3], a[224:227], v[120:123], v[0:3]
    ds_read_b64_tr_b16 v[140:141], v160 offset:30720
    s_waitcnt lgkmcnt(12)
    v_mfma_f32_16x16x32_bf16 v[4:7], a[228:231], v[120:123], v[4:7]
    s_add_u32 m0, s40, 0
    s_waitcnt lgkmcnt(11)
    v_mfma_f32_16x16x32_bf16 v[8:11], a[232:235], v[120:123], v[8:11]
    ds_read_b64_tr_b16 v[142:143], v160 offset:32000
    s_waitcnt lgkmcnt(11)
    v_mfma_f32_16x16x32_bf16 v[12:15], a[236:239], v[120:123], v[12:15]
    ds_read_b128 a[240:243], v169 offset:16384
    s_waitcnt lgkmcnt(10)
    v_mfma_f32_16x16x32_bf16 v[16:19], a[224:227], v[124:127], v[16:19]
    buffer_load_dwordx4 v176, s[8:11], s38 offen lds
    s_waitcnt lgkmcnt(3)
    v_mfma_f32_16x16x32_bf16 v[80:83], v[96:99], a[224:227], v[80:83]
    ds_read_b128 a[244:247], v169 offset:18432
    v_mfma_f32_16x16x32_bf16 v[20:23], a[228:231], v[124:127], v[20:23]
    ds_read_b128 a[248:251], v170 offset:16384
    v_mfma_f32_16x16x32_bf16 v[24:27], a[232:235], v[124:127], v[24:27]
    buffer_load_dwordx4 v177, s[8:11], s38 offen offset:1024 lds
    v_mfma_f32_16x16x32_bf16 v[28:31], a[236:239], v[124:127], v[28:31]
    ds_read_b128 a[252:255], v170 offset:18432
    v_mfma_f32_16x16x32_bf16 v[32:35], a[224:227], v[128:131], v[32:35]
    ds_read_b64_tr_b16 v[144:145], v161 offset:30720
    v_mfma_f32_16x16x32_bf16 v[36:39], a[228:231], v[128:131], v[36:39]
    s_add_u32 m0, s40, 0x800
    v_mfma_f32_16x16x32_bf16 v[84:87], v[96:99], a[228:231], v[84:87]
    v_mfma_f32_16x16x32_bf16 v[40:43], a[232:235], v[128:131], v[40:43]
    ds_read_b64_tr_b16 v[146:147], v161 offset:32000
    v_mfma_f32_16x16x32_bf16 v[44:47], a[236:239], v[128:131], v[44:47]
    ds_read_b64_tr_b16 v[148:149], v162 offset:30720
    v_mfma_f32_16x16x32_bf16 v[48:51], a[224:227], v[132:135], v[48:51]
    buffer_load_dwordx4 v178, s[8:11], s38 offen lds
    v_mfma_f32_16x16x32_bf16 v[52:55], a[228:231], v[132:135], v[52:55]
    ds_read_b64_tr_b16 v[150:151], v162 offset:32000
    v_mfma_f32_16x16x32_bf16 v[56:59], a[232:235], v[132:135], v[56:59]
    ds_read_b64_tr_b16 v[152:153], v163 offset:30720
    v_mfma_f32_16x16x32_bf16 v[88:91], v[96:99], a[232:235], v[88:91]
    buffer_load_dwordx4 v179, s[8:11], s38 offen offset:1024 lds
    v_mfma_f32_16x16x32_bf16 v[60:63], a[236:239], v[132:135], v[60:63]
    ds_read_b64_tr_b16 v[154:155], v163 offset:32000
    v_mfma_f32_16x16x32_bf16 v[64:67], a[224:227], v[136:139], v[64:67]
    ds_read_b64_tr_b16 v[156:157], v164 offset:30720
    v_mfma_f32_16x16x32_bf16 v[68:71], a[228:231], v[136:139], v[68:71]
    v_mfma_f32_16x16x32_bf16 v[72:75], a[232:235], v[136:139], v[72:75]
    ds_read_b64_tr_b16 v[158:159], v164 offset:32000
    v_mfma_f32_16x16x32_bf16 v[76:79], a[236:239], v[136:139], v[76:79]
    ds_read_b128 v[100:103], v104 offset:960
    v_mfma_f32_16x16x32_bf16 v[92:95], v[96:99], a[236:239], v[92:95]
    s_waitcnt vmcnt(9)
    s_waitcnt lgkmcnt(0)
    s_barrier
    v_mfma_f32_16x16x32_bf16 v[0:3], a[240:243], v[140:143], v[0:3]
    ds_read_b64_tr_b16 v[120:121], v160 offset:40960
    v_subrev_u32 v180, 0x500, v171
    v_add_u32 v181, 0x3b600, v171
    v_cndmask_b32 v171, v180, v181, s[44:45]
    v_mfma_f32_16x16x32_bf16 v[4:7], a[244:247], v[140:143], v[4:7]
    ds_read_b64_tr_b16 v[122:123], v160 offset:42240
    v_mfma_f32_16x16x32_bf16 v[8:11], a[248:251], v[140:143], v[8:11]
    v_subrev_u32 v180, 0x500, v172
    v_add_u32 v181, 0x3b600, v172
    v_cndmask_b32 v172, v180, v181, s[46:47]
    v_mfma_f32_16x16x32_bf16 v[12:15], a[252:255], v[140:143], v[12:15]
    ds_read_b128 v[192:195], v167 offset:32768
    v_mfma_f32_16x16x32_bf16 v[16:19], a[240:243], v[144:147], v[16:19]
    v_subrev_u32 v180, 0x500, v173
    v_add_u32 v181, 0x3b600, v173
    v_cndmask_b32 v173, v180, v181, s[48:49]
    v_mfma_f32_16x16x32_bf16 v[80:83], v[100:103], a[240:243], v[80:83]
    ds_read_b128 v[196:199], v167 offset:34816
    v_mfma_f32_16x16x32_bf16 v[20:23], a[244:247], v[144:147], v[20:23]
    v_subrev_u32 v180, 0x500, v174
    v_add_u32 v181, 0x3b600, v174
    v_cndmask_b32 v174, v180, v181, s[50:51]
    v_mfma_f32_16x16x32_bf16 v[24:27], a[248:251], v[144:147], v[24:27]
    ds_read_b128 v[200:203], v168 offset:32768
    v_mfma_f32_16x16x32_bf16 v[28:31], a[252:255], v[144:147], v[28:31]
    ds_read_b128 v[204:207], v168 offset:34816
    v_subrev_u32 v180, 0x500, v175
    v_add_u32 v181, 0x3b600, v175
    v_cndmask_b32 v175, v180, v181, s[52:53]
    v_mfma_f32_16x16x32_bf16 v[32:35], a[240:243], v[148:151], v[32:35]
    ds_read_b64_tr_b16 v[124:125], v161 offset:40960
    v_mfma_f32_16x16x32_bf16 v[36:39], a[244:247], v[148:151], v[36:39]
    s_add_u32 m0, s41, 0x5000
    s_mul_i32 s39, s92, 0x3c000
    s_cmp_eq_u32 s92, 9
    s_cselect_b32 s39, 0, s39
    s_cselect_b32 s93, 0x21c000, 0
    s_cselect_b32 s95, 0xfffc4000, 0
    s_add_u32 s92, s92, 2
    s_sub_u32 s36, s92, 10
    s_cmp_lt_u32 s92, 10
    s_cselect_b32 s92, s92, s36
    v_mfma_f32_16x16x32_bf16 v[84:87], v[100:103], a[244:247], v[84:87]
    ds_read_b64_tr_b16 v[126:127], v161 offset:42240
    v_mfma_f32_16x16x32_bf16 v[40:43], a[248:251], v[148:151], v[40:43]
    v_add_u32 v180, s93, v171
    v_add_u32 v181, s95, v171
    v_cmp_le_u32 vcc, 0x3b920, v171
    s_nop 1
    v_cndmask_b32 v180, v180, v181, vcc
    buffer_load_dwordx4 v180, s[12:15], s39 offen offset:0 lds
    v_mfma_f32_16x16x32_bf16 v[44:47], a[252:255], v[148:151], v[44:47]
    ds_read_b64_tr_b16 v[128:129], v162 offset:40960
    v_mfma_f32_16x16x32_bf16 v[48:51], a[240:243], v[152:155], v[48:51]
    v_add_u32 v180, s93, v172
    v_add_u32 v181, s95, v172
    v_cmp_le_u32 vcc, 0x3b920, v172
    s_nop 1
    v_cndmask_b32 v180, v180, v181, vcc
    buffer_load_dwordx4 v180, s[12:15], s39 offen offset:1024 lds
    v_mfma_f32_16x16x32_bf16 v[52:55], a[244:247], v[152:155], v[52:55]
    ds_read_b64_tr_b16 v[130:131], v162 offset:42240
    v_mfma_f32_16x16x32_bf16 v[56:59], a[248:251], v[152:155], v[56:59]
    ds_read_b64_tr_b16 v[132:133], v163 offset:40960
    v_add_u32 v180, s93, v173
    v_add_u32 v181, s95, v173
    v_cmp_le_u32 vcc, 0x3b920, v173
    s_nop 1
    v_cndmask_b32 v180, v180, v181, vcc
    buffer_load_dwordx4 v180, s[12:15], s39 offen offset:2048 lds
    v_mfma_f32_16x16x32_bf16 v[88:91], v[100:103], a[248:251], v[88:91]
    ds_read_b64_tr_b16 v[134:135], v163 offset:42240
    v_mfma_f32_16x16x32_bf16 v[60:63], a[252:255], v[152:155], v[60:63]
    v_add_u32 v180, s93, v174
    v_add_u32 v181, s95, v174
    v_cmp_le_u32 vcc, 0x3b920, v174
    s_nop 1
    v_cndmask_b32 v180, v180, v181, vcc
    buffer_load_dwordx4 v180, s[12:15], s39 offen offset:3072 lds
    v_mfma_f32_16x16x32_bf16 v[64:67], a[240:243], v[156:159], v[64:67]
    ds_read_b64_tr_b16 v[136:137], v164 offset:40960
    v_mfma_f32_16x16x32_bf16 v[68:71], a[244:247], v[156:159], v[68:71]
    v_add_u32 v180, s93, v175
    v_add_u32 v181, s95, v175
    v_cmp_le_u32 vcc, 0x3b920, v175
    s_nop 1
    v_cndmask_b32 v180, v180, v181, vcc
    s_add_u32 m0, s41, 0x6000
    s_nop 0
    buffer_load_dwordx4 v180, s[12:15], s39 offen lds
    v_mfma_f32_16x16x32_bf16 v[72:75], a[248:251], v[156:159], v[72:75]
    ds_read_b64_tr_b16 v[138:139], v164 offset:42240
    v_mfma_f32_16x16x32_bf16 v[76:79], a[252:255], v[156:159], v[76:79]
    v_mfma_f32_16x16x32_bf16 v[92:95], v[100:103], a[252:255], v[92:95]
    ds_read_b128 v[96:99], v104 offset:1024
    s_waitcnt lgkmcnt(12)
    v_mfma_f32_16x16x32_bf16 v[0:3], v[192:195], v[120:123], v[0:3]
    ds_read_b64_tr_b16 v[140:141], v160 offset:51200
    s_waitcnt lgkmcnt(12)
    v_mfma_f32_16x16x32_bf16 v[4:7], v[196:199], v[120:123], v[4:7]
    ds_read_b64_tr_b16 v[142:143], v160 offset:52480
    s_waitcnt lgkmcnt(12)
    v_mfma_f32_16x16x32_bf16 v[8:11], v[200:203], v[120:123], v[8:11]
    s_waitcnt lgkmcnt(11)
    v_mfma_f32_16x16x32_bf16 v[12:15], v[204:207], v[120:123], v[12:15]
    ds_read_b128 v[208:211], v169 offset:32768
    s_waitcnt lgkmcnt(10)
    v_mfma_f32_16x16x32_bf16 v[16:19], v[192:195], v[124:127], v[16:19]
    ds_read_b128 v[212:215], v169 offset:34816
    s_waitcnt lgkmcnt(4)
    v_mfma_f32_16x16x32_bf16 v[80:83], v[96:99], v[192:195], v[80:83]
    v_mfma_f32_16x16x32_bf16 v[20:23], v[196:199], v[124:127], v[20:23]
    ds_read_b128 v[216:219], v170 offset:32768
    v_mfma_f32_16x16x32_bf16 v[24:27], v[200:203], v[124:127], v[24:27]
    v_mfma_f32_16x16x32_bf16 v[28:31], v[204:207], v[124:127], v[28:31]
    ds_read_b128 v[220:223], v170 offset:34816
    v_mfma_f32_16x16x32_bf16 v[32:35], v[192:195], v[128:131], v[32:35]
    ds_read_b64_tr_b16 v[144:145], v161 offset:51200
    v_mfma_f32_16x16x32_bf16 v[36:39], v[196:199], v[128:131], v[36:39]
    v_mfma_f32_16x16x32_bf16 v[84:87], v[96:99], v[196:199], v[84:87]
    ds_read_b64_tr_b16 v[146:147], v161 offset:52480
    v_mfma_f32_16x16x32_bf16 v[40:43], v[200:203], v[128:131], v[40:43]
    ds_read_b64_tr_b16 v[148:149], v162 offset:51200
    v_mfma_f32_16x16x32_bf16 v[44:47], v[204:207], v[128:131], v[44:47]
    v_mfma_f32_16x16x32_bf16 v[48:51], v[192:195], v[132:135], v[48:51]
    ds_read_b64_tr_b16 v[150:151], v162 offset:52480
    v_mfma_f32_16x16x32_bf16 v[52:55], v[196:199], v[132:135], v[52:55]
    v_mfma_f32_16x16x32_bf16 v[56:59], v[200:203], v[132:135], v[56:59]
    ds_read_b64_tr_b16 v[152:153], v163 offset:51200
    v_mfma_f32_16x16x32_bf16 v[88:91], v[96:99], v[200:203], v[88:91]
    ds_read_b64_tr_b16 v[154:155], v163 offset:52480
    v_mfma_f32_16x16x32_bf16 v[60:63], v[204:207], v[132:135], v[60:63]
    v_mfma_f32_16x16x32_bf16 v[64:67], v[192:195], v[136:139], v[64:67]
    ds_read_b64_tr_b16 v[156:157], v164 offset:51200
    v_mfma_f32_16x16x32_bf16 v[68:71], v[196:199], v[136:139], v[68:71]
    ds_read_b64_tr_b16 v[158:159], v164 offset:52480
    v_mfma_f32_16x16x32_bf16 v[72:75], v[200:203], v[136:139], v[72:75]
    v_mfma_f32_16x16x32_bf16 v[76:79], v[204:207], v[136:139], v[76:79]
    ds_read_b128 v[100:103], v104 offset:1088
    v_mfma_f32_16x16x32_bf16 v[92:95], v[96:99], v[204:207], v[92:95]
    s_waitcnt vmcnt(5)
    s_waitcnt lgkmcnt(0)
    s_barrier
    v_mfma_f32_16x16x32_bf16 v[0:3], v[208:211], v[140:143], v[0:3]
    ds_read_b64_tr_b16 v[120:121], v160 offset:0
    v_mfma_f32_16x16x32_bf16 v[4:7], v[212:215], v[140:143], v[4:7]
    s_add_u32 m0, s41, 0xa000
    s_mul_i32 s39, s92, 0x3c000
    s_cmp_eq_u32 s92, 9
    s_cselect_b32 s39, 0, s39
    s_cselect_b32 s93, 0x21c000, 0
    s_cselect_b32 s95, 0xfffc4000, 0
    s_add_u32 s92, s92, 2
    s_sub_u32 s36, s92, 10
    s_cmp_lt_u32 s92, 10
    s_cselect_b32 s92, s92, s36
    v_mfma_f32_16x16x32_bf16 v[8:11], v[216:219], v[140:143], v[8:11]
    ds_read_b64_tr_b16 v[122:123], v160 offset:1280
    v_mfma_f32_16x16x32_bf16 v[12:15], v[220:223], v[140:143], v[12:15]
    ds_read_b128 v[224:227], v167 offset:0
    v_mfma_f32_16x16x32_bf16 v[16:19], v[208:211], v[144:147], v[16:19]
    v_add_u32 v180, s93, v171
    v_add_u32 v181, s95, v171
    v_cmp_le_u32 vcc, 0x3b920, v171
    s_nop 1
    v_cndmask_b32 v180, v180, v181, vcc
    buffer_load_dwordx4 v180, s[12:15], s39 offen offset:0 lds
    v_mfma_f32_16x16x32_bf16 v[80:83], v[100:103], v[208:211], v[80:83]
    ds_read_b128 v[228:231], v167 offset:2048
    v_mfma_f32_16x16x32_bf16 v[20:23], v[212:215], v[144:147], v[20:23]
    ds_read_b128 v[232:235], v168 offset:0
    v_mfma_f32_16x16x32_bf16 v[24:27], v[216:219], v[144:147], v[24:27]
    v_add_u32 v180, s93, v172
    v_add_u32 v181, s95, v172
    v_cmp_le_u32 vcc, 0x3b920, v172
    s_nop 1
    v_cndmask_b32 v180, v180, v181, vcc
    buffer_load_dwordx4 v180, s[12:15], s39 offen offset:1024 lds
    v_mfma_f32_16x16x32_bf16 v[28:31], v[220:223], v[144:147], v[28:31]
    ds_read_b128 v[236:239], v168 offset:2048
    v_mfma_f32_16x16x32_bf16 v[32:35], v[208:211], v[148:151], v[32:35]
    ds_read_b64_tr_b16 v[124:125], v161 offset:0
    v_mfma_f32_16x16x32_bf16 v[36:39], v[212:215], v[148:151], v[36:39]
    v_add_u32 v180, s93, v173
    v_add_u32 v181, s95, v173
    v_cmp_le_u32 vcc, 0x3b920, v173
    s_nop 1
    v_cndmask_b32 v180, v180, v181, vcc
    buffer_load_dwordx4 v180, s[12:15], s39 offen offset:2048 lds
    v_mfma_f32_16x16x32_bf16 v[84:87], v[100:103], v[212:215], v[84:87]
    v_mfma_f32_16x16x32_bf16 v[40:43], v[216:219], v[148:151], v[40:43]
    ds_read_b64_tr_b16 v[126:127], v161 offset:1280
    v_mfma_f32_16x16x32_bf16 v[44:47], v[220:223], v[148:151], v[44:47]
    ds_read_b64_tr_b16 v[128:129], v162 offset:0
    v_mfma_f32_16x16x32_bf16 v[48:51], v[208:211], v[152:155], v[48:51]
    v_add_u32 v180, s93, v174
    v_add_u32 v181, s95, v174
    v_cmp_le_u32 vcc, 0x3b920, v174
    s_nop 1
    v_cndmask_b32 v180, v180, v181, vcc
    buffer_load_dwordx4 v180, s[12:15], s39 offen offset:3072 lds
    v_mfma_f32_16x16x32_bf16 v[52:55], v[212:215], v[152:155], v[52:55]
    ds_read_b64_tr_b16 v[130:131], v162 offset:1280
    v_mfma_f32_16x16x32_bf16 v[56:59], v[216:219], v[152:155], v[56:59]
    ds_read_b64_tr_b16 v[132:133], v163 offset:0
    v_mfma_f32_16x16x32_bf16 v[88:91], v[100:103], v[216:219], v[88:91]
    v_add_u32 v180, s93, v175
    v_add_u32 v181, s95, v175
    v_cmp_le_u32 vcc, 0x3b920, v175
    s_nop 1
    v_cndmask_b32 v180, v180, v181, vcc
    s_add_u32 m0, s41, 0xb000
    s_nop 0
    buffer_load_dwordx4 v180, s[12:15], s39 offen lds
    v_mfma_f32_16x16x32_bf16 v[60:63], v[220:223], v[152:155], v[60:63]
    ds_read_b64_tr_b16 v[134:135], v163 offset:1280
    v_mfma_f32_16x16x32_bf16 v[64:67], v[208:211], v[156:159], v[64:67]
    ds_read_b64_tr_b16 v[136:137], v164 offset:0
    v_mfma_f32_16x16x32_bf16 v[68:71], v[212:215], v[156:159], v[68:71]
    v_mfma_f32_16x16x32_bf16 v[72:75], v[216:219], v[156:159], v[72:75]
    ds_read_b64_tr_b16 v[138:139], v164 offset:1280
    v_mfma_f32_16x16x32_bf16 v[76:79], v[220:223], v[156:159], v[76:79]
    ds_read_b128 v[96:99], v104 offset:1152
    v_mfma_f32_16x16x32_bf16 v[92:95], v[100:103], v[220:223], v[92:95]
    s_waitcnt lgkmcnt(12)
    v_mfma_f32_16x16x32_bf16 v[0:3], v[224:227], v[120:123], v[0:3]
    ds_read_b64_tr_b16 v[140:141], v160 offset:10240
    s_waitcnt lgkmcnt(12)
    v_mfma_f32_16x16x32_bf16 v[4:7], v[228:231], v[120:123], v[4:7]
    ds_read_b64_tr_b16 v[142:143], v160 offset:11520
    s_waitcnt lgkmcnt(12)
    v_mfma_f32_16x16x32_bf16 v[8:11], v[232:235], v[120:123], v[8:11]
    s_waitcnt lgkmcnt(11)
    v_mfma_f32_16x16x32_bf16 v[12:15], v[236:239], v[120:123], v[12:15]
    ds_read_b128 v[240:243], v169 offset:0
    s_waitcnt lgkmcnt(10)
    v_mfma_f32_16x16x32_bf16 v[16:19], v[224:227], v[124:127], v[16:19]
    ds_read_b128 v[244:247], v169 offset:2048
    s_waitcnt lgkmcnt(4)
    v_mfma_f32_16x16x32_bf16 v[80:83], v[96:99], v[224:227], v[80:83]
    v_mfma_f32_16x16x32_bf16 v[20:23], v[228:231], v[124:127], v[20:23]
    ds_read_b128 v[248:251], v170 offset:0
    v_mfma_f32_16x16x32_bf16 v[24:27], v[232:235], v[124:127], v[24:27]
    v_mfma_f32_16x16x32_bf16 v[28:31], v[236:239], v[124:127], v[28:31]
    ds_read_b128 v[252:255], v170 offset:2048
    v_mfma_f32_16x16x32_bf16 v[32:35], v[224:227], v[128:131], v[32:35]
    ds_read_b64_tr_b16 v[144:145], v161 offset:10240
    v_mfma_f32_16x16x32_bf16 v[36:39], v[228:231], v[128:131], v[36:39]
    v_mfma_f32_16x16x32_bf16 v[84:87], v[96:99], v[228:231], v[84:87]
    ds_read_b64_tr_b16 v[146:147], v161 offset:11520
    v_mfma_f32_16x16x32_bf16 v[40:43], v[232:235], v[128:131], v[40:43]
    ds_read_b64_tr_b16 v[148:149], v162 offset:10240
    v_mfma_f32_16x16x32_bf16 v[44:47], v[236:239], v[128:131], v[44:47]
    v_mfma_f32_16x16x32_bf16 v[48:51], v[224:227], v[132:135], v[48:51]
    ds_read_b64_tr_b16 v[150:151], v162 offset:11520
    v_mfma_f32_16x16x32_bf16 v[52:55], v[228:231], v[132:135], v[52:55]
    v_mfma_f32_16x16x32_bf16 v[56:59], v[232:235], v[132:135], v[56:59]
    ds_read_b64_tr_b16 v[152:153], v163 offset:10240
    v_mfma_f32_16x16x32_bf16 v[88:91], v[96:99], v[232:235], v[88:91]
    ds_read_b64_tr_b16 v[154:155], v163 offset:11520
    v_mfma_f32_16x16x32_bf16 v[60:63], v[236:239], v[132:135], v[60:63]
    v_mfma_f32_16x16x32_bf16 v[64:67], v[224:227], v[136:139], v[64:67]
    ds_read_b64_tr_b16 v[156:157], v164 offset:10240
    v_mfma_f32_16x16x32_bf16 v[68:71], v[228:231], v[136:139], v[68:71]
    ds_read_b64_tr_b16 v[158:159], v164 offset:11520
    v_mfma_f32_16x16x32_bf16 v[72:75], v[232:235], v[136:139], v[72:75]
    v_mfma_f32_16x16x32_bf16 v[76:79], v[236:239], v[136:139], v[76:79]
    ds_read_b128 v[100:103], v104 offset:1216
    v_mfma_f32_16x16x32_bf16 v[92:95], v[96:99], v[236:239], v[92:95]
    s_waitcnt lgkmcnt(0)
    s_barrier
    v_mfma_f32_16x16x32_bf16 v[0:3], v[240:243], v[140:143], v[0:3]
    s_add_u32 m0, s41, 0
    s_mul_i32 s39, s92, 0x3c000
    s_cmp_eq_u32 s92, 9
    s_cselect_b32 s39, 0, s39
    s_cselect_b32 s93, 0x21c000, 0
    s_cselect_b32 s95, 0xfffc4000, 0
    s_add_u32 s92, s92, 2
    s_sub_u32 s36, s92, 10
    s_cmp_lt_u32 s92, 10
    s_cselect_b32 s92, s92, s36
    v_mfma_f32_16x16x32_bf16 v[4:7], v[244:247], v[140:143], v[4:7]
    v_mfma_f32_16x16x32_bf16 v[8:11], v[248:251], v[140:143], v[8:11]
    v_mfma_f32_16x16x32_bf16 v[12:15], v[252:255], v[140:143], v[12:15]
    v_add_u32 v180, s93, v171
    v_add_u32 v181, s95, v171
    v_cmp_le_u32 vcc, 0x3b920, v171
    s_nop 1
    v_cndmask_b32 v180, v180, v181, vcc
    buffer_load_dwordx4 v180, s[12:15], s39 offen offset:0 lds
    v_mfma_f32_16x16x32_bf16 v[16:19], v[240:243], v[144:147], v[16:19]
    v_mfma_f32_16x16x32_bf16 v[80:83], v[100:103], v[240:243], v[80:83]
    v_mfma_f32_16x16x32_bf16 v[20:23], v[244:247], v[144:147], v[20:23]
    v_add_u32 v180, s93, v172
    v_add_u32 v181, s95, v172
    v_cmp_le_u32 vcc, 0x3b920, v172
    s_nop 1
    v_cndmask_b32 v180, v180, v181, vcc
    buffer_load_dwordx4 v180, s[12:15], s39 offen offset:1024 lds
    v_mfma_f32_16x16x32_bf16 v[24:27], v[248:251], v[144:147], v[24:27]
    v_mfma_f32_16x16x32_bf16 v[28:31], v[252:255], v[144:147], v[28:31]
    v_mfma_f32_16x16x32_bf16 v[32:35], v[240:243], v[148:151], v[32:35]
    v_add_u32 v180, s93, v173
    v_add_u32 v181, s95, v173
    v_cmp_le_u32 vcc, 0x3b920, v173
    s_nop 1
    v_cndmask_b32 v180, v180, v181, vcc
    buffer_load_dwordx4 v180, s[12:15], s39 offen offset:2048 lds
    v_mfma_f32_16x16x32_bf16 v[36:39], v[244:247], v[148:151], v[36:39]
    v_mfma_f32_16x16x32_bf16 v[84:87], v[100:103], v[244:247], v[84:87]
    v_mfma_f32_16x16x32_bf16 v[40:43], v[248:251], v[148:151], v[40:43]
    v_add_u32 v180, s93, v174
    v_add_u32 v181, s95, v174
    v_cmp_le_u32 vcc, 0x3b920, v174
    s_nop 1
    v_cndmask_b32 v180, v180, v181, vcc
    buffer_load_dwordx4 v180, s[12:15], s39 offen offset:3072 lds
    v_mfma_f32_16x16x32_bf16 v[44:47], v[252:255], v[148:151], v[44:47]
    v_mfma_f32_16x16x32_bf16 v[48:51], v[240:243], v[152:155], v[48:51]
    v_mfma_f32_16x16x32_bf16 v[52:55], v[244:247], v[152:155], v[52:55]
    v_add_u32 v180, s93, v175
    v_add_u32 v181, s95, v175
    v_cmp_le_u32 vcc, 0x3b920, v175
    s_nop 1
    v_cndmask_b32 v180, v180, v181, vcc
    s_add_u32 m0, s41, 0x1000
    s_nop 0
    buffer_load_dwordx4 v180, s[12:15], s39 offen lds
    v_mfma_f32_16x16x32_bf16 v[56:59], v[248:251], v[152:155], v[56:59]
    v_mfma_f32_16x16x32_bf16 v[88:91], v[100:103], v[248:251], v[88:91]
    v_mfma_f32_16x16x32_bf16 v[60:63], v[252:255], v[152:155], v[60:63]
    v_mfma_f32_16x16x32_bf16 v[64:67], v[240:243], v[156:159], v[64:67]
    v_mfma_f32_16x16x32_bf16 v[68:71], v[244:247], v[156:159], v[68:71]
    v_mfma_f32_16x16x32_bf16 v[72:75], v[248:251], v[156:159], v[72:75]
    s_mov_b32 s47, 0x3b920
    v_mfma_f32_16x16x32_bf16 v[76:79], v[252:255], v[156:159], v[76:79]
    v_mfma_f32_16x16x32_bf16 v[92:95], v[100:103], v[252:255], v[92:95]
    v_mul_f32 v176, 0xbfb8aa3b, v80
    v_mul_f32 v177, 0xbfb8aa3b, v84
    v_mul_f32 v178, 0xbfb8aa3b, v88
    s_nop 4
    v_mul_f32 v179, 0xbfb8aa3b, v92
    v_exp_f32 v176, v176
    v_exp_f32 v177, v177
    v_exp_f32 v178, v178
    v_exp_f32 v179, v179
    v_add_f32 v176, 1.0, v176
    v_add_f32 v177, 1.0, v177
    v_add_f32 v178, 1.0, v178
    v_add_f32 v179, 1.0, v179
    v_rcp_f32 v176, v176
    v_rcp_f32 v177, v177
    v_rcp_f32 v178, v178
    v_rcp_f32 v179, v179
    v_lshlrev_b32 v106, 3, v190
    v_cmp_lt_u32 vcc, 15, v190
    v_mov_b32 v107, s91
    s_nop 0
    v_cndmask_b32 v106, v106, v107, vcc
    s_lshl_b32 s36, s31, 7
    s_lshr_b32 s37, s32, 1
    s_lshl_b32 s37, s37, 5
    s_add_u32 s36, s36, s37
    s_and_b32 s37, s32, 1
    s_add_u32 s36, s36, s37
    s_lshl_b32 s36, s36, 2
    s_add_u32 s36, s36, 0x800000
    s_lshr_b32 s37, s32, 2
    s_lshl_b32 s37, s37, 1
    s_cmp_eq_u32 s37, s33
    s_cselect_b32 s42, s36, s91
    s_and_b32 s36, s32, 3
    v_mov_b32 v107, v176
    s_cmp_eq_u32 s36, 1
    s_cselect_b64 vcc, -1, 0
    v_cndmask_b32 v107, v107, v177, vcc
    s_cmp_eq_u32 s36, 2
    s_cselect_b64 vcc, -1, 0
    v_cndmask_b32 v107, v107, v178, vcc
    s_cmp_eq_u32 s36, 3
    s_cselect_b64 vcc, -1, 0
    v_cndmask_b32 v107, v107, v179, vcc
    buffer_store_dword v107, v106, s[16:19], s42 offen sc1
    v_lshrrev_b32 v100, 2, v190
    v_lshlrev_b32 v100, 7, v100
    v_and_b32 v101, 3, v190
    v_lshlrev_b32 v101, 4, v101
    v_add_u32 v100, v100, v101
    v_add_u32 v100, 0xb00000, v100
    v_mov_b32 v92, -1
    v_mov_b32 v93, -1
    v_mov_b32 v94, -1
    v_mov_b32 v95, -1
    s_lshl_b32 s36, s31, 3
    s_lshl_b32 s37, s34, 2
    s_add_u32 s36, s36, s37
    s_lshl_b32 s36, s36, 2
    s_lshr_b32 s37, s32, 1
    s_add_u32 s36, s36, s37
    s_mul_i32 s36, s36, 0x1400
    s_add_u32 s48, s36, 0
    s_add_u32 s49, s48, 0x5000
    s_add_u32 s50, s48, 0xa000
    s_add_u32 s51, s48, 0xf000
    s_add_u32 s52, s48, 0x1000
    s_add_u32 s53, s48, 0xb000
    s_and_b32 s42, s32, 1
    s_lshl_b32 s37, s42, 1
    s_add_u32 s37, s37, s35
    s_lshl_b32 s37, s37, 10
    v_lshlrev_b32 v96, 4, v190
    v_add_u32 v96, s37, v96
    s_lshl_b32 s37, s35, 9
    s_lshl_b32 s42, s42, 8
    s_add_u32 s37, s37, s42
    v_lshrrev_b32 v97, 4, v190
    v_mul_u32_u24 v97, 0x5000, v97
    v_and_b32 v95, 15, v190
    v_lshlrev_b32 v95, 4, v95
    v_add3_u32 v97, v95, v97, s37
    v_mov_b32 v95, -1
    v_mul_f32 v182, s88, v0
    v_mul_f32 v183, s88, v1
    v_mul_f32 v184, s88, v2
    v_mul_f32 v185, s88, v3
    v_mul_f32 v186, s88, v4
    v_mul_f32 v187, s88, v5
    v_mul_f32 v188, s88, v6
    v_mul_f32 v189, s88, v7
    v_exp_f32 v182, v182 clamp
    v_exp_f32 v183, v183 clamp
    v_exp_f32 v184, v184 clamp
    v_exp_f32 v185, v185 clamp
    buffer_load_dwordx4 v[156:159], v100, s[16:19], 0 offen sc1
    v_exp_f32 v186, v186 clamp
    v_exp_f32 v187, v187 clamp
    v_exp_f32 v188, v188 clamp
    v_exp_f32 v189, v189 clamp
    v_max_f32 v0, s89, v0
    v_max_f32 v1, s89, v1
    v_max_f32 v2, s89, v2
    v_max_f32 v3, s89, v3
    v_max_f32 v4, s89, v4
    v_max_f32 v5, s89, v5
    v_max_f32 v6, s89, v6
    v_max_f32 v7, s89, v7
    s_add_u32 m0, s41, 0x1e000
    s_mul_i32 s100, s92, 0x3c000
    s_cmp_eq_u32 s92, 9
    s_cselect_b32 s100, 0, s100
    s_cselect_b32 s93, 0x21c000, 0
    s_cselect_b32 s95, 0xfffc4000, 0
    s_add_u32 s92, s92, 2
    s_sub_u32 s46, s92, 10
    s_cmp_lt_u32 s92, 10
    s_cselect_b32 s92, s92, s46
    v_add_f32 v0, v0, v182
    v_add_f32 v1, v1, v183
    v_add_f32 v2, v2, v184
    v_add_f32 v3, v3, v185
    v_add_f32 v4, v4, v186
    v_add_f32 v5, v5, v187
    v_add_f32 v6, v6, v188
    v_add_f32 v7, v7, v189
    v_mul_f32 v182, s88, v8
    v_mul_f32 v183, s88, v9
    v_mul_f32 v184, s88, v10
    v_mul_f32 v185, s88, v11
    v_add_u32 v120, s93, v171
    v_add_u32 v121, s95, v171
    v_cmp_le_u32 s[44:45], s47, v171
    s_nop 1
    v_cndmask_b32 v120, v120, v121, s[44:45]
    buffer_load_dwordx4 v120, s[12:15], s100 offen offset:0 lds
    v_mul_f32 v186, s88, v12
    v_mul_f32 v187, s88, v13
    v_mul_f32 v188, s88, v14
    v_mul_f32 v189, s88, v15
    v_exp_f32 v182, v182 clamp
    v_exp_f32 v183, v183 clamp
    v_exp_f32 v184, v184 clamp
    v_exp_f32 v185, v185 clamp
    v_exp_f32 v186, v186 clamp
    v_exp_f32 v187, v187 clamp
    v_exp_f32 v188, v188 clamp
    v_exp_f32 v189, v189 clamp
    v_add_u32 v120, s93, v172
    v_add_u32 v121, s95, v172
    v_cmp_le_u32 s[44:45], s47, v172
    s_nop 1
    v_cndmask_b32 v120, v120, v121, s[44:45]
    buffer_load_dwordx4 v120, s[12:15], s100 offen offset:1024 lds
    v_max_f32 v8, s89, v8
    v_max_f32 v9, s89, v9
    v_max_f32 v10, s89, v10
    v_max_f32 v11, s89, v11
    v_max_f32 v12, s89, v12
    v_max_f32 v13, s89, v13
    v_max_f32 v14, s89, v14
    v_max_f32 v15, s89, v15
    v_add_f32 v8, v8, v182
    v_add_f32 v9, v9, v183
    v_add_f32 v10, v10, v184
    v_add_f32 v11, v11, v185
    v_add_u32 v120, s93, v173
    v_add_u32 v121, s95, v173
    v_cmp_le_u32 s[44:45], s47, v173
    s_nop 1
    v_cndmask_b32 v120, v120, v121, s[44:45]
    buffer_load_dwordx4 v120, s[12:15], s100 offen offset:2048 lds
    v_add_f32 v12, v12, v186
    v_add_f32 v13, v13, v187
    v_add_f32 v14, v14, v188
    v_add_f32 v15, v15, v189
    v_mul_f32 v182, s88, v16
    v_mul_f32 v183, s88, v17
    v_mul_f32 v184, s88, v18
    v_mul_f32 v185, s88, v19
    v_mul_f32 v186, s88, v20
    v_mul_f32 v187, s88, v21
    v_mul_f32 v188, s88, v22
    v_mul_f32 v189, s88, v23
    v_add_u32 v120, s93, v174
    v_add_u32 v121, s95, v174
    v_cmp_le_u32 s[44:45], s47, v174
    s_nop 1
    v_cndmask_b32 v120, v120, v121, s[44:45]
    buffer_load_dwordx4 v120, s[12:15], s100 offen offset:3072 lds
    v_exp_f32 v182, v182 clamp
    v_exp_f32 v183, v183 clamp
    v_exp_f32 v184, v184 clamp
    v_exp_f32 v185, v185 clamp
    v_exp_f32 v186, v186 clamp
    v_exp_f32 v187, v187 clamp
    v_exp_f32 v188, v188 clamp
    v_exp_f32 v189, v189 clamp
    v_max_f32 v16, s89, v16
    v_max_f32 v17, s89, v17
    v_max_f32 v18, s89, v18
    v_max_f32 v19, s89, v19
    v_add_u32 v120, s93, v175
    v_add_u32 v121, s95, v175
    v_cmp_le_u32 s[44:45], s47, v175
    s_nop 1
    v_cndmask_b32 v120, v120, v121, s[44:45]
    s_add_u32 m0, s41, 0x1f000
    s_nop 0
    buffer_load_dwordx4 v120, s[12:15], s100 offen lds
    v_max_f32 v20, s89, v20
    v_max_f32 v21, s89, v21
    v_max_f32 v22, s89, v22
    v_max_f32 v23, s89, v23
    v_add_f32 v16, v16, v182
    v_add_f32 v17, v17, v183
    v_add_f32 v18, v18, v184
    v_add_f32 v19, v19, v185
    v_add_f32 v20, v20, v186
    v_add_f32 v21, v21, v187
    v_add_f32 v22, v22, v188
    v_add_f32 v23, v23, v189
    v_mul_f32 v182, s88, v24
    v_mul_f32 v183, s88, v25
    v_mul_f32 v184, s88, v26
    v_mul_f32 v185, s88, v27
    v_mul_f32 v186, s88, v28
    v_mul_f32 v187, s88, v29
    v_mul_f32 v188, s88, v30
    v_mul_f32 v189, s88, v31
    v_exp_f32 v182, v182 clamp
    v_exp_f32 v183, v183 clamp
    v_exp_f32 v184, v184 clamp
    v_exp_f32 v185, v185 clamp
    s_add_u32 m0, s41, 0x23000
    s_mul_i32 s100, s92, 0x3c000
    s_cmp_eq_u32 s92, 9
    s_cselect_b32 s100, 0, s100
    s_cselect_b32 s93, 0x21c000, 0
    s_cselect_b32 s95, 0xfffc4000, 0
    s_add_u32 s92, s92, 2
    s_sub_u32 s46, s92, 10
    s_cmp_lt_u32 s92, 10
    s_cselect_b32 s92, s92, s46
    v_exp_f32 v186, v186 clamp
    v_exp_f32 v187, v187 clamp
    v_exp_f32 v188, v188 clamp
    v_exp_f32 v189, v189 clamp
    v_max_f32 v24, s89, v24
    v_max_f32 v25, s89, v25
    v_max_f32 v26, s89, v26
    v_max_f32 v27, s89, v27
    v_max_f32 v28, s89, v28
    v_max_f32 v29, s89, v29
    v_max_f32 v30, s89, v30
    v_max_f32 v31, s89, v31
    v_add_u32 v120, s93, v171
    v_add_u32 v121, s95, v171
    v_cmp_le_u32 s[44:45], s47, v171
    s_nop 1
    v_cndmask_b32 v120, v120, v121, s[44:45]
    buffer_load_dwordx4 v120, s[12:15], s100 offen offset:0 lds
    v_add_f32 v24, v24, v182
    v_add_f32 v25, v25, v183
    v_add_f32 v26, v26, v184
    v_add_f32 v27, v27, v185
    v_add_f32 v28, v28, v186
    v_add_f32 v29, v29, v187
    v_add_f32 v30, v30, v188
    v_add_f32 v31, v31, v189
    v_mul_f32 v182, s88, v64
    v_mul_f32 v183, s88, v65
    v_mul_f32 v184, s88, v66
    v_mul_f32 v185, s88, v67
    v_add_u32 v120, s93, v172
    v_add_u32 v121, s95, v172
    v_cmp_le_u32 s[44:45], s47, v172
    s_nop 1
    v_cndmask_b32 v120, v120, v121, s[44:45]
    buffer_load_dwordx4 v120, s[12:15], s100 offen offset:1024 lds
    v_exp_f32 v182, v182 clamp
    v_exp_f32 v183, v183 clamp
    v_exp_f32 v184, v184 clamp
    v_exp_f32 v185, v185 clamp
    v_max_f32 v186, s89, v64
    v_max_f32 v187, s89, v65
    v_max_f32 v188, s89, v66
    v_max_f32 v189, s89, v67
    v_add_f32 v186, v186, v182
    v_add_f32 v187, v187, v183
    v_add_f32 v188, v188, v184
    v_add_f32 v189, v189, v185
    v_add_u32 v120, s93, v173
    v_add_u32 v121, s95, v173
    v_cmp_le_u32 s[44:45], s47, v173
    s_nop 1
    v_cndmask_b32 v120, v120, v121, s[44:45]
    buffer_load_dwordx4 v120, s[12:15], s100 offen offset:2048 lds
    v_cndmask_b32 v64, v64, v186, s[72:73]
    v_cndmask_b32 v65, v65, v187, s[72:73]
    v_cndmask_b32 v66, v66, v188, s[72:73]
    v_cndmask_b32 v67, v67, v189, s[72:73]
    v_mul_f32 v182, s88, v68
    v_mul_f32 v183, s88, v69
    v_mul_f32 v184, s88, v70
    v_mul_f32 v185, s88, v71
    v_exp_f32 v182, v182 clamp
    v_exp_f32 v183, v183 clamp
    v_exp_f32 v184, v184 clamp
    v_exp_f32 v185, v185 clamp
    v_add_u32 v120, s93, v174
    v_add_u32 v121, s95, v174
    v_cmp_le_u32 s[44:45], s47, v174
    s_nop 1
    v_cndmask_b32 v120, v120, v121, s[44:45]
    buffer_load_dwordx4 v120, s[12:15], s100 offen offset:3072 lds
    v_max_f32 v186, s89, v68
    v_max_f32 v187, s89, v69
    v_max_f32 v188, s89, v70
    v_max_f32 v189, s89, v71
    v_add_f32 v186, v186, v182
    v_add_f32 v187, v187, v183
    v_add_f32 v188, v188, v184
    v_add_f32 v189, v189, v185
    v_cndmask_b32 v68, v68, v186, s[72:73]
    v_cndmask_b32 v69, v69, v187, s[72:73]
    v_cndmask_b32 v70, v70, v188, s[72:73]
    v_cndmask_b32 v71, v71, v189, s[72:73]
    v_add_u32 v120, s93, v175
    v_add_u32 v121, s95, v175
    v_cmp_le_u32 s[44:45], s47, v175
    s_nop 1
    v_cndmask_b32 v120, v120, v121, s[44:45]
    s_add_u32 m0, s41, 0x24000
    s_nop 0
    buffer_load_dwordx4 v120, s[12:15], s100 offen lds
    v_mul_f32 v182, s88, v72
    v_mul_f32 v183, s88, v73
    v_mul_f32 v184, s88, v74
    v_mul_f32 v185, s88, v75
    v_exp_f32 v182, v182 clamp
    v_exp_f32 v183, v183 clamp
    v_exp_f32 v184, v184 clamp
    v_exp_f32 v185, v185 clamp
    v_max_f32 v186, s89, v72
    v_max_f32 v187, s89, v73
    v_max_f32 v188, s89, v74
    v_max_f32 v189, s89, v75
    v_add_f32 v186, v186, v182
    v_add_f32 v187, v187, v183
    v_add_f32 v188, v188, v184
    v_add_f32 v189, v189, v185
    v_cndmask_b32 v72, v72, v186, s[72:73]
    v_cndmask_b32 v73, v73, v187, s[72:73]
    v_cndmask_b32 v74, v74, v188, s[72:73]
    v_cndmask_b32 v75, v75, v189, s[72:73]
    v_mul_f32 v182, s88, v76
    v_mul_f32 v183, s88, v77
    v_mul_f32 v184, s88, v78
    v_mul_f32 v185, s88, v79
    buffer_store_dwordx4 v[92:95], v96, s[16:19], s48 offen sc1
    v_exp_f32 v182, v182 clamp
    v_exp_f32 v183, v183 clamp
    v_exp_f32 v184, v184 clamp
    v_exp_f32 v185, v185 clamp
    v_max_f32 v186, s89, v76
    v_max_f32 v187, s89, v77
    v_max_f32 v188, s89, v78
    v_max_f32 v189, s89, v79
    v_add_f32 v186, v186, v182
    v_add_f32 v187, v187, v183
    v_add_f32 v188, v188, v184
    v_add_f32 v189, v189, v185
    buffer_store_dwordx4 v[92:95], v96, s[16:19], s49 offen sc1
    v_cndmask_b32 v76, v76, v186, s[72:73]
    v_cndmask_b32 v77, v77, v187, s[72:73]
    v_cndmask_b32 v78, v78, v188, s[72:73]
    v_cndmask_b32 v79, v79, v189, s[72:73]
    v_cvt_pk_bf16_f32 v0, v0, v1
    v_cvt_pk_bf16_f32 v1, v2, v3
    v_cvt_pk_bf16_f32 v2, v4, v5
    v_cvt_pk_bf16_f32 v3, v6, v7
    v_cvt_pk_bf16_f32 v16, v16, v17
    v_cvt_pk_bf16_f32 v17, v18, v19
    v_cvt_pk_bf16_f32 v18, v20, v21
    v_cvt_pk_bf16_f32 v19, v22, v23
    buffer_store_dwordx4 v[92:95], v96, s[16:19], s50 offen sc1
    v_cvt_pk_bf16_f32 v32, v32, v33
    v_cvt_pk_bf16_f32 v33, v34, v35
    v_cvt_pk_bf16_f32 v34, v36, v37
    v_cvt_pk_bf16_f32 v35, v38, v39
    v_cvt_pk_bf16_f32 v48, v48, v49
    v_cvt_pk_bf16_f32 v49, v50, v51
    v_cvt_pk_bf16_f32 v50, v52, v53
    v_cvt_pk_bf16_f32 v51, v54, v55
    v_cvt_pk_bf16_f32 v64, v64, v65
    v_cvt_pk_bf16_f32 v65, v66, v67
    v_cvt_pk_bf16_f32 v66, v68, v69
    v_cvt_pk_bf16_f32 v67, v70, v71
    buffer_store_dwordx4 v[92:95], v96, s[16:19], s51 offen sc1
    v_mov_b32 v182, s90
    v_cndmask_b32 v68, v64, v182, s[72:73]
    v_cndmask_b32 v69, v65, v182, s[72:73]
    v_cndmask_b32 v70, v66, v182, s[72:73]
    v_cndmask_b32 v71, v67, v182, s[72:73]
    v_cvt_pk_bf16_f32 v8, v8, v9
    v_cvt_pk_bf16_f32 v9, v10, v11
    v_cvt_pk_bf16_f32 v10, v12, v13
    v_cvt_pk_bf16_f32 v11, v14, v15
    v_cvt_pk_bf16_f32 v24, v24, v25
    v_cvt_pk_bf16_f32 v25, v26, v27
    v_cvt_pk_bf16_f32 v26, v28, v29
    buffer_store_dwordx4 v[92:95], v97, s[16:19], s52 offen sc1
    v_cvt_pk_bf16_f32 v27, v30, v31
    v_cvt_pk_bf16_f32 v40, v40, v41
    v_cvt_pk_bf16_f32 v41, v42, v43
    v_cvt_pk_bf16_f32 v42, v44, v45
    v_cvt_pk_bf16_f32 v43, v46, v47
    v_cvt_pk_bf16_f32 v56, v56, v57
    v_cvt_pk_bf16_f32 v57, v58, v59
    v_cvt_pk_bf16_f32 v58, v60, v61
    v_cvt_pk_bf16_f32 v59, v62, v63
    v_cvt_pk_bf16_f32 v72, v72, v73
    v_cvt_pk_bf16_f32 v73, v74, v75
    v_cvt_pk_bf16_f32 v74, v76, v77
    v_cvt_pk_bf16_f32 v75, v78, v79
    v_mov_b32 v182, s90
    v_cndmask_b32 v76, v72, v182, s[72:73]
    v_cndmask_b32 v77, v73, v182, s[72:73]
    v_cndmask_b32 v78, v74, v182, s[72:73]
    v_cndmask_b32 v79, v75, v182, s[72:73]
    v_mfma_f32_16x16x32_bf16 v[4:7], v[0:3], v[32:35], 0
    v_mfma_f32_16x16x32_bf16 v[20:23], v[16:19], v[48:51], 0
    v_mfma_f32_16x16x32_bf16 v[36:39], v[0:3], v[68:71], 0
    v_mfma_f32_16x16x32_bf16 v[52:55], v[16:19], v[68:71], 0
    v_mfma_f32_16x16x32_bf16 v[12:15], v[64:67], v[32:35], 0
    v_mfma_f32_16x16x32_bf16 v[28:31], v[64:67], v[48:51], 0
    v_mfma_f32_16x16x32_bf16 v[44:47], v[64:67], v[68:71], 0
    v_mfma_f32_16x16x32_bf16 v[4:7], v[8:11], v[40:43], v[4:7]
    v_mfma_f32_16x16x32_bf16 v[20:23], v[24:27], v[56:59], v[20:23]
    v_mfma_f32_16x16x32_bf16 v[36:39], v[8:11], v[76:79], v[36:39]
    v_mfma_f32_16x16x32_bf16 v[52:55], v[24:27], v[76:79], v[52:55]
    v_mfma_f32_16x16x32_bf16 v[12:15], v[72:75], v[40:43], v[12:15]
    v_mfma_f32_16x16x32_bf16 v[28:31], v[72:75], v[56:59], v[28:31]
    v_mfma_f32_16x16x32_bf16 v[44:47], v[72:75], v[76:79], v[44:47]
    s_nop 4
    v_cndmask_b32 v36, v36, v52, s[74:75]
    s_nop 0
    v_cndmask_b32 v12, v12, v28, s[76:77]
    v_cndmask_b32 v37, v37, v53, s[74:75]
    v_cndmask_b32 v13, v13, v29, s[76:77]
    v_cndmask_b32 v38, v38, v54, s[74:75]
    v_cndmask_b32 v14, v14, v30, s[76:77]
    v_cndmask_b32 v39, v39, v55, s[74:75]
    v_cndmask_b32 v15, v15, v31, s[76:77]
    v_permlane32_swap_b32 v12, v44
    v_permlane32_swap_b32 v13, v45
    v_permlane32_swap_b32 v14, v46
    v_permlane32_swap_b32 v15, v47
    s_cmp_eq_u32 s34, 1
    s_cselect_b64 s[98:99], -1, 0
    v_cndmask_b32 v44, v36, v4, s[98:99]
    v_cndmask_b32 v45, v37, v5, s[98:99]
    v_cndmask_b32 v46, v38, v6, s[98:99]
    v_cndmask_b32 v47, v39, v7, s[98:99]
    v_cndmask_b32 v60, v12, v20, s[98:99]
    v_cndmask_b32 v61, v13, v21, s[98:99]
    v_cndmask_b32 v62, v14, v22, s[98:99]
    v_cndmask_b32 v63, v15, v23, s[98:99]
    v_lshlrev_b32 v180, 4, v190
    s_lshl_b32 s36, s33, 11
    s_add_u32 s36, s36, 0xf000
    s_xor_b32 s37, s33, 2
    s_lshl_b32 s37, s37, 11
    s_add_u32 s37, s37, 0xf000
    v_add_u32 v181, s37, v180
    v_add_u32 v180, s36, v180
    ds_write_b128 v180, v[44:47] offset:0
    ds_write_b128 v180, v[60:63] offset:1024
    v_cndmask_b32 v52, v4, v36, s[98:99]
    v_cndmask_b32 v53, v5, v37, s[98:99]
    v_cndmask_b32 v54, v6, v38, s[98:99]
    v_cndmask_b32 v55, v7, v39, s[98:99]
    v_cndmask_b32 v28, v20, v12, s[98:99]
    v_cndmask_b32 v29, v21, v13, s[98:99]
    v_cndmask_b32 v30, v22, v14, s[98:99]
    v_cndmask_b32 v31, v23, v15, s[98:99]
    s_waitcnt lgkmcnt(0)
    s_barrier
    ds_read_b128 v[44:47], v181 offset:0
    ds_read_b128 v[60:63], v181 offset:1024
    s_lshl_b32 s36, s32, 1
    s_add_u32 s36, s36, s35
    s_lshl_b32 s36, s36, 1
    s_add_u32 s36, s36, s34
    s_lshl_b32 s36, s36, 4
    s_add_u32 s36, s36, s31
    s_lshl_b32 s36, s36, 10
    s_add_u32 s36, s36, 0x900000
    v_lshlrev_b32 v180, 4, v190
    s_waitcnt lgkmcnt(1)
    v_add_f32 v52, v52, v44
    v_add_f32 v53, v53, v45
    v_add_f32 v54, v54, v46
    v_add_f32 v55, v55, v47
    v_cvt_pk_bf16_f32 v4, v52, v53
    v_cvt_pk_bf16_f32 v5, v54, v55
    s_waitcnt lgkmcnt(0)
    v_add_f32 v28, v28, v60
    v_add_f32 v29, v29, v61
    v_add_f32 v30, v30, v62
    v_add_f32 v31, v31, v63
    v_cvt_pk_bf16_f32 v6, v28, v29
    v_cvt_pk_bf16_f32 v7, v30, v31
    buffer_store_dwordx4 v[4:7], v180, s[16:19], s36 offen sc1
    s_waitcnt vmcnt(23)
    s_barrier
    ds_read_b64_tr_b16 v[120:121], v160 offset:20480
    ds_read_b64_tr_b16 v[122:123], v160 offset:21760
    ds_read_b64_tr_b16 v[124:125], v161 offset:20480
    ds_read_b64_tr_b16 v[126:127], v161 offset:21760
    ds_read_b64_tr_b16 v[128:129], v165 offset:20480
    ds_read_b64_tr_b16 v[130:131], v165 offset:21760
    ds_read_b64_tr_b16 v[140:141], v160 offset:30720
    ds_read_b64_tr_b16 v[142:143], v160 offset:32000
    ds_read_b64_tr_b16 v[144:145], v161 offset:30720
    ds_read_b64_tr_b16 v[146:147], v161 offset:32000
    ds_read_b64_tr_b16 v[148:149], v165 offset:30720
    ds_read_b64_tr_b16 v[150:151], v165 offset:32000
    s_waitcnt lgkmcnt(10)
    v_mfma_f32_16x16x32_bf16 v[80:83], v[120:123], a[0:3], 0
    ds_read_b64_tr_b16 v[132:133], v162 offset:20480
    v_mfma_f32_16x16x32_bf16 v[84:87], v[120:123], a[4:7], 0
    ds_read_b64_tr_b16 v[134:135], v162 offset:21760
    v_mfma_f32_16x16x32_bf16 v[88:91], v[120:123], a[8:11], 0
    v_mfma_f32_16x16x32_bf16 v[92:95], v[120:123], a[12:15], 0
    ds_read_b64_tr_b16 v[136:137], v163 offset:20480
    s_waitcnt lgkmcnt(11)
    v_mfma_f32_16x16x32_bf16 v[96:99], v[124:127], a[0:3], 0
    v_mfma_f32_16x16x32_bf16 v[100:103], v[124:127], a[4:7], 0
    ds_read_b64_tr_b16 v[138:139], v163 offset:21760
    v_mfma_f32_16x16x32_bf16 v[104:107], v[124:127], a[8:11], 0
    ds_read_b64_tr_b16 v[152:153], v166 offset:20480
    v_mfma_f32_16x16x32_bf16 v[108:111], v[124:127], a[12:15], 0
    s_waitcnt lgkmcnt(11)
    v_mfma_f32_16x16x32_bf16 v[112:115], v[128:131], a[0:3], 0
    ds_read_b64_tr_b16 v[154:155], v166 offset:21760
    v_mfma_f32_16x16x32_bf16 v[116:119], v[128:131], a[4:7], 0
    s_waitcnt lgkmcnt(10)
    v_mfma_f32_16x16x32_bf16 v[80:83], v[140:143], a[16:19], v[80:83]
    ds_read_b64_tr_b16 v[120:121], v162 offset:30720
    v_mfma_f32_16x16x32_bf16 v[84:87], v[140:143], a[20:23], v[84:87]
    ds_read_b64_tr_b16 v[122:123], v162 offset:32000
    v_mfma_f32_16x16x32_bf16 v[88:91], v[140:143], a[24:27], v[88:91]
    v_mfma_f32_16x16x32_bf16 v[92:95], v[140:143], a[28:31], v[92:95]
    ds_read_b64_tr_b16 v[124:125], v163 offset:30720
    s_waitcnt lgkmcnt(11)
    v_mfma_f32_16x16x32_bf16 v[96:99], v[144:147], a[16:19], v[96:99]
    v_mfma_f32_16x16x32_bf16 v[100:103], v[144:147], a[20:23], v[100:103]
    ds_read_b64_tr_b16 v[126:127], v163 offset:32000
    v_mfma_f32_16x16x32_bf16 v[104:107], v[144:147], a[24:27], v[104:107]
    ds_read_b64_tr_b16 v[128:129], v166 offset:30720
    v_mfma_f32_16x16x32_bf16 v[108:111], v[144:147], a[28:31], v[108:111]
    s_waitcnt lgkmcnt(11)
    v_mfma_f32_16x16x32_bf16 v[112:115], v[148:151], a[16:19], v[112:115]
    ds_read_b64_tr_b16 v[130:131], v166 offset:32000
    v_mfma_f32_16x16x32_bf16 v[116:119], v[148:151], a[20:23], v[116:119]
    s_waitcnt vmcnt(18)
    s_barrier
    s_waitcnt lgkmcnt(10)
    v_mfma_f32_16x16x32_bf16 v[80:83], v[132:135], a[32:35], v[80:83]
    ds_read_b64_tr_b16 v[140:141], v160 offset:40960
    ds_read_b64_tr_b16 v[142:143], v160 offset:42240
    ds_read_b64_tr_b16 v[144:145], v161 offset:40960
    ds_read_b64_tr_b16 v[146:147], v161 offset:42240
    ds_read_b64_tr_b16 v[148:149], v165 offset:40960
    v_mfma_f32_16x16x32_bf16 v[84:87], v[132:135], a[36:39], v[84:87]
    ds_read_b64_tr_b16 v[150:151], v165 offset:42240
    s_waitcnt vmcnt(16)
    v_xor_b32 v156, s28, v156
    v_xor_b32 v157, s28, v157
    v_xor_b32 v158, s28, v158
    v_xor_b32 v159, s28, v159
    v_or3_b32 v156, v156, v157, v158
    v_or_b32 v156, v156, v159
    v_cmp_ne_u32 vcc, 0, v156
    s_nop 4
    s_cbranch_vccz Lfbd_6
    s_mov_b32 s43, 0
Lfb_5:
    v_lshrrev_b32 v187, 2, v190
    v_lshlrev_b32 v187, 7, v187
    v_and_b32 v185, 3, v190
    v_lshlrev_b32 v185, 4, v185
    v_add_u32 v187, v187, v185
    s_mov_b32 s36, 0xb00000
    buffer_load_dwordx4 v[156:159], v187, s[16:19], s36 offen sc1
    s_waitcnt vmcnt(0)
    v_xor_b32 v156, s28, v156
    v_xor_b32 v157, s28, v157
    v_xor_b32 v158, s28, v158
    v_xor_b32 v159, s28, v159
    v_or3_b32 v156, v156, v157, v158
    v_or_b32 v156, v156, v159
    v_cmp_ne_u32 vcc, 0, v156
    s_nop 4
    s_cbranch_vccz Lfbd_6
    s_add_u32 s43, s43, 1
    s_cmp_lt_u32 s43, 0x8000
    s_cbranch_scc1 Lfb_5
Lfbd_6:
    s_not_b32 s36, s94
    s_and_b32 s36, s36, 2
    v_mfma_f32_16x16x32_bf16 v[88:91], v[132:135], a[40:43], v[88:91]
    s_lshl_b32 s36, s36, 1
    s_lshr_b32 s44, s94, 1
    s_and_b32 s44, s44, 2
    s_add_u32 s44, s44, s36
    s_and_b32 s36, s94, 1
    v_mfma_f32_16x16x32_bf16 v[92:95], v[132:135], a[44:47], v[92:95]
    s_add_u32 s44, s44, s36
    s_lshl_b32 s44, s44, 2
    s_lshr_b32 s36, s94, 3
    s_and_b32 s36, s36, 3
    s_waitcnt lgkmcnt(14)
    v_mfma_f32_16x16x32_bf16 v[96:99], v[136:139], a[32:35], v[96:99]
    s_add_u32 s44, s44, s36
    s_lshr_b32 s45, s94, 5
    s_and_b32 s36, s44, 3
    s_mul_i32 s36, s36, 1
    s_add_u32 s46, s45, s36
    v_mfma_f32_16x16x32_bf16 v[100:103], v[136:139], a[36:39], v[100:103]
    s_sub_u32 s36, s46, 5
    s_cmp_lt_u32 s46, 5
    s_cselect_b32 s46, s46, s36
    s_sub_u32 s36, s46, 5
    v_mfma_f32_16x16x32_bf16 v[104:107], v[136:139], a[40:43], v[104:107]
    s_cmp_lt_u32 s46, 5
    s_cselect_b32 s46, s46, s36
    s_sub_u32 s36, s46, 5
    s_cmp_lt_u32 s46, 5
    s_cselect_b32 s46, s46, s36
    v_mfma_f32_16x16x32_bf16 v[108:111], v[136:139], a[44:47], v[108:111]
    s_and_b32 s47, s45, 3
    s_mul_i32 s36, s45, 0x64
    s_mul_i32 s37, s33, 25
    s_add_u32 s36, s36, s37
    s_waitcnt lgkmcnt(12)
    v_mfma_f32_16x16x32_bf16 v[112:115], v[152:155], a[32:35], v[112:115]
    s_lshl_b32 s36, s36, 10
    s_add_u32 s24, s36, 0xcc8000
    s_add_u32 s25, s24, 0x1000
    s_mul_i32 s36, s45, 0x64
    s_mul_i32 s37, s33, 25
    v_mfma_f32_16x16x32_bf16 v[116:119], v[152:155], a[36:39], v[116:119]
    s_add_u32 s36, s36, s37
    s_lshl_b32 s36, s36, 10
    s_add_u32 s26, s36, 0xc00000
    s_add_u32 s27, s26, 0x1000
    s_waitcnt lgkmcnt(10)
    v_mfma_f32_16x16x32_bf16 v[80:83], v[120:123], a[48:51], v[80:83]
    ds_read_b64_tr_b16 v[132:133], v160 offset:51200
    ds_read_b64_tr_b16 v[134:135], v160 offset:52480
    ds_read_b64_tr_b16 v[136:137], v161 offset:51200
    ds_read_b64_tr_b16 v[138:139], v161 offset:52480
    v_mfma_f32_16x16x32_bf16 v[84:87], v[120:123], a[52:55], v[84:87]
    ds_read_b64_tr_b16 v[152:153], v165 offset:51200
    ds_read_b64_tr_b16 v[154:155], v165 offset:52480
    s_add_u32 s36, s46, 0
    s_mul_i32 s36, s36, 0x1400
    v_mfma_f32_16x16x32_bf16 v[88:91], v[120:123], a[56:59], v[88:91]
    v_lshlrev_b32 v156, 4, v190
    v_add_u32 v156, s36, v156
    s_add_u32 s36, s46, 1
    s_sub_u32 s43, s36, 5
    v_mfma_f32_16x16x32_bf16 v[92:95], v[120:123], a[60:63], v[92:95]
    s_cmp_ge_u32 s36, 5
    s_cselect_b32 s36, s43, s36
    s_mul_i32 s36, s36, 0x1400
    v_lshlrev_b32 v157, 4, v190
    s_waitcnt lgkmcnt(14)
    v_mfma_f32_16x16x32_bf16 v[96:99], v[124:127], a[48:51], v[96:99]
    v_add_u32 v157, s36, v157
    s_add_u32 s36, s46, 2
    s_sub_u32 s43, s36, 5
    s_cmp_ge_u32 s36, 5
    v_mfma_f32_16x16x32_bf16 v[100:103], v[124:127], a[52:55], v[100:103]
    s_cselect_b32 s36, s43, s36
    s_mul_i32 s36, s36, 0x1400
    v_lshlrev_b32 v158, 4, v190
    v_add_u32 v158, s36, v158
    v_mfma_f32_16x16x32_bf16 v[104:107], v[124:127], a[56:59], v[104:107]
    s_add_u32 s36, s46, 3
    s_sub_u32 s43, s36, 5
    s_cmp_ge_u32 s36, 5
    s_cselect_b32 s36, s43, s36
    v_mfma_f32_16x16x32_bf16 v[108:111], v[124:127], a[60:63], v[108:111]
    s_mul_i32 s36, s36, 0x1400
    v_lshlrev_b32 v159, 4, v190
    v_add_u32 v159, s36, v159
    s_add_u32 s36, s46, 4
    s_waitcnt lgkmcnt(12)
    v_mfma_f32_16x16x32_bf16 v[112:115], v[128:131], a[48:51], v[112:115]
    s_sub_u32 s43, s36, 5
    s_cmp_ge_u32 s36, 5
    s_cselect_b32 s36, s43, s36
    s_mul_i32 s36, s36, 0x1400
    v_mfma_f32_16x16x32_bf16 v[116:119], v[128:131], a[52:55], v[116:119]
    v_lshlrev_b32 v189, 4, v190
    v_add_u32 v189, s36, v189
    buffer_load_dwordx4 a[0:3], v156, s[16:19], s24 offen offset:0 sc1
    buffer_load_dwordx4 a[4:7], v156, s[16:19], s24 offen offset:1024 sc1
    s_waitcnt lgkmcnt(10)
    v_mfma_f32_16x16x32_bf16 v[80:83], v[140:143], a[64:67], v[80:83]
    ds_read_b64_tr_b16 v[120:121], v162 offset:40960
    v_mfma_f32_16x16x32_bf16 v[84:87], v[140:143], a[68:71], v[84:87]
    ds_read_b64_tr_b16 v[122:123], v162 offset:42240
    v_mfma_f32_16x16x32_bf16 v[88:91], v[140:143], a[72:75], v[88:91]
    ds_read_b64_tr_b16 v[124:125], v163 offset:40960
    v_mfma_f32_16x16x32_bf16 v[92:95], v[140:143], a[76:79], v[92:95]
    ds_read_b64_tr_b16 v[126:127], v163 offset:42240
    s_waitcnt lgkmcnt(12)
    v_mfma_f32_16x16x32_bf16 v[96:99], v[144:147], a[64:67], v[96:99]
    v_mfma_f32_16x16x32_bf16 v[100:103], v[144:147], a[68:71], v[100:103]
    ds_read_b64_tr_b16 v[128:129], v166 offset:40960
    v_mfma_f32_16x16x32_bf16 v[104:107], v[144:147], a[72:75], v[104:107]
    ds_read_b64_tr_b16 v[130:131], v166 offset:42240
    v_mfma_f32_16x16x32_bf16 v[108:111], v[144:147], a[76:79], v[108:111]
    buffer_load_dwordx4 a[8:11], v156, s[16:19], s24 offen offset:2048 sc1
    s_waitcnt lgkmcnt(12)
    v_mfma_f32_16x16x32_bf16 v[112:115], v[148:151], a[64:67], v[112:115]
    buffer_load_dwordx4 a[12:15], v156, s[16:19], s24 offen offset:3072 sc1
    v_mfma_f32_16x16x32_bf16 v[116:119], v[148:151], a[68:71], v[116:119]
    s_waitcnt lgkmcnt(10)
    v_mfma_f32_16x16x32_bf16 v[80:83], v[132:135], a[80:83], v[80:83]
    ds_read_b64_tr_b16 v[140:141], v162 offset:51200
    v_mfma_f32_16x16x32_bf16 v[84:87], v[132:135], a[84:87], v[84:87]
    ds_read_b64_tr_b16 v[142:143], v162 offset:52480
    v_mfma_f32_16x16x32_bf16 v[88:91], v[132:135], a[88:91], v[88:91]
    ds_read_b64_tr_b16 v[144:145], v163 offset:51200
    v_mfma_f32_16x16x32_bf16 v[92:95], v[132:135], a[92:95], v[92:95]
    ds_read_b64_tr_b16 v[146:147], v163 offset:52480
    s_waitcnt lgkmcnt(12)
    v_mfma_f32_16x16x32_bf16 v[96:99], v[136:139], a[80:83], v[96:99]
    v_mfma_f32_16x16x32_bf16 v[100:103], v[136:139], a[84:87], v[100:103]
    ds_read_b64_tr_b16 v[148:149], v166 offset:51200
    v_mfma_f32_16x16x32_bf16 v[104:107], v[136:139], a[88:91], v[104:107]
    ds_read_b64_tr_b16 v[150:151], v166 offset:52480
    v_mfma_f32_16x16x32_bf16 v[108:111], v[136:139], a[92:95], v[108:111]
    buffer_load_dwordx4 a[16:19], v156, s[16:19], s25 offen offset:0 sc1
    s_waitcnt lgkmcnt(12)
    v_mfma_f32_16x16x32_bf16 v[112:115], v[152:155], a[80:83], v[112:115]
    buffer_load_dwordx4 a[20:23], v157, s[16:19], s24 offen offset:0 sc1
    v_mfma_f32_16x16x32_bf16 v[116:119], v[152:155], a[84:87], v[116:119]
    s_waitcnt vmcnt(7)
    s_barrier
    s_waitcnt lgkmcnt(10)
    v_mfma_f32_16x16x32_bf16 v[80:83], v[120:123], a[96:99], v[80:83]
    ds_read_b64_tr_b16 v[132:133], v160 offset:0
    ds_read_b64_tr_b16 v[134:135], v160 offset:1280
    v_mfma_f32_16x16x32_bf16 v[84:87], v[120:123], a[100:103], v[84:87]
    ds_read_b64_tr_b16 v[136:137], v161 offset:0
    ds_read_b64_tr_b16 v[138:139], v161 offset:1280
    v_mfma_f32_16x16x32_bf16 v[88:91], v[120:123], a[104:107], v[88:91]
    ds_read_b64_tr_b16 v[152:153], v165 offset:0
    ds_read_b64_tr_b16 v[154:155], v165 offset:1280
    v_mfma_f32_16x16x32_bf16 v[92:95], v[120:123], a[108:111], v[92:95]
    s_lshr_b32 s36, s94, 4
    s_lshl_b32 s36, s36, 7
    s_waitcnt lgkmcnt(14)
    v_mfma_f32_16x16x32_bf16 v[96:99], v[124:127], a[96:99], v[96:99]
    s_and_b32 s37, s94, 15
    s_lshl_b32 s37, s37, 2
    v_mfma_f32_16x16x32_bf16 v[100:103], v[124:127], a[100:103], v[100:103]
    s_add_u32 s36, s36, s37
    s_add_u32 s36, s36, 0xb01000
    v_mfma_f32_16x16x32_bf16 v[104:107], v[124:127], a[104:107], v[104:107]
    v_mov_b32 v180, s36
    v_mov_b32 v181, s91
    v_mfma_f32_16x16x32_bf16 v[108:111], v[124:127], a[108:111], v[108:111]
    v_cmp_eq_u32 vcc, 0, v191
    s_nop 1
    v_cndmask_b32 v180, v181, v180, vcc
    s_waitcnt lgkmcnt(12)
    v_mfma_f32_16x16x32_bf16 v[112:115], v[128:131], a[96:99], v[112:115]
    v_mov_b32 v181, s28
    buffer_store_dword v181, v180, s[16:19], 0 offen sc1
    v_mfma_f32_16x16x32_bf16 v[116:119], v[128:131], a[100:103], v[116:119]
    buffer_load_dwordx4 a[24:27], v157, s[16:19], s24 offen offset:1024 sc1
    buffer_load_dwordx4 a[28:31], v157, s[16:19], s24 offen offset:2048 sc1
    s_waitcnt lgkmcnt(10)
    v_mfma_f32_16x16x32_bf16 v[80:83], v[140:143], a[112:115], v[80:83]
    ds_read_b64_tr_b16 v[120:121], v160 offset:10240
    v_mfma_f32_16x16x32_bf16 v[84:87], v[140:143], a[116:119], v[84:87]
    ds_read_b64_tr_b16 v[122:123], v160 offset:11520
    v_mfma_f32_16x16x32_bf16 v[88:91], v[140:143], a[120:123], v[88:91]
    ds_read_b64_tr_b16 v[124:125], v161 offset:10240
    v_mfma_f32_16x16x32_bf16 v[92:95], v[140:143], a[124:127], v[92:95]
    ds_read_b64_tr_b16 v[126:127], v161 offset:11520
    s_waitcnt lgkmcnt(12)
    v_mfma_f32_16x16x32_bf16 v[96:99], v[144:147], a[112:115], v[96:99]
    v_mfma_f32_16x16x32_bf16 v[100:103], v[144:147], a[116:119], v[100:103]
    ds_read_b64_tr_b16 v[128:129], v165 offset:10240
    v_mfma_f32_16x16x32_bf16 v[104:107], v[144:147], a[120:123], v[104:107]
    ds_read_b64_tr_b16 v[130:131], v165 offset:11520
    v_mfma_f32_16x16x32_bf16 v[108:111], v[144:147], a[124:127], v[108:111]
    buffer_load_dwordx4 a[32:35], v157, s[16:19], s24 offen offset:3072 sc1
    s_waitcnt lgkmcnt(12)
    v_mfma_f32_16x16x32_bf16 v[112:115], v[148:151], a[112:115], v[112:115]
    buffer_load_dwordx4 a[36:39], v157, s[16:19], s25 offen offset:0 sc1
    v_mfma_f32_16x16x32_bf16 v[116:119], v[148:151], a[116:119], v[116:119]
    s_waitcnt lgkmcnt(10)
    v_mfma_f32_16x16x32_bf16 v[80:83], v[132:135], a[128:131], v[80:83]
    ds_read_b64_tr_b16 v[140:141], v162 offset:0
    v_mfma_f32_16x16x32_bf16 v[84:87], v[132:135], a[132:135], v[84:87]
    ds_read_b64_tr_b16 v[142:143], v162 offset:1280
    v_mfma_f32_16x16x32_bf16 v[88:91], v[132:135], a[136:139], v[88:91]
    ds_read_b64_tr_b16 v[144:145], v163 offset:0
    v_mfma_f32_16x16x32_bf16 v[92:95], v[132:135], a[140:143], v[92:95]
    ds_read_b64_tr_b16 v[146:147], v163 offset:1280
    s_waitcnt lgkmcnt(12)
    v_mfma_f32_16x16x32_bf16 v[96:99], v[136:139], a[128:131], v[96:99]
    v_mfma_f32_16x16x32_bf16 v[100:103], v[136:139], a[132:135], v[100:103]
    ds_read_b64_tr_b16 v[148:149], v166 offset:0
    v_mfma_f32_16x16x32_bf16 v[104:107], v[136:139], a[136:139], v[104:107]
    ds_read_b64_tr_b16 v[150:151], v166 offset:1280
    v_mfma_f32_16x16x32_bf16 v[108:111], v[136:139], a[140:143], v[108:111]
    buffer_load_dwordx4 a[40:43], v158, s[16:19], s24 offen offset:0 sc1
    s_waitcnt lgkmcnt(12)
    v_mfma_f32_16x16x32_bf16 v[112:115], v[152:155], a[128:131], v[112:115]
    buffer_load_dwordx4 a[44:47], v158, s[16:19], s24 offen offset:1024 sc1
    v_mfma_f32_16x16x32_bf16 v[116:119], v[152:155], a[132:135], v[116:119]
    s_waitcnt lgkmcnt(10)
    v_mfma_f32_16x16x32_bf16 v[80:83], v[120:123], a[144:147], v[80:83]
    ds_read_b64_tr_b16 v[132:133], v162 offset:10240
    v_mfma_f32_16x16x32_bf16 v[84:87], v[120:123], a[148:151], v[84:87]
    ds_read_b64_tr_b16 v[134:135], v162 offset:11520
    v_mfma_f32_16x16x32_bf16 v[88:91], v[120:123], a[152:155], v[88:91]
    ds_read_b64_tr_b16 v[136:137], v163 offset:10240
    v_mfma_f32_16x16x32_bf16 v[92:95], v[120:123], a[156:159], v[92:95]
    ds_read_b64_tr_b16 v[138:139], v163 offset:11520
    s_waitcnt lgkmcnt(12)
    v_mfma_f32_16x16x32_bf16 v[96:99], v[124:127], a[144:147], v[96:99]
    v_mfma_f32_16x16x32_bf16 v[100:103], v[124:127], a[148:151], v[100:103]
    ds_read_b64_tr_b16 v[152:153], v166 offset:10240
    v_mfma_f32_16x16x32_bf16 v[104:107], v[124:127], a[152:155], v[104:107]
    ds_read_b64_tr_b16 v[154:155], v166 offset:11520
    v_mfma_f32_16x16x32_bf16 v[108:111], v[124:127], a[156:159], v[108:111]
    buffer_load_dwordx4 a[48:51], v158, s[16:19], s24 offen offset:2048 sc1
    s_waitcnt lgkmcnt(12)
    v_mfma_f32_16x16x32_bf16 v[112:115], v[128:131], a[144:147], v[112:115]
    buffer_load_dwordx4 a[52:55], v158, s[16:19], s24 offen offset:3072 sc1
    v_mfma_f32_16x16x32_bf16 v[116:119], v[128:131], a[148:151], v[116:119]
    s_barrier
    s_waitcnt lgkmcnt(10)
    v_mfma_f32_16x16x32_bf16 v[80:83], v[140:143], a[160:163], v[80:83]
    v_add_u32 v160, 0x1e000, v160
    v_add_u32 v161, 0x1e000, v161
    v_mfma_f32_16x16x32_bf16 v[84:87], v[140:143], a[164:167], v[84:87]
    v_add_u32 v165, 0x1e000, v165
    v_mfma_f32_16x16x32_bf16 v[88:91], v[140:143], a[168:171], v[88:91]
    v_add_u32 v162, 0x1e000, v162
    v_add_u32 v163, 0x1e000, v163
    v_mfma_f32_16x16x32_bf16 v[92:95], v[140:143], a[172:175], v[92:95]
    v_add_u32 v166, 0x1e000, v166
    s_waitcnt lgkmcnt(8)
    v_mfma_f32_16x16x32_bf16 v[96:99], v[144:147], a[160:163], v[96:99]
    ds_read_b64_tr_b16 v[120:121], v160 offset:0
    v_mfma_f32_16x16x32_bf16 v[100:103], v[144:147], a[164:167], v[100:103]
    ds_read_b64_tr_b16 v[122:123], v160 offset:1280
    ds_read_b64_tr_b16 v[124:125], v161 offset:0
    v_mfma_f32_16x16x32_bf16 v[104:107], v[144:147], a[168:171], v[104:107]
    ds_read_b64_tr_b16 v[126:127], v161 offset:1280
    v_mfma_f32_16x16x32_bf16 v[108:111], v[144:147], a[172:175], v[108:111]
    ds_read_b64_tr_b16 v[128:129], v165 offset:0
    ds_read_b64_tr_b16 v[130:131], v165 offset:1280
    s_waitcnt lgkmcnt(12)
    v_mfma_f32_16x16x32_bf16 v[112:115], v[148:151], a[160:163], v[112:115]
    buffer_load_dwordx4 a[56:59], v158, s[16:19], s25 offen offset:0 sc1
    v_mfma_f32_16x16x32_bf16 v[116:119], v[148:151], a[164:167], v[116:119]
    buffer_load_dwordx4 a[60:63], v159, s[16:19], s24 offen offset:0 sc1
    s_waitcnt lgkmcnt(10)
    v_mfma_f32_16x16x32_bf16 v[80:83], v[132:135], a[176:179], v[80:83]
    ds_read_b64_tr_b16 v[140:141], v160 offset:10240
    v_mfma_f32_16x16x32_bf16 v[84:87], v[132:135], a[180:183], v[84:87]
    ds_read_b64_tr_b16 v[142:143], v160 offset:11520
    v_mfma_f32_16x16x32_bf16 v[88:91], v[132:135], a[184:187], v[88:91]
    ds_read_b64_tr_b16 v[144:145], v161 offset:10240
    v_mfma_f32_16x16x32_bf16 v[92:95], v[132:135], a[188:191], v[92:95]
    ds_read_b64_tr_b16 v[146:147], v161 offset:11520
    s_waitcnt lgkmcnt(12)
    v_mfma_f32_16x16x32_bf16 v[96:99], v[136:139], a[176:179], v[96:99]
    ds_read_b64_tr_b16 v[148:149], v165 offset:10240
    v_mfma_f32_16x16x32_bf16 v[100:103], v[136:139], a[180:183], v[100:103]
    ds_read_b64_tr_b16 v[150:151], v165 offset:11520
    v_mfma_f32_16x16x32_bf16 v[104:107], v[136:139], a[184:187], v[104:107]
    s_lshl_b32 s36, s32, 1
    s_add_u32 s36, s36, s35
    s_lshl_b32 s36, s36, 1
    s_add_u32 s36, s36, s34
    s_lshl_b32 s36, s36, 4
    s_lshl_b32 s36, s36, 10
    s_add_u32 s37, s36, 0x900000
    v_lshlrev_b32 v186, 4, v190
    v_mfma_f32_16x16x32_bf16 v[108:111], v[136:139], a[188:191], v[108:111]
    buffer_load_dwordx4 v[0:3], v186, s[16:19], s37 offen offset:0 sc1
    s_waitcnt lgkmcnt(12)
    v_mfma_f32_16x16x32_bf16 v[112:115], v[152:155], a[176:179], v[112:115]
    buffer_load_dwordx4 v[4:7], v186, s[16:19], s37 offen offset:1024 sc1
    v_mfma_f32_16x16x32_bf16 v[116:119], v[152:155], a[180:183], v[116:119]
    s_waitcnt lgkmcnt(10)
    v_mfma_f32_16x16x32_bf16 v[80:83], v[120:123], a[192:195], v[80:83]
    ds_read_b64_tr_b16 v[132:133], v162 offset:0
    v_mfma_f32_16x16x32_bf16 v[84:87], v[120:123], a[196:199], v[84:87]
    ds_read_b64_tr_b16 v[134:135], v162 offset:1280
    v_mfma_f32_16x16x32_bf16 v[88:91], v[120:123], a[200:203], v[88:91]
    ds_read_b64_tr_b16 v[136:137], v163 offset:0
    v_mfma_f32_16x16x32_bf16 v[92:95], v[120:123], a[204:207], v[92:95]
    ds_read_b64_tr_b16 v[138:139], v163 offset:1280
    s_waitcnt lgkmcnt(12)
    v_mfma_f32_16x16x32_bf16 v[96:99], v[124:127], a[192:195], v[96:99]
    v_mfma_f32_16x16x32_bf16 v[100:103], v[124:127], a[196:199], v[100:103]
    ds_read_b64_tr_b16 v[152:153], v166 offset:0
    v_mfma_f32_16x16x32_bf16 v[104:107], v[124:127], a[200:203], v[104:107]
    ds_read_b64_tr_b16 v[154:155], v166 offset:1280
    v_mfma_f32_16x16x32_bf16 v[108:111], v[124:127], a[204:207], v[108:111]
    buffer_load_dwordx4 v[8:11], v186, s[16:19], s37 offen offset:2048 sc1
    s_waitcnt lgkmcnt(12)
    v_mfma_f32_16x16x32_bf16 v[112:115], v[128:131], a[192:195], v[112:115]
    buffer_load_dwordx4 v[12:15], v186, s[16:19], s37 offen offset:3072 sc1
    v_mfma_f32_16x16x32_bf16 v[116:119], v[128:131], a[196:199], v[116:119]
    s_waitcnt lgkmcnt(10)
    v_mfma_f32_16x16x32_bf16 v[80:83], v[140:143], a[208:211], v[80:83]
    ds_read_b64_tr_b16 v[120:121], v162 offset:10240
    v_mfma_f32_16x16x32_bf16 v[84:87], v[140:143], a[212:215], v[84:87]
    ds_read_b64_tr_b16 v[122:123], v162 offset:11520
    v_mfma_f32_16x16x32_bf16 v[88:91], v[140:143], a[216:219], v[88:91]
    ds_read_b64_tr_b16 v[124:125], v163 offset:10240
    v_mfma_f32_16x16x32_bf16 v[92:95], v[140:143], a[220:223], v[92:95]
    ds_read_b64_tr_b16 v[126:127], v163 offset:11520
    s_waitcnt lgkmcnt(12)
    v_mfma_f32_16x16x32_bf16 v[96:99], v[144:147], a[208:211], v[96:99]
    v_mfma_f32_16x16x32_bf16 v[100:103], v[144:147], a[212:215], v[100:103]
    ds_read_b64_tr_b16 v[128:129], v166 offset:10240
    v_mfma_f32_16x16x32_bf16 v[104:107], v[144:147], a[216:219], v[104:107]
    ds_read_b64_tr_b16 v[130:131], v166 offset:11520
    v_mfma_f32_16x16x32_bf16 v[108:111], v[144:147], a[220:223], v[108:111]
    s_add_u32 s37, s37, 0x1000
    buffer_load_dwordx4 v[16:19], v186, s[16:19], s37 offen offset:0 sc1
    s_waitcnt lgkmcnt(12)
    v_mfma_f32_16x16x32_bf16 v[112:115], v[148:151], a[208:211], v[112:115]
    buffer_load_dwordx4 v[20:23], v186, s[16:19], s37 offen offset:1024 sc1
    v_mfma_f32_16x16x32_bf16 v[116:119], v[148:151], a[212:215], v[116:119]
    s_waitcnt lgkmcnt(10)
    v_mfma_f32_16x16x32_bf16 v[80:83], v[132:135], a[224:227], v[80:83]
    ds_read_b64_tr_b16 v[140:141], v160 offset:20480
    v_mfma_f32_16x16x32_bf16 v[84:87], v[132:135], a[228:231], v[84:87]
    ds_read_b64_tr_b16 v[142:143], v160 offset:21760
    v_mfma_f32_16x16x32_bf16 v[88:91], v[132:135], a[232:235], v[88:91]
    ds_read_b64_tr_b16 v[144:145], v161 offset:20480
    v_mfma_f32_16x16x32_bf16 v[92:95], v[132:135], a[236:239], v[92:95]
    ds_read_b64_tr_b16 v[146:147], v161 offset:21760
    s_waitcnt lgkmcnt(12)
    v_mfma_f32_16x16x32_bf16 v[96:99], v[136:139], a[224:227], v[96:99]
    v_mfma_f32_16x16x32_bf16 v[100:103], v[136:139], a[228:231], v[100:103]
    ds_read_b64_tr_b16 v[148:149], v165 offset:20480
    v_mfma_f32_16x16x32_bf16 v[104:107], v[136:139], a[232:235], v[104:107]
    ds_read_b64_tr_b16 v[150:151], v165 offset:21760
    v_mfma_f32_16x16x32_bf16 v[108:111], v[136:139], a[236:239], v[108:111]
    buffer_load_dwordx4 v[24:27], v186, s[16:19], s37 offen offset:2048 sc1
    s_waitcnt lgkmcnt(12)
    v_mfma_f32_16x16x32_bf16 v[112:115], v[152:155], a[224:227], v[112:115]
    buffer_load_dwordx4 v[28:31], v186, s[16:19], s37 offen offset:3072 sc1
    v_mfma_f32_16x16x32_bf16 v[116:119], v[152:155], a[228:231], v[116:119]
    s_waitcnt lgkmcnt(10)
    v_mfma_f32_16x16x32_bf16 v[80:83], v[120:123], a[240:243], v[80:83]
    ds_read_b64_tr_b16 v[132:133], v160 offset:30720
    v_mfma_f32_16x16x32_bf16 v[84:87], v[120:123], a[244:247], v[84:87]
    ds_read_b64_tr_b16 v[134:135], v160 offset:32000
    v_mfma_f32_16x16x32_bf16 v[88:91], v[120:123], a[248:251], v[88:91]
    ds_read_b64_tr_b16 v[136:137], v161 offset:30720
    v_mfma_f32_16x16x32_bf16 v[92:95], v[120:123], a[252:255], v[92:95]
    ds_read_b64_tr_b16 v[138:139], v161 offset:32000
    s_waitcnt lgkmcnt(12)
    v_mfma_f32_16x16x32_bf16 v[96:99], v[124:127], a[240:243], v[96:99]
    v_mfma_f32_16x16x32_bf16 v[100:103], v[124:127], a[244:247], v[100:103]
    ds_read_b64_tr_b16 v[152:153], v165 offset:30720
    v_mfma_f32_16x16x32_bf16 v[104:107], v[124:127], a[248:251], v[104:107]
    ds_read_b64_tr_b16 v[154:155], v165 offset:32000
    v_mfma_f32_16x16x32_bf16 v[108:111], v[124:127], a[252:255], v[108:111]
    s_add_u32 s37, s37, 0x1000
    buffer_load_dwordx4 v[32:35], v186, s[16:19], s37 offen offset:0 sc1
    s_waitcnt lgkmcnt(12)
    v_mfma_f32_16x16x32_bf16 v[112:115], v[128:131], a[240:243], v[112:115]
    buffer_load_dwordx4 v[36:39], v186, s[16:19], s37 offen offset:1024 sc1
    v_mfma_f32_16x16x32_bf16 v[116:119], v[128:131], a[244:247], v[116:119]
    s_waitcnt lgkmcnt(10)
    v_mfma_f32_16x16x32_bf16 v[80:83], v[140:143], v[192:195], v[80:83]
    ds_read_b64_tr_b16 v[120:121], v162 offset:20480
    v_mfma_f32_16x16x32_bf16 v[84:87], v[140:143], v[196:199], v[84:87]
    ds_read_b64_tr_b16 v[122:123], v162 offset:21760
    v_mfma_f32_16x16x32_bf16 v[88:91], v[140:143], v[200:203], v[88:91]
    ds_read_b64_tr_b16 v[124:125], v163 offset:20480
    v_mfma_f32_16x16x32_bf16 v[92:95], v[140:143], v[204:207], v[92:95]
    ds_read_b64_tr_b16 v[126:127], v163 offset:21760
    s_waitcnt lgkmcnt(12)
    v_mfma_f32_16x16x32_bf16 v[96:99], v[144:147], v[192:195], v[96:99]
    v_mfma_f32_16x16x32_bf16 v[100:103], v[144:147], v[196:199], v[100:103]
    ds_read_b64_tr_b16 v[128:129], v166 offset:20480
    v_mfma_f32_16x16x32_bf16 v[104:107], v[144:147], v[200:203], v[104:107]
    ds_read_b64_tr_b16 v[130:131], v166 offset:21760
    v_mfma_f32_16x16x32_bf16 v[108:111], v[144:147], v[204:207], v[108:111]
    buffer_load_dwordx4 v[40:43], v186, s[16:19], s37 offen offset:2048 sc1
    s_waitcnt lgkmcnt(12)
    v_mfma_f32_16x16x32_bf16 v[112:115], v[148:151], v[192:195], v[112:115]
    buffer_load_dwordx4 v[44:47], v186, s[16:19], s37 offen offset:3072 sc1
    v_mfma_f32_16x16x32_bf16 v[116:119], v[148:151], v[196:199], v[116:119]
    s_waitcnt lgkmcnt(10)
    v_mfma_f32_16x16x32_bf16 v[80:83], v[132:135], v[208:211], v[80:83]
    ds_read_b64_tr_b16 v[140:141], v162 offset:30720
    v_mfma_f32_16x16x32_bf16 v[84:87], v[132:135], v[212:215], v[84:87]
    ds_read_b64_tr_b16 v[142:143], v162 offset:32000
    v_mfma_f32_16x16x32_bf16 v[88:91], v[132:135], v[216:219], v[88:91]
    ds_read_b64_tr_b16 v[144:145], v163 offset:30720
    v_mfma_f32_16x16x32_bf16 v[92:95], v[132:135], v[220:223], v[92:95]
    ds_read_b64_tr_b16 v[146:147], v163 offset:32000
    s_waitcnt lgkmcnt(12)
    v_mfma_f32_16x16x32_bf16 v[96:99], v[136:139], v[208:211], v[96:99]
    v_mfma_f32_16x16x32_bf16 v[100:103], v[136:139], v[212:215], v[100:103]
    ds_read_b64_tr_b16 v[148:149], v166 offset:30720
    v_mfma_f32_16x16x32_bf16 v[104:107], v[136:139], v[216:219], v[104:107]
    ds_read_b64_tr_b16 v[150:151], v166 offset:32000
    v_mfma_f32_16x16x32_bf16 v[108:111], v[136:139], v[220:223], v[108:111]
    s_add_u32 s37, s37, 0x1000
    buffer_load_dwordx4 v[48:51], v186, s[16:19], s37 offen offset:0 sc1
    s_waitcnt lgkmcnt(12)
    v_mfma_f32_16x16x32_bf16 v[112:115], v[152:155], v[208:211], v[112:115]
    buffer_load_dwordx4 v[52:55], v186, s[16:19], s37 offen offset:1024 sc1
    v_mfma_f32_16x16x32_bf16 v[116:119], v[152:155], v[212:215], v[116:119]
    s_waitcnt lgkmcnt(10)
    v_mfma_f32_16x16x32_bf16 v[80:83], v[120:123], v[224:227], v[80:83]
    buffer_load_dwordx4 v[56:59], v186, s[16:19], s37 offen offset:2048 sc1
    v_mfma_f32_16x16x32_bf16 v[84:87], v[120:123], v[228:231], v[84:87]
    v_mfma_f32_16x16x32_bf16 v[88:91], v[120:123], v[232:235], v[88:91]
    v_mfma_f32_16x16x32_bf16 v[92:95], v[120:123], v[236:239], v[92:95]
    s_waitcnt lgkmcnt(8)
    v_mfma_f32_16x16x32_bf16 v[96:99], v[124:127], v[224:227], v[96:99]
    v_mfma_f32_16x16x32_bf16 v[100:103], v[124:127], v[228:231], v[100:103]
    buffer_load_dwordx4 v[60:63], v186, s[16:19], s37 offen offset:3072 sc1
    v_mfma_f32_16x16x32_bf16 v[104:107], v[124:127], v[232:235], v[104:107]
    v_mfma_f32_16x16x32_bf16 v[108:111], v[124:127], v[236:239], v[108:111]
    s_waitcnt lgkmcnt(6)
    v_mfma_f32_16x16x32_bf16 v[112:115], v[128:131], v[224:227], v[112:115]
    v_mfma_f32_16x16x32_bf16 v[116:119], v[128:131], v[228:231], v[116:119]
    s_waitcnt lgkmcnt(4)
    v_mfma_f32_16x16x32_bf16 v[80:83], v[140:143], v[240:243], v[80:83]
    buffer_load_dwordx4 a[64:67], v159, s[16:19], s24 offen offset:1024 sc1
    v_mfma_f32_16x16x32_bf16 v[84:87], v[140:143], v[244:247], v[84:87]
    v_mfma_f32_16x16x32_bf16 v[88:91], v[140:143], v[248:251], v[88:91]
    v_mfma_f32_16x16x32_bf16 v[92:95], v[140:143], v[252:255], v[92:95]
    s_waitcnt lgkmcnt(2)
    v_mfma_f32_16x16x32_bf16 v[96:99], v[144:147], v[240:243], v[96:99]
    v_mfma_f32_16x16x32_bf16 v[100:103], v[144:147], v[244:247], v[100:103]
    buffer_load_dwordx4 a[68:71], v159, s[16:19], s24 offen offset:2048 sc1
    v_mfma_f32_16x16x32_bf16 v[104:107], v[144:147], v[248:251], v[104:107]
    v_mfma_f32_16x16x32_bf16 v[108:111], v[144:147], v[252:255], v[108:111]
    s_waitcnt lgkmcnt(0)
    v_mfma_f32_16x16x32_bf16 v[112:115], v[148:151], v[240:243], v[112:115]
    v_mfma_f32_16x16x32_bf16 v[116:119], v[148:151], v[244:247], v[116:119]
    v_mov_b32 v192, 0
    v_mov_b32 v193, 0
    v_mov_b32 v196, 0
    v_mov_b32 v197, 0
    v_bfe_u32 v182, v190, 2, 2
    v_lshrrev_b32 v183, 4, v190
    v_cmp_eq_u32 vcc, v182, v183
    v_and_b32 v182, 1, v190
    v_lshlrev_b32 v182, 4, v182
    v_mov_b32 v183, 0x3f80
    v_lshlrev_b32 v183, v182, v183
    v_cndmask_b32 v183, 0, v183, vcc
    v_and_b32 v182, 2, v190
    v_cmp_eq_u32 vcc, 0, v182
    s_nop 1
    v_cndmask_b32 v194, 0, v183, vcc
    v_cndmask_b32 v195, v183, 0, vcc
    v_mul_f32 v160, s88, v112
    v_mul_f32 v161, s88, v113
    v_mul_f32 v162, s88, v114
    v_mul_f32 v163, s88, v115
    buffer_load_dwordx4 a[72:75], v159, s[16:19], s24 offen offset:3072 sc1
    v_mul_f32 v164, s88, v116
    v_mul_f32 v165, s88, v117
    v_mul_f32 v166, s88, v118
    v_mul_f32 v171, s88, v119
    v_exp_f32 v160, v160 clamp
    v_exp_f32 v161, v161 clamp
    v_exp_f32 v162, v162 clamp
    v_exp_f32 v163, v163 clamp
    v_exp_f32 v164, v164 clamp
    v_exp_f32 v165, v165 clamp
    v_exp_f32 v166, v166 clamp
    v_exp_f32 v171, v171 clamp
    v_max_f32 v112, s89, v112
    s_waitcnt vmcnt(18)
    v_mfma_f32_16x16x32_bf16 v[200:203], v[194:197], v[0:3], 0
    v_max_f32 v113, s89, v113
    v_max_f32 v114, s89, v114
    v_mfma_f32_16x16x32_bf16 v[204:207], v[192:195], v[0:3], 0
    buffer_load_dwordx4 a[76:79], v159, s[16:19], s25 offen offset:0 sc1
    v_max_f32 v115, s89, v115
    v_max_f32 v116, s89, v116
    s_waitcnt vmcnt(18)
    v_mfma_f32_16x16x32_bf16 v[208:211], v[194:197], v[4:7], 0
    v_max_f32 v117, s89, v117
    v_max_f32 v118, s89, v118
    v_mfma_f32_16x16x32_bf16 v[212:215], v[192:195], v[4:7], 0
    v_max_f32 v119, s89, v119
    v_add_f32 v112, v112, v160
    s_waitcnt vmcnt(17)
    v_mfma_f32_16x16x32_bf16 v[200:203], v[194:197], v[8:11], v[200:203]
    v_add_f32 v113, v113, v161
    v_add_f32 v114, v114, v162
    buffer_load_dwordx4 a[80:83], v189, s[16:19], s24 offen offset:0 sc1
    v_mfma_f32_16x16x32_bf16 v[204:207], v[192:195], v[8:11], v[204:207]
    v_add_f32 v115, v115, v163
    v_add_f32 v116, v116, v164
    s_waitcnt vmcnt(17)
    v_mfma_f32_16x16x32_bf16 v[208:211], v[194:197], v[12:15], v[208:211]
    v_add_f32 v117, v117, v165
    v_add_f32 v118, v118, v166
    v_mfma_f32_16x16x32_bf16 v[212:215], v[192:195], v[12:15], v[212:215]
    v_add_f32 v119, v119, v171
    v_cvt_pk_bf16_f32 v122, v112, v113
    v_cvt_pk_bf16_f32 v123, v114, v115
    s_waitcnt vmcnt(16)
    v_mfma_f32_16x16x32_bf16 v[200:203], v[194:197], v[16:19], v[200:203]
    buffer_load_dwordx4 a[84:87], v189, s[16:19], s24 offen offset:1024 sc1
    v_cvt_pk_bf16_f32 v138, v112, v113
    v_cvt_pk_bf16_f32 v139, v114, v115
    v_mfma_f32_16x16x32_bf16 v[204:207], v[192:195], v[16:19], v[204:207]
    v_cvt_pk_bf16_f32 v126, v116, v117
    v_cvt_pk_bf16_f32 v127, v118, v119
    s_waitcnt vmcnt(16)
    v_mfma_f32_16x16x32_bf16 v[208:211], v[194:197], v[20:23], v[208:211]
    v_cvt_pk_bf16_f32 v142, v116, v117
    v_cvt_pk_bf16_f32 v143, v118, v119
    v_mfma_f32_16x16x32_bf16 v[212:215], v[192:195], v[20:23], v[212:215]
    v_lshlrev_b32 v180, 3, v190
    v_add_u32 v181, 0x100, v180
    buffer_load_dwordx4 a[88:91], v189, s[16:19], s24 offen offset:2048 sc1
    s_waitcnt vmcnt(16)
    v_mfma_f32_16x16x32_bf16 v[200:203], v[194:197], v[24:27], v[200:203]
    v_and_b32 v181, 0x1ff, v181
    s_lshl_b32 s36, s33, 10
    v_mfma_f32_16x16x32_bf16 v[204:207], v[192:195], v[24:27], v[204:207]
    s_add_u32 s36, s36, 0x13000
    s_xor_b32 s37, s33, 1
    s_waitcnt vmcnt(15)
    v_mfma_f32_16x16x32_bf16 v[208:211], v[194:197], v[28:31], v[208:211]
    s_lshl_b32 s37, s37, 10
    s_add_u32 s37, s37, 0x13000
    v_mfma_f32_16x16x32_bf16 v[212:215], v[192:195], v[28:31], v[212:215]
    buffer_load_dwordx4 a[92:95], v189, s[16:19], s24 offen offset:3072 sc1
    v_add_u32 v180, s36, v180
    v_add_u32 v181, s37, v181
    ds_write_b64 v180, v[122:123] offset:0
    s_waitcnt vmcnt(15)
    v_mfma_f32_16x16x32_bf16 v[200:203], v[194:197], v[32:35], v[200:203]
    ds_write_b64 v180, v[126:127] offset:512
    v_mul_f32 v160, s88, v80
    v_mfma_f32_16x16x32_bf16 v[204:207], v[192:195], v[32:35], v[204:207]
    v_mul_f32 v161, s88, v81
    v_mul_f32 v162, s88, v82
    s_waitcnt vmcnt(14)
    v_mfma_f32_16x16x32_bf16 v[208:211], v[194:197], v[36:39], v[208:211]
    v_mul_f32 v163, s88, v83
    buffer_load_dwordx4 a[96:99], v189, s[16:19], s25 offen offset:0 sc1
    v_mul_f32 v164, s88, v96
    v_mfma_f32_16x16x32_bf16 v[212:215], v[192:195], v[36:39], v[212:215]
    v_mul_f32 v165, s88, v97
    v_mul_f32 v166, s88, v98
    s_waitcnt vmcnt(14)
    v_mfma_f32_16x16x32_bf16 v[200:203], v[194:197], v[40:43], v[200:203]
    v_mul_f32 v171, s88, v99
    v_exp_f32 v160, v160 clamp
    v_mfma_f32_16x16x32_bf16 v[204:207], v[192:195], v[40:43], v[204:207]
    v_exp_f32 v161, v161 clamp
    v_exp_f32 v162, v162 clamp
    s_waitcnt vmcnt(13)
    v_mfma_f32_16x16x32_bf16 v[208:211], v[194:197], v[44:47], v[208:211]
    buffer_load_dwordx4 a[100:103], v156, s[16:19], s26 offen offset:0 sc1
    v_exp_f32 v163, v163 clamp
    v_exp_f32 v164, v164 clamp
    v_mfma_f32_16x16x32_bf16 v[212:215], v[192:195], v[44:47], v[212:215]
    v_exp_f32 v165, v165 clamp
    v_exp_f32 v166, v166 clamp
    v_exp_f32 v171, v171 clamp
    s_waitcnt vmcnt(13)
    v_mfma_f32_16x16x32_bf16 v[200:203], v[194:197], v[48:51], v[200:203]
    v_max_f32 v80, s89, v80
    v_max_f32 v81, s89, v81
    v_mfma_f32_16x16x32_bf16 v[204:207], v[192:195], v[48:51], v[204:207]
    v_max_f32 v82, s89, v82
    buffer_load_dwordx4 a[104:107], v156, s[16:19], s26 offen offset:1024 sc1
    v_max_f32 v83, s89, v83
    s_waitcnt vmcnt(13)
    v_mfma_f32_16x16x32_bf16 v[208:211], v[194:197], v[52:55], v[208:211]
    v_max_f32 v96, s89, v96
    v_max_f32 v97, s89, v97
    v_mfma_f32_16x16x32_bf16 v[212:215], v[192:195], v[52:55], v[212:215]
    v_max_f32 v98, s89, v98
    v_max_f32 v99, s89, v99
    s_waitcnt vmcnt(12)
    v_mfma_f32_16x16x32_bf16 v[200:203], v[194:197], v[56:59], v[200:203]
    v_add_f32 v80, v80, v160
    v_add_f32 v81, v81, v161
    v_mfma_f32_16x16x32_bf16 v[204:207], v[192:195], v[56:59], v[204:207]
    buffer_load_dwordx4 a[108:111], v156, s[16:19], s26 offen offset:2048 sc1
    v_add_f32 v82, v82, v162
    v_add_f32 v83, v83, v163
    s_waitcnt vmcnt(12)
    v_mfma_f32_16x16x32_bf16 v[208:211], v[194:197], v[60:63], v[208:211]
    v_add_f32 v96, v96, v164
    v_add_f32 v97, v97, v165
    v_mfma_f32_16x16x32_bf16 v[212:215], v[192:195], v[60:63], v[212:215]
    v_add_f32 v98, v98, v166
    v_add_f32 v99, v99, v171
    v_max3_u32 v185, v0, v2, v4
    v_max3_u32 v185, v185, v6, v8
    v_max3_u32 v185, v185, v10, v12
    v_max3_u32 v185, v185, v14, v16
    v_max3_u32 v185, v185, v18, v20
    v_max3_u32 v185, v185, v22, v24
    buffer_load_dwordx4 a[112:115], v156, s[16:19], s26 offen offset:3072 sc1
    v_max3_u32 v185, v185, v26, v28
    v_max3_u32 v185, v185, v30, v32
    v_max3_u32 v185, v185, v34, v36
    v_max3_u32 v185, v185, v38, v40
    v_max3_u32 v185, v185, v42, v44
    v_max3_u32 v185, v185, v46, v48
    v_max3_u32 v185, v185, v50, v52
    v_max3_u32 v185, v185, v54, v56
    v_max3_u32 v185, v185, v58, v60
    v_max_u32 v185, v185, v62
    v_cmp_eq_u32 vcc, -1, v185
    s_nop 4
    s_cbranch_vccz Lpad_7
    s_mov_b32 s43, 0
Lpa_8:
    s_lshl_b32 s36, s32, 1
    s_add_u32 s36, s36, s35
    s_lshl_b32 s36, s36, 1
    s_add_u32 s36, s36, s34
    s_lshl_b32 s36, s36, 4
    s_lshl_b32 s36, s36, 10
    s_add_u32 s36, s36, 0x900000
    v_lshlrev_b32 v186, 4, v190
    buffer_load_dwordx4 v[0:3], v186, s[16:19], s36 offen offset:0 sc1
    buffer_load_dwordx4 v[4:7], v186, s[16:19], s36 offen offset:1024 sc1
    buffer_load_dwordx4 v[8:11], v186, s[16:19], s36 offen offset:2048 sc1
    buffer_load_dwordx4 v[12:15], v186, s[16:19], s36 offen offset:3072 sc1
    s_add_u32 s36, s36, 0x1000
    buffer_load_dwordx4 v[16:19], v186, s[16:19], s36 offen offset:0 sc1
    buffer_load_dwordx4 v[20:23], v186, s[16:19], s36 offen offset:1024 sc1
    buffer_load_dwordx4 v[24:27], v186, s[16:19], s36 offen offset:2048 sc1
    buffer_load_dwordx4 v[28:31], v186, s[16:19], s36 offen offset:3072 sc1
    s_add_u32 s36, s36, 0x1000
    buffer_load_dwordx4 v[32:35], v186, s[16:19], s36 offen offset:0 sc1
    buffer_load_dwordx4 v[36:39], v186, s[16:19], s36 offen offset:1024 sc1
    buffer_load_dwordx4 v[40:43], v186, s[16:19], s36 offen offset:2048 sc1
    buffer_load_dwordx4 v[44:47], v186, s[16:19], s36 offen offset:3072 sc1
    s_add_u32 s36, s36, 0x1000
    buffer_load_dwordx4 v[48:51], v186, s[16:19], s36 offen offset:0 sc1
    buffer_load_dwordx4 v[52:55], v186, s[16:19], s36 offen offset:1024 sc1
    buffer_load_dwordx4 v[56:59], v186, s[16:19], s36 offen offset:2048 sc1
    buffer_load_dwordx4 v[60:63], v186, s[16:19], s36 offen offset:3072 sc1
    s_waitcnt vmcnt(0)
    v_max3_u32 v185, v0, v2, v4
    v_max3_u32 v185, v185, v6, v8
    v_max3_u32 v185, v185, v10, v12
    v_max3_u32 v185, v185, v14, v16
    v_max3_u32 v185, v185, v18, v20
    v_max3_u32 v185, v185, v22, v24
    v_max3_u32 v185, v185, v26, v28
    v_max3_u32 v185, v185, v30, v32
    v_max3_u32 v185, v185, v34, v36
    v_max3_u32 v185, v185, v38, v40
    v_max3_u32 v185, v185, v42, v44
    v_max3_u32 v185, v185, v46, v48
    v_max3_u32 v185, v185, v50, v52
    v_max3_u32 v185, v185, v54, v56
    v_max3_u32 v185, v185, v58, v60
    v_max_u32 v185, v185, v62
    v_cmp_eq_u32 vcc, -1, v185
    s_nop 4
    s_cbranch_vccz Lpar_9
    s_add_u32 s43, s43, 1
    s_cmp_lt_u32 s43, 0x8000
    s_cbranch_scc1 Lpa_8
Lpar_9:
    v_mfma_f32_16x16x32_bf16 v[200:203], v[194:197], v[0:3], 0
    v_mfma_f32_16x16x32_bf16 v[204:207], v[192:195], v[0:3], 0
    v_mfma_f32_16x16x32_bf16 v[208:211], v[194:197], v[4:7], 0
    v_mfma_f32_16x16x32_bf16 v[212:215], v[192:195], v[4:7], 0
    v_mfma_f32_16x16x32_bf16 v[200:203], v[194:197], v[8:11], v[200:203]
    v_mfma_f32_16x16x32_bf16 v[204:207], v[192:195], v[8:11], v[204:207]
    v_mfma_f32_16x16x32_bf16 v[208:211], v[194:197], v[12:15], v[208:211]
    v_mfma_f32_16x16x32_bf16 v[212:215], v[192:195], v[12:15], v[212:215]
    v_mfma_f32_16x16x32_bf16 v[200:203], v[194:197], v[16:19], v[200:203]
    v_mfma_f32_16x16x32_bf16 v[204:207], v[192:195], v[16:19], v[204:207]
    v_mfma_f32_16x16x32_bf16 v[208:211], v[194:197], v[20:23], v[208:211]
    v_mfma_f32_16x16x32_bf16 v[212:215], v[192:195], v[20:23], v[212:215]
    v_mfma_f32_16x16x32_bf16 v[200:203], v[194:197], v[24:27], v[200:203]
    v_mfma_f32_16x16x32_bf16 v[204:207], v[192:195], v[24:27], v[204:207]
    v_mfma_f32_16x16x32_bf16 v[208:211], v[194:197], v[28:31], v[208:211]
    v_mfma_f32_16x16x32_bf16 v[212:215], v[192:195], v[28:31], v[212:215]
    v_mfma_f32_16x16x32_bf16 v[200:203], v[194:197], v[32:35], v[200:203]
    v_mfma_f32_16x16x32_bf16 v[204:207], v[192:195], v[32:35], v[204:207]
    v_mfma_f32_16x16x32_bf16 v[208:211], v[194:197], v[36:39], v[208:211]
    v_mfma_f32_16x16x32_bf16 v[212:215], v[192:195], v[36:39], v[212:215]
    v_mfma_f32_16x16x32_bf16 v[200:203], v[194:197], v[40:43], v[200:203]
    v_mfma_f32_16x16x32_bf16 v[204:207], v[192:195], v[40:43], v[204:207]
    v_mfma_f32_16x16x32_bf16 v[208:211], v[194:197], v[44:47], v[208:211]
    v_mfma_f32_16x16x32_bf16 v[212:215], v[192:195], v[44:47], v[212:215]
    v_mfma_f32_16x16x32_bf16 v[200:203], v[194:197], v[48:51], v[200:203]
    v_mfma_f32_16x16x32_bf16 v[204:207], v[192:195], v[48:51], v[204:207]
    v_mfma_f32_16x16x32_bf16 v[208:211], v[194:197], v[52:55], v[208:211]
    v_mfma_f32_16x16x32_bf16 v[212:215], v[192:195], v[52:55], v[212:215]
    v_mfma_f32_16x16x32_bf16 v[200:203], v[194:197], v[56:59], v[200:203]
    v_mfma_f32_16x16x32_bf16 v[204:207], v[192:195], v[56:59], v[204:207]
    v_mfma_f32_16x16x32_bf16 v[208:211], v[194:197], v[60:63], v[208:211]
    v_mfma_f32_16x16x32_bf16 v[212:215], v[192:195], v[60:63], v[212:215]
    s_nop 7
Lpad_7:
    v_add_f32 v200, v200, v208
    v_add_f32 v201, v201, v209
    v_add_f32 v202, v202, v210
    v_add_f32 v203, v203, v211
    v_add_f32 v204, v204, v212
    v_add_f32 v205, v205, v213
    v_add_f32 v206, v206, v214
    v_add_f32 v207, v207, v215
    v_lshlrev_b32 v184, 4, v190
    buffer_load_dwordx4 a[116:119], v156, s[16:19], s27 offen offset:0 sc1
    s_lshl_b32 s36, s35, 12
    s_add_u32 s36, s36, 0xf000
    v_add_u32 v184, s36, v184
    s_lshl_b32 s37, s34, 11
    v_add_u32 v187, s37, v184
    ds_write_b128 v187, v[200:203] offset:0
    ds_write_b128 v187, v[204:207] offset:1024
    v_mul_f32 v160, s88, v84
    v_mul_f32 v161, s88, v85
    v_mul_f32 v162, s88, v86
    v_mul_f32 v163, s88, v87
    v_mul_f32 v164, s88, v100
    v_mul_f32 v165, s88, v101
    v_mul_f32 v166, s88, v102
    v_mul_f32 v171, s88, v103
    v_exp_f32 v160, v160 clamp
    v_exp_f32 v161, v161 clamp
    v_exp_f32 v162, v162 clamp
    v_exp_f32 v163, v163 clamp
    v_exp_f32 v164, v164 clamp
    buffer_load_dwordx4 a[120:123], v157, s[16:19], s26 offen offset:0 sc1
    v_exp_f32 v165, v165 clamp
    v_exp_f32 v166, v166 clamp
    v_exp_f32 v171, v171 clamp
    v_max_f32 v84, s89, v84
    v_max_f32 v85, s89, v85
    v_max_f32 v86, s89, v86
    v_max_f32 v87, s89, v87
    v_max_f32 v100, s89, v100
    v_max_f32 v101, s89, v101
    v_max_f32 v102, s89, v102
    v_max_f32 v103, s89, v103
    v_add_f32 v84, v84, v160
    v_add_f32 v85, v85, v161
    v_add_f32 v86, v86, v162
    v_add_f32 v87, v87, v163
    v_add_f32 v100, v100, v164
    v_add_f32 v101, v101, v165
    v_add_f32 v102, v102, v166
    v_add_f32 v103, v103, v171
    s_waitcnt lgkmcnt(0)
    s_barrier
    buffer_load_dwordx4 a[124:127], v157, s[16:19], s26 offen offset:1024 sc1
    ds_read_b128 v[4:7], v184 offset:0
    ds_read_b128 v[8:11], v184 offset:1024
    ds_read_b128 v[12:15], v184 offset:2048
    ds_read_b128 v[16:19], v184 offset:3072
    ds_read_b64 v[130:131], v181 offset:0
    ds_read_b64 v[146:147], v181 offset:0
    ds_read_b64 v[134:135], v181 offset:512
    ds_read_b64 v[150:151], v181 offset:512
    s_lshl_b32 s36, s31, 3
    s_lshl_b32 s37, s34, 2
    s_add_u32 s36, s36, s37
    s_lshl_b32 s36, s36, 2
    s_lshr_b32 s37, s32, 1
    s_add_u32 s36, s36, s37
    s_mul_i32 s36, s36, 0x1400
    s_mul_i32 s37, s35, 0xa000
    s_add_u32 s48, s36, s37
    s_sub_u32 s49, s36, s37
    s_and_b32 s36, s32, 1
    s_lshl_b32 s37, s36, 1
    buffer_load_dwordx4 a[128:131], v157, s[16:19], s26 offen offset:2048 sc1
    s_add_u32 s37, s37, s35
    s_lshl_b32 s37, s37, 10
    v_lshlrev_b32 v182, 4, v190
    v_add_u32 v182, s37, v182
    v_and_b32 v183, 15, v190
    v_lshlrev_b32 v183, 4, v183
    v_bfe_u32 v185, v190, 4, 1
    v_lshlrev_b32 v185, 3, v185
    v_add_u32 v183, v183, v185
    s_lshl_b32 s37, s35, 9
    s_lshl_b32 s36, s36, 8
    s_add_u32 s37, s37, s36
    s_add_u32 s37, s37, 0x1000
    v_add_u32 v183, s37, v183
    v_mov_b32 v185, s91
    v_cmp_gt_u32 vcc, 32, v190
    s_nop 1
    v_cndmask_b32 v183, v183, v185, vcc
    v_mov_b32 v20, 0
    v_mov_b32 v21, 0
    v_mov_b32 v22, 0
    buffer_load_dwordx4 a[132:135], v157, s[16:19], s26 offen offset:3072 sc1
    v_mov_b32 v23, 0
    s_waitcnt lgkmcnt(4)
    v_mov_b32 v24, v16
    v_mov_b32 v25, v17
    v_mov_b32 v26, v18
    v_mov_b32 v27, v19
    v_permlane32_swap_b32 v24, v20
    v_permlane32_swap_b32 v25, v21
    v_permlane32_swap_b32 v26, v22
    v_permlane32_swap_b32 v27, v23
    v_cvt_pk_bf16_f32 v52, v16, v17
    v_cvt_pk_bf16_f32 v53, v18, v19
    v_cvt_pk_bf16_f32 v54, v20, v21
    v_cvt_pk_bf16_f32 v55, v22, v23
    v_cvt_pk_bf16_f32 v56, v12, v13
    v_cvt_pk_bf16_f32 v57, v14, v15
    v_mov_b32 v58, v54 row_newbcast:0 row_mask:0xf bank_mask:0xf
    v_mov_b32 v59, v55 row_newbcast:0 row_mask:0xf bank_mask:0xf
    v_cvt_pk_bf16_f32 v28, v4, v5
    v_cvt_pk_bf16_f32 v29, v6, v7
    v_cndmask_b32 v30, 0, v52, s[78:79]
    buffer_load_dwordx4 a[136:139], v157, s[16:19], s27 offen offset:0 sc1
    v_mov_b32 v36, v56
    v_cndmask_b32 v38, 0, v54, s[78:79]
    v_mov_b32 v44, v56 row_newbcast:0 row_mask:0xf bank_mask:0xf
    v_cndmask_b32 v46, 0, v58, s[78:79]
    v_cndmask_b32 v31, 0, v53, s[78:79]
    v_mov_b32 v37, v57
    v_cndmask_b32 v39, 0, v55, s[78:79]
    v_mov_b32 v45, v57 row_newbcast:0 row_mask:0xf bank_mask:0xf
    v_cndmask_b32 v47, 0, v59, s[78:79]
    v_cvt_pk_bf16_f32 v32, v8, v9
    v_cvt_pk_bf16_f32 v33, v10, v11
    v_cndmask_b32 v34, 0, v52, s[80:81]
    v_mov_b32 v40, v56
    v_cndmask_b32 v42, 0, v54, s[80:81]
    v_mov_b32 v48, v56 row_newbcast:4 row_mask:0xf bank_mask:0xf
    v_cndmask_b32 v50, 0, v58, s[80:81]
    v_cndmask_b32 v35, 0, v53, s[80:81]
    v_mov_b32 v41, v57
    v_cndmask_b32 v43, 0, v55, s[80:81]
    v_mov_b32 v49, v57 row_newbcast:4 row_mask:0xf bank_mask:0xf
    buffer_load_dwordx4 a[140:143], v158, s[16:19], s26 offen offset:0 sc1
    v_cndmask_b32 v51, 0, v59, s[80:81]
    v_lshrrev_b32 v152, 2, v190
    v_lshlrev_b32 v152, 7, v152
    v_and_b32 v153, 3, v190
    v_lshlrev_b32 v153, 4, v153
    v_add_u32 v152, v152, v153
    s_mov_b32 s14, 0xb01000
    buffer_load_dwordx4 v[252:255], v152, s[16:19], s14 offen sc1
    v_cvt_pk_bf16_f32 v120, v80, v81
    v_cvt_pk_bf16_f32 v121, v82, v83
    v_cvt_pk_bf16_f32 v136, v96, v97
    v_cvt_pk_bf16_f32 v137, v98, v99
    v_mfma_f32_16x16x32_bf16 v[68:71], v[44:47], v[120:123], 0
    s_nop 0
    v_mfma_f32_16x16x32_bf16 v[216:219], v[48:51], v[136:139], 0
    buffer_load_dwordx4 a[144:147], v158, s[16:19], s26 offen offset:1024 sc1
    v_mfma_f32_16x16x32_bf16 v[60:63], v[28:31], v[120:123], 0
    v_mfma_f32_16x16x32_bf16 v[64:67], v[36:39], v[120:123], 0
    v_mfma_f32_16x16x32_bf16 v[72:75], v[32:35], v[136:139], 0
    v_mfma_f32_16x16x32_bf16 v[76:79], v[40:43], v[136:139], 0
    v_mul_f32 v160, s88, v88
    v_mul_f32 v161, s88, v89
    v_mul_f32 v162, s88, v90
    v_mul_f32 v163, s88, v91
    buffer_load_dwordx4 a[148:151], v158, s[16:19], s26 offen offset:2048 sc1
    v_mul_f32 v164, s88, v104
    v_mul_f32 v165, s88, v105
    v_mul_f32 v166, s88, v106
    v_mul_f32 v171, s88, v107
    v_exp_f32 v160, v160 clamp
    v_exp_f32 v161, v161 clamp
    v_exp_f32 v162, v162 clamp
    v_exp_f32 v163, v163 clamp
    v_exp_f32 v164, v164 clamp
    v_exp_f32 v165, v165 clamp
    v_exp_f32 v166, v166 clamp
    v_exp_f32 v171, v171 clamp
    v_max_f32 v88, s89, v88
    v_max_f32 v89, s89, v89
    v_max_f32 v90, s89, v90
    v_max_f32 v91, s89, v91
    v_max_f32 v104, s89, v104
    v_max_f32 v105, s89, v105
    v_max_f32 v106, s89, v106
    v_max_f32 v107, s89, v107
    buffer_load_dwordx4 a[152:155], v158, s[16:19], s26 offen offset:3072 sc1
    v_add_f32 v88, v88, v160
    v_add_f32 v89, v89, v161
    v_add_f32 v90, v90, v162
    v_add_f32 v91, v91, v163
    v_add_f32 v104, v104, v164
    v_add_f32 v105, v105, v165
    v_add_f32 v106, v106, v166
    v_add_f32 v107, v107, v171
    v_cvt_pk_bf16_f32 v124, v84, v85
    v_cvt_pk_bf16_f32 v125, v86, v87
    v_cvt_pk_bf16_f32 v140, v100, v101
    v_cvt_pk_bf16_f32 v141, v102, v103
    v_mfma_f32_16x16x32_bf16 v[236:239], v[44:47], v[124:127], 0
    s_nop 0
    v_mfma_f32_16x16x32_bf16 v[248:251], v[48:51], v[140:143], 0
    buffer_load_dwordx4 a[156:159], v158, s[16:19], s27 offen offset:0 sc1
    v_mfma_f32_16x16x32_bf16 v[228:231], v[28:31], v[124:127], 0
    v_mfma_f32_16x16x32_bf16 v[232:235], v[36:39], v[124:127], 0
    v_mfma_f32_16x16x32_bf16 v[240:243], v[32:35], v[140:143], 0
    v_mfma_f32_16x16x32_bf16 v[244:247], v[40:43], v[140:143], 0
    v_add_f32 v68, s89, v68
    v_add_f32 v216, s89, v216
    v_rcp_f32 v68, v68
    v_rcp_f32 v216, v216
    buffer_load_dwordx4 a[160:163], v159, s[16:19], s26 offen offset:0 sc1
    v_mul_f32 v68, v68, v176
    v_mul_f32 v216, v216, v176
    v_mul_f32 v60, v60, v68
    v_mul_f32 v61, v61, v68
    v_mul_f32 v62, v62, v68
    v_mul_f32 v63, v63, v68
    v_cvt_pk_bf16_f32 v220, v60, v61
    v_cvt_pk_bf16_f32 v221, v62, v63
    v_mul_f32 v72, v72, v216
    v_mul_f32 v73, v73, v216
    v_mul_f32 v74, v74, v216
    v_mul_f32 v75, v75, v216
    v_cvt_pk_bf16_f32 v222, v72, v73
    v_cvt_pk_bf16_f32 v223, v74, v75
    s_add_u32 s50, s48, 0
    buffer_store_dwordx4 v[220:223], v182, s[16:19], s50 offen sc1
    v_mul_f32 v64, v64, v68
    v_mul_f32 v65, v65, v68
    v_mul_f32 v66, v66, v68
    v_mul_f32 v67, v67, v68
    buffer_load_dwordx4 a[164:167], v159, s[16:19], s26 offen offset:1024 sc1
    v_mul_f32 v76, v76, v216
    v_mul_f32 v77, v77, v216
    v_mul_f32 v78, v78, v216
    v_mul_f32 v79, v79, v216
    v_cndmask_b32 v64, v64, v76, s[76:77]
    v_cndmask_b32 v65, v65, v77, s[76:77]
    v_cndmask_b32 v66, v66, v78, s[76:77]
    v_cndmask_b32 v67, v67, v79, s[76:77]
    v_cvt_pk_bf16_f32 v224, v64, v65
    v_cvt_pk_bf16_f32 v225, v66, v67
    buffer_store_dwordx2 v[224:225], v183, s[16:19], s50 offen sc1
    v_mul_f32 v160, s88, v92
    v_mul_f32 v161, s88, v93
    v_mul_f32 v162, s88, v94
    v_mul_f32 v163, s88, v95
    v_mul_f32 v164, s88, v108
    v_mul_f32 v165, s88, v109
    v_mul_f32 v166, s88, v110
    v_mul_f32 v171, s88, v111
    v_exp_f32 v160, v160 clamp
    buffer_load_dwordx4 a[168:171], v159, s[16:19], s26 offen offset:2048 sc1
    v_exp_f32 v161, v161 clamp
    v_exp_f32 v162, v162 clamp
    v_exp_f32 v163, v163 clamp
    v_exp_f32 v164, v164 clamp
    v_exp_f32 v165, v165 clamp
    v_exp_f32 v166, v166 clamp
    v_exp_f32 v171, v171 clamp
    v_max_f32 v92, s89, v92
    v_max_f32 v93, s89, v93
    v_max_f32 v94, s89, v94
    v_max_f32 v95, s89, v95
    v_max_f32 v108, s89, v108
    v_max_f32 v109, s89, v109
    v_max_f32 v110, s89, v110
    v_max_f32 v111, s89, v111
    v_add_f32 v92, v92, v160
    v_add_f32 v93, v93, v161
    v_add_f32 v94, v94, v162
    v_add_f32 v95, v95, v163
    v_add_f32 v108, v108, v164
    buffer_load_dwordx4 a[172:175], v159, s[16:19], s26 offen offset:3072 sc1
    v_add_f32 v109, v109, v165
    v_add_f32 v110, v110, v166
    v_add_f32 v111, v111, v171
    v_cvt_pk_bf16_f32 v128, v88, v89
    v_cvt_pk_bf16_f32 v129, v90, v91
    v_cvt_pk_bf16_f32 v144, v104, v105
    v_cvt_pk_bf16_f32 v145, v106, v107
    s_waitcnt lgkmcnt(3)
    v_mfma_f32_16x16x32_bf16 v[68:71], v[44:47], v[128:131], 0
    s_waitcnt lgkmcnt(2)
    v_mfma_f32_16x16x32_bf16 v[216:219], v[48:51], v[144:147], 0
    v_mfma_f32_16x16x32_bf16 v[60:63], v[28:31], v[128:131], 0
    v_mfma_f32_16x16x32_bf16 v[64:67], v[36:39], v[128:131], 0
    buffer_load_dwordx4 a[176:179], v159, s[16:19], s27 offen offset:0 sc1
    v_mfma_f32_16x16x32_bf16 v[72:75], v[32:35], v[144:147], 0
    v_mfma_f32_16x16x32_bf16 v[76:79], v[40:43], v[144:147], 0
    v_add_f32 v236, s89, v236
    v_add_f32 v248, s89, v248
    v_rcp_f32 v236, v236
    v_rcp_f32 v248, v248
    v_mul_f32 v236, v236, v177
    v_mul_f32 v248, v248, v177
    v_mul_f32 v228, v228, v236
    v_mul_f32 v229, v229, v236
    v_mul_f32 v230, v230, v236
    v_mul_f32 v231, v231, v236
    v_cvt_pk_bf16_f32 v220, v228, v229
    v_cvt_pk_bf16_f32 v221, v230, v231
    buffer_load_dwordx4 a[180:183], v189, s[16:19], s26 offen offset:0 sc1
    v_mul_f32 v240, v240, v248
    v_mul_f32 v241, v241, v248
    v_mul_f32 v242, v242, v248
    v_mul_f32 v243, v243, v248
    v_cvt_pk_bf16_f32 v222, v240, v241
    v_cvt_pk_bf16_f32 v223, v242, v243
    s_add_u32 s50, s48, 0x5000
    buffer_store_dwordx4 v[220:223], v182, s[16:19], s50 offen sc1
    v_mul_f32 v232, v232, v236
    v_mul_f32 v233, v233, v236
    v_mul_f32 v234, v234, v236
    v_mul_f32 v235, v235, v236
    v_mul_f32 v244, v244, v248
    v_mul_f32 v245, v245, v248
    v_mul_f32 v246, v246, v248
    v_mul_f32 v247, v247, v248
    v_cndmask_b32 v232, v232, v244, s[76:77]
    v_cndmask_b32 v233, v233, v245, s[76:77]
    v_cndmask_b32 v234, v234, v246, s[76:77]
    v_cndmask_b32 v235, v235, v247, s[76:77]
    buffer_load_dwordx4 a[184:187], v189, s[16:19], s26 offen offset:1024 sc1
    v_cvt_pk_bf16_f32 v224, v232, v233
    v_cvt_pk_bf16_f32 v225, v234, v235
    buffer_store_dwordx2 v[224:225], v183, s[16:19], s50 offen sc1
    v_cvt_pk_bf16_f32 v132, v92, v93
    v_cvt_pk_bf16_f32 v133, v94, v95
    v_cvt_pk_bf16_f32 v148, v108, v109
    v_cvt_pk_bf16_f32 v149, v110, v111
    s_waitcnt lgkmcnt(1)
    v_mfma_f32_16x16x32_bf16 v[236:239], v[44:47], v[132:135], 0
    s_waitcnt lgkmcnt(0)
    v_mfma_f32_16x16x32_bf16 v[248:251], v[48:51], v[148:151], 0
    v_mfma_f32_16x16x32_bf16 v[228:231], v[28:31], v[132:135], 0
    v_mfma_f32_16x16x32_bf16 v[232:235], v[36:39], v[132:135], 0
    buffer_load_dwordx4 a[188:191], v189, s[16:19], s26 offen offset:2048 sc1
    v_mfma_f32_16x16x32_bf16 v[240:243], v[32:35], v[148:151], 0
    v_mfma_f32_16x16x32_bf16 v[244:247], v[40:43], v[148:151], 0
    v_mov_b32 v89, v190
    s_add_u32 s36, s46, 0
    s_lshl_b32 s36, s36, 10
    v_lshlrev_b32 v80, 4, v190
    v_add_u32 v80, s36, v80
    s_add_u32 s36, s46, 1
    s_sub_u32 s43, s36, 5
    s_cmp_ge_u32 s36, 5
    s_cselect_b32 s36, s43, s36
    s_lshl_b32 s36, s36, 10
    v_lshlrev_b32 v81, 4, v190
    v_add_u32 v81, s36, v81
    s_add_u32 s36, s46, 2
    buffer_load_dwordx4 a[192:195], v189, s[16:19], s26 offen offset:3072 sc1
    s_sub_u32 s43, s36, 5
    s_cmp_ge_u32 s36, 5
    s_cselect_b32 s36, s43, s36
    s_lshl_b32 s36, s36, 10
    v_lshlrev_b32 v82, 4, v190
    v_add_u32 v82, s36, v82
    s_add_u32 s36, s46, 3
    s_sub_u32 s43, s36, 5
    s_cmp_ge_u32 s36, 5
    s_cselect_b32 s36, s43, s36
    s_lshl_b32 s36, s36, 10
    v_lshlrev_b32 v83, 4, v190
    v_add_u32 v83, s36, v83
    s_add_u32 s36, s46, 4
    s_sub_u32 s43, s36, 5
    s_cmp_ge_u32 s36, 5
    s_cselect_b32 s36, s43, s36
    s_lshl_b32 s36, s36, 10
    v_lshlrev_b32 v84, 4, v190
    v_add_u32 v84, s36, v84
    s_xor_b32 s36, s33, s47
    s_xor_b32 s36, s36, 0
    s_lshl_b32 s37, s44, 2
    buffer_load_dwordx4 a[196:199], v189, s[16:19], s27 offen offset:0 sc1
    s_add_u32 s36, s36, s37
    s_lshl_b32 s36, s36, 2
    s_add_u32 s36, s36, s33
    s_mul_i32 s36, s36, 0x1400
    s_add_u32 s4, s36, 0
    s_add_u32 s0, s36, 0x280000
    s_xor_b32 s36, s33, s47
    s_xor_b32 s36, s36, 1
    s_lshl_b32 s37, s44, 2
    s_add_u32 s36, s36, s37
    s_lshl_b32 s36, s36, 2
    s_add_u32 s36, s36, s33
    s_mul_i32 s36, s36, 0x1400
    s_add_u32 s5, s36, 0
    s_add_u32 s1, s36, 0x280000
    s_xor_b32 s36, s33, s47
    s_xor_b32 s36, s36, 2
    s_lshl_b32 s37, s44, 2
    s_add_u32 s36, s36, s37
    s_lshl_b32 s36, s36, 2
    s_add_u32 s36, s36, s33
    s_mul_i32 s36, s36, 0x1400
    s_add_u32 s6, s36, 0
    s_add_u32 s2, s36, 0x280000
    s_xor_b32 s36, s33, s47
    s_xor_b32 s36, s36, 3
    s_lshl_b32 s37, s44, 2
    s_add_u32 s36, s36, s37
    s_lshl_b32 s36, s36, 2
    s_add_u32 s36, s36, s33
    s_mul_i32 s36, s36, 0x1400
    s_add_u32 s7, s36, 0
    s_add_u32 s3, s36, 0x280000
    s_mov_b32 s8, s70
    s_mov_b32 s9, s71
    s_mov_b32 s10, 0x280000
    s_mov_b32 s11, 0x20000
    v_add_f32 v68, s89, v68
    v_add_f32 v216, s89, v216
    v_rcp_f32 v68, v68
    v_rcp_f32 v216, v216
    v_mul_f32 v68, v68, v178
    v_mul_f32 v216, v216, v178
    v_mul_f32 v60, v60, v68
    v_mul_f32 v61, v61, v68
    v_mul_f32 v62, v62, v68
    v_mul_f32 v63, v63, v68
    v_cvt_pk_bf16_f32 v220, v60, v61
    v_cvt_pk_bf16_f32 v221, v62, v63
    v_mul_f32 v72, v72, v216
    v_mul_f32 v73, v73, v216
    v_mul_f32 v74, v74, v216
    v_mul_f32 v75, v75, v216
    v_cvt_pk_bf16_f32 v222, v72, v73
    v_cvt_pk_bf16_f32 v223, v74, v75
    s_add_u32 s50, s49, 0xa000
    buffer_store_dwordx4 v[220:223], v182, s[16:19], s50 offen sc1
    v_mul_f32 v64, v64, v68
    v_mul_f32 v65, v65, v68
    v_mul_f32 v66, v66, v68
    v_mul_f32 v67, v67, v68
    v_mul_f32 v76, v76, v216
    v_mul_f32 v77, v77, v216
    v_mul_f32 v78, v78, v216
    v_mul_f32 v79, v79, v216
    v_cndmask_b32 v64, v64, v76, s[76:77]
    v_cndmask_b32 v65, v65, v77, s[76:77]
    v_cndmask_b32 v66, v66, v78, s[76:77]
    v_cndmask_b32 v67, v67, v79, s[76:77]
    v_cvt_pk_bf16_f32 v224, v64, v65
    v_cvt_pk_bf16_f32 v225, v66, v67
    buffer_store_dwordx2 v[224:225], v183, s[16:19], s50 offen sc1
    v_add_f32 v236, s89, v236
    v_add_f32 v248, s89, v248
    v_rcp_f32 v236, v236
    v_rcp_f32 v248, v248
    v_mul_f32 v236, v236, v179
    v_mul_f32 v248, v248, v179
    v_mul_f32 v228, v228, v236
    v_mul_f32 v229, v229, v236
    v_mul_f32 v230, v230, v236
    v_mul_f32 v231, v231, v236
    v_cvt_pk_bf16_f32 v220, v228, v229
    v_cvt_pk_bf16_f32 v221, v230, v231
    v_mul_f32 v240, v240, v248
    v_mul_f32 v241, v241, v248
    v_mul_f32 v242, v242, v248
    v_mul_f32 v243, v243, v248
    v_cvt_pk_bf16_f32 v222, v240, v241
    v_cvt_pk_bf16_f32 v223, v242, v243
    s_add_u32 s50, s49, 0xf000
    buffer_store_dwordx4 v[220:223], v182, s[16:19], s50 offen sc1
    v_mul_f32 v232, v232, v236
    v_mul_f32 v233, v233, v236
    v_mul_f32 v234, v234, v236
    v_mul_f32 v235, v235, v236
    v_mul_f32 v244, v244, v248
    v_mul_f32 v245, v245, v248
    v_mul_f32 v246, v246, v248
    v_mul_f32 v247, v247, v248
    v_cndmask_b32 v232, v232, v244, s[76:77]
    v_cndmask_b32 v233, v233, v245, s[76:77]
    v_cndmask_b32 v234, v234, v246, s[76:77]
    v_cndmask_b32 v235, v235, v247, s[76:77]
    v_cvt_pk_bf16_f32 v224, v232, v233
    v_cvt_pk_bf16_f32 v225, v234, v235
    buffer_store_dwordx2 v[224:225], v183, s[16:19], s50 offen sc1
    s_waitcnt vmcnt(22)
    v_xor_b32 v252, s28, v252
    v_xor_b32 v253, s28, v253
    v_xor_b32 v254, s28, v254
    v_xor_b32 v255, s28, v255
    v_or3_b32 v252, v252, v253, v254
    v_or_b32 v252, v252, v255
    v_cmp_ne_u32 vcc, 0, v252
    s_nop 4
    s_cbranch_vccz Lf2d_11
    s_mov_b32 s15, 0
Lf2_10:
    buffer_load_dwordx4 v[252:255], v152, s[16:19], s14 offen sc1
    s_waitcnt vmcnt(0)
    v_xor_b32 v252, s28, v252
    v_xor_b32 v253, s28, v253
    v_xor_b32 v254, s28, v254
    v_xor_b32 v255, s28, v255
    v_or3_b32 v252, v252, v253, v254
    v_or_b32 v252, v252, v255
    v_cmp_ne_u32 vcc, 0, v252
    s_nop 4
    s_cbranch_vccz Lf2d_11
    s_add_u32 s15, s15, 1
    s_cmp_lt_u32 s15, 0x8000
    s_cbranch_scc1 Lf2_10
Lf2d_11:
    buffer_load_dwordx4 a[204:207], v80, s[16:19], s1 offen sc1
    buffer_load_dwordx4 a[220:223], v81, s[16:19], s1 offen sc1
    buffer_load_dwordx4 a[236:239], v82, s[16:19], s1 offen sc1
    buffer_load_dwordx4 a[252:255], v83, s[16:19], s1 offen sc1
    buffer_load_dwordx4 v[244:247], v84, s[16:19], s1 offen sc1
    buffer_load_dwordx4 a[208:211], v80, s[16:19], s2 offen sc1
    buffer_load_dwordx4 a[224:227], v81, s[16:19], s2 offen sc1
    buffer_load_dwordx4 a[240:243], v82, s[16:19], s2 offen sc1
    buffer_load_dwordx4 v[232:235], v83, s[16:19], s2 offen sc1
    buffer_load_dwordx4 v[248:251], v84, s[16:19], s2 offen sc1
    s_mov_b32 s13, 0
    v_lshlrev_b32 v88, 4, v89
    s_xor_b32 s36, s33, 1
    s_lshr_b32 s37, s36, 1
    s_mul_i32 s37, s37, 0x11800
    s_mul_i32 s36, s36, 0x3c00
    s_add_u32 s36, s36, s37
    s_add_u32 s36, s36, 0x5000
    s_add_u32 s36, s36, 0
    v_add_u32 v91, s36, v88
    s_xor_b32 s36, s33, 2
    s_lshr_b32 s37, s36, 1
    s_mul_i32 s37, s37, 0x11800
    s_mul_i32 s36, s36, 0x3c00
    s_add_u32 s36, s36, s37
    s_add_u32 s36, s36, 0x5000
    s_add_u32 s36, s36, 0x1400
    v_add_u32 v92, s36, v88
    s_xor_b32 s36, s33, 3
    s_lshr_b32 s37, s36, 1
    s_mul_i32 s37, s37, 0x11800
    s_mul_i32 s36, s36, 0x3c00
    s_add_u32 s36, s36, s37
    s_add_u32 s36, s36, 0x5000
    s_add_u32 s36, s36, 0x2800
    v_add_u32 v93, s36, v88
    s_lshr_b32 s37, s33, 1
    s_mul_i32 s37, s37, 0x11800
    s_mul_i32 s36, s33, 0x3c00
    s_add_u32 s36, s36, s37
    s_add_u32 s36, s36, 0x5000
    v_add_u32 v87, s36, v88
    s_xor_b32 s36, s33, s47
    s_lshr_b32 s37, s36, 1
    s_lshl_b32 s37, s37, 5
    s_and_b32 s36, s36, 1
    s_add_u32 s36, s36, s37
    s_lshl_b32 s37, s44, 6
    s_add_u32 s36, s36, s37
    s_mul_i32 s36, s36, 0x500
    s_mul_i32 s37, s45, 0xa0
    s_add_u32 s12, s36, s37
    v_and_b32 v86, 15, v89
    v_mul_u32_u24 v86, 0xa00, v86
    v_lshrrev_b32 v90, 4, v89
    v_mul_u32_u24 v90, 40, v90
    v_add_u32 v90, v90, v86
    s_waitcnt vmcnt(9)
    v_accvgpr_read_b32 v176, a204
    v_accvgpr_read_b32 v177, a206
    s_waitcnt vmcnt(8)
    v_accvgpr_read_b32 v178, a220
    v_accvgpr_read_b32 v179, a222
    s_waitcnt vmcnt(7)
    v_accvgpr_read_b32 v180, a236
    v_accvgpr_read_b32 v181, a238
    s_waitcnt vmcnt(6)
    v_accvgpr_read_b32 v182, a252
    v_accvgpr_read_b32 v183, a254
    v_max3_u32 v85, v176, v177, v178
    v_max3_u32 v85, v85, v179, v180
    v_max3_u32 v85, v85, v181, v182
    s_waitcnt vmcnt(5)
    v_max3_u32 v85, v85, v183, v244
    v_max_u32 v85, v85, v246
    v_cmp_eq_u32 vcc, -1, v85
    s_nop 4
    s_cbranch_vccz Lok_13
Lsp_12:
    buffer_load_dwordx4 a[204:207], v80, s[16:19], s1 offen sc1
    buffer_load_dwordx4 a[220:223], v81, s[16:19], s1 offen sc1
    buffer_load_dwordx4 a[236:239], v82, s[16:19], s1 offen sc1
    buffer_load_dwordx4 a[252:255], v83, s[16:19], s1 offen sc1
    buffer_load_dwordx4 v[244:247], v84, s[16:19], s1 offen sc1
    buffer_load_dwordx4 a[208:211], v80, s[16:19], s2 offen sc1
    buffer_load_dwordx4 a[224:227], v81, s[16:19], s2 offen sc1
    buffer_load_dwordx4 a[240:243], v82, s[16:19], s2 offen sc1
    buffer_load_dwordx4 v[232:235], v83, s[16:19], s2 offen sc1
    buffer_load_dwordx4 v[248:251], v84, s[16:19], s2 offen sc1
    s_waitcnt vmcnt(9)
    v_accvgpr_read_b32 v176, a204
    v_accvgpr_read_b32 v177, a206
    s_waitcnt vmcnt(8)
    v_accvgpr_read_b32 v178, a220
    v_accvgpr_read_b32 v179, a222
    s_waitcnt vmcnt(7)
    v_accvgpr_read_b32 v180, a236
    v_accvgpr_read_b32 v181, a238
    s_waitcnt vmcnt(6)
    v_accvgpr_read_b32 v182, a252
    v_accvgpr_read_b32 v183, a254
    v_max3_u32 v85, v176, v177, v178
    v_max3_u32 v85, v85, v179, v180
    v_max3_u32 v85, v85, v181, v182
    s_waitcnt vmcnt(5)
    v_max3_u32 v85, v85, v183, v244
    v_max_u32 v85, v85, v246
    v_cmp_eq_u32 vcc, -1, v85
    s_nop 4
    s_cbranch_vccz Lok_13
    s_add_u32 s13, s13, 1
    s_cmp_lt_u32 s13, 0x8000
    s_cbranch_scc1 Lsp_12
Lok_13:
    v_mfma_f32_16x16x32_bf16 v[20:23], a[0:3], a[204:207], 0
    v_mfma_f32_16x16x32_bf16 v[24:27], a[4:7], a[204:207], 0
    v_mfma_f32_16x16x32_bf16 v[28:31], a[8:11], a[204:207], 0
    v_mfma_f32_16x16x32_bf16 v[32:35], a[12:15], a[204:207], 0
    v_mfma_f32_16x16x32_bf16 v[36:39], a[16:19], a[204:207], 0
    buffer_load_dwordx4 a[212:215], v80, s[16:19], s3 offen sc1
    v_mfma_f32_16x16x32_bf16 v[20:23], a[20:23], a[220:223], v[20:23]
    v_mfma_f32_16x16x32_bf16 v[24:27], a[24:27], a[220:223], v[24:27]
    buffer_load_dwordx4 a[228:231], v81, s[16:19], s3 offen sc1
    v_mfma_f32_16x16x32_bf16 v[28:31], a[28:31], a[220:223], v[28:31]
    v_mfma_f32_16x16x32_bf16 v[32:35], a[32:35], a[220:223], v[32:35]
    buffer_load_dwordx4 a[244:247], v82, s[16:19], s3 offen sc1
    v_mfma_f32_16x16x32_bf16 v[36:39], a[36:39], a[220:223], v[36:39]
    v_mfma_f32_16x16x32_bf16 v[20:23], a[40:43], a[236:239], v[20:23]
    buffer_load_dwordx4 v[236:239], v83, s[16:19], s3 offen sc1
    v_mfma_f32_16x16x32_bf16 v[24:27], a[44:47], a[236:239], v[24:27]
    v_mfma_f32_16x16x32_bf16 v[28:31], a[48:51], a[236:239], v[28:31]
    buffer_load_dwordx4 v[252:255], v84, s[16:19], s3 offen sc1
    v_mfma_f32_16x16x32_bf16 v[32:35], a[52:55], a[236:239], v[32:35]
    v_mfma_f32_16x16x32_bf16 v[36:39], a[56:59], a[236:239], v[36:39]
    s_waitcnt vmcnt(9)
    v_accvgpr_read_b32 v176, a208
    v_accvgpr_read_b32 v177, a210
    v_mfma_f32_16x16x32_bf16 v[20:23], a[60:63], a[252:255], v[20:23]
    s_waitcnt vmcnt(8)
    v_accvgpr_read_b32 v178, a224
    v_mfma_f32_16x16x32_bf16 v[24:27], a[64:67], a[252:255], v[24:27]
    v_accvgpr_read_b32 v179, a226
    s_waitcnt vmcnt(7)
    v_accvgpr_read_b32 v180, a240
    v_mfma_f32_16x16x32_bf16 v[28:31], a[68:71], a[252:255], v[28:31]
    v_accvgpr_read_b32 v181, a242
    v_mfma_f32_16x16x32_bf16 v[32:35], a[72:75], a[252:255], v[32:35]
    v_max3_u32 v85, v176, v177, v178
    v_max3_u32 v85, v85, v179, v180
    v_mfma_f32_16x16x32_bf16 v[36:39], a[76:79], a[252:255], v[36:39]
    s_waitcnt vmcnt(6)
    v_max3_u32 v85, v85, v181, v232
    v_mfma_f32_16x16x32_bf16 v[20:23], a[80:83], v[244:247], v[20:23]
    s_waitcnt vmcnt(5)
    v_max3_u32 v85, v85, v234, v248
    v_max_u32 v85, v85, v250
    v_mfma_f32_16x16x32_bf16 v[24:27], a[84:87], v[244:247], v[24:27]
    v_cmp_eq_u32 vcc, -1, v85
    v_mfma_f32_16x16x32_bf16 v[28:31], a[88:91], v[244:247], v[28:31]
    v_mfma_f32_16x16x32_bf16 v[32:35], a[92:95], v[244:247], v[32:35]
    v_mfma_f32_16x16x32_bf16 v[36:39], a[96:99], v[244:247], v[36:39]
    s_nop 1
    s_cbranch_vccz Lok_15
Lsp_14:
    buffer_load_dwordx4 a[208:211], v80, s[16:19], s2 offen sc1
    buffer_load_dwordx4 a[224:227], v81, s[16:19], s2 offen sc1
    buffer_load_dwordx4 a[240:243], v82, s[16:19], s2 offen sc1
    buffer_load_dwordx4 v[232:235], v83, s[16:19], s2 offen sc1
    buffer_load_dwordx4 v[248:251], v84, s[16:19], s2 offen sc1
    buffer_load_dwordx4 a[212:215], v80, s[16:19], s3 offen sc1
    buffer_load_dwordx4 a[228:231], v81, s[16:19], s3 offen sc1
    buffer_load_dwordx4 a[244:247], v82, s[16:19], s3 offen sc1
    buffer_load_dwordx4 v[236:239], v83, s[16:19], s3 offen sc1
    buffer_load_dwordx4 v[252:255], v84, s[16:19], s3 offen sc1
    s_waitcnt vmcnt(9)
    v_accvgpr_read_b32 v176, a208
    v_accvgpr_read_b32 v177, a210
    s_waitcnt vmcnt(8)
    v_accvgpr_read_b32 v178, a224
    v_accvgpr_read_b32 v179, a226
    s_waitcnt vmcnt(7)
    v_accvgpr_read_b32 v180, a240
    v_accvgpr_read_b32 v181, a242
    v_max3_u32 v85, v176, v177, v178
    v_max3_u32 v85, v85, v179, v180
    s_waitcnt vmcnt(6)
    v_max3_u32 v85, v85, v181, v232
    s_waitcnt vmcnt(5)
    v_max3_u32 v85, v85, v234, v248
    v_max_u32 v85, v85, v250
    v_cmp_eq_u32 vcc, -1, v85
    s_nop 4
    s_cbranch_vccz Lok_15
    s_add_u32 s13, s13, 1
    s_cmp_lt_u32 s13, 0x8000
    s_cbranch_scc1 Lsp_14
Lok_15:
    v_mfma_f32_16x16x32_bf16 v[40:43], a[0:3], a[208:211], 0
    v_mfma_f32_16x16x32_bf16 v[44:47], a[4:7], a[208:211], 0
    v_mfma_f32_16x16x32_bf16 v[48:51], a[8:11], a[208:211], 0
    v_mfma_f32_16x16x32_bf16 v[52:55], a[12:15], a[208:211], 0
    v_mfma_f32_16x16x32_bf16 v[56:59], a[16:19], a[208:211], 0
    buffer_load_dwordx4 a[200:203], v80, s[16:19], s0 offen sc1
    v_mfma_f32_16x16x32_bf16 v[40:43], a[20:23], a[224:227], v[40:43]
    v_mfma_f32_16x16x32_bf16 v[44:47], a[24:27], a[224:227], v[44:47]
    buffer_load_dwordx4 a[216:219], v81, s[16:19], s0 offen sc1
    v_mfma_f32_16x16x32_bf16 v[48:51], a[28:31], a[224:227], v[48:51]
    v_mfma_f32_16x16x32_bf16 v[52:55], a[32:35], a[224:227], v[52:55]
    buffer_load_dwordx4 a[232:235], v82, s[16:19], s0 offen sc1
    v_mfma_f32_16x16x32_bf16 v[56:59], a[36:39], a[224:227], v[56:59]
    v_mfma_f32_16x16x32_bf16 v[40:43], a[40:43], a[240:243], v[40:43]
    buffer_load_dwordx4 a[248:251], v83, s[16:19], s0 offen sc1
    v_mfma_f32_16x16x32_bf16 v[44:47], a[44:47], a[240:243], v[44:47]
    v_mfma_f32_16x16x32_bf16 v[48:51], a[48:51], a[240:243], v[48:51]
    buffer_load_dwordx4 v[240:243], v84, s[16:19], s0 offen sc1
    v_mfma_f32_16x16x32_bf16 v[52:55], a[52:55], a[240:243], v[52:55]
    v_mfma_f32_16x16x32_bf16 v[56:59], a[56:59], a[240:243], v[56:59]
    s_waitcnt vmcnt(9)
    v_accvgpr_read_b32 v176, a212
    v_accvgpr_read_b32 v177, a214
    v_mfma_f32_16x16x32_bf16 v[40:43], a[60:63], v[232:235], v[40:43]
    s_waitcnt vmcnt(8)
    v_accvgpr_read_b32 v178, a228
    v_mfma_f32_16x16x32_bf16 v[44:47], a[64:67], v[232:235], v[44:47]
    v_accvgpr_read_b32 v179, a230
    s_waitcnt vmcnt(7)
    v_accvgpr_read_b32 v180, a244
    v_mfma_f32_16x16x32_bf16 v[48:51], a[68:71], v[232:235], v[48:51]
    v_accvgpr_read_b32 v181, a246
    v_mfma_f32_16x16x32_bf16 v[52:55], a[72:75], v[232:235], v[52:55]
    v_max3_u32 v85, v176, v177, v178
    v_max3_u32 v85, v85, v179, v180
    v_mfma_f32_16x16x32_bf16 v[56:59], a[76:79], v[232:235], v[56:59]
    s_waitcnt vmcnt(6)
    v_max3_u32 v85, v85, v181, v236
    v_mfma_f32_16x16x32_bf16 v[40:43], a[80:83], v[248:251], v[40:43]
    s_waitcnt vmcnt(5)
    v_max3_u32 v85, v85, v238, v252
    v_max_u32 v85, v85, v254
    v_mfma_f32_16x16x32_bf16 v[44:47], a[84:87], v[248:251], v[44:47]
    v_cmp_eq_u32 vcc, -1, v85
    v_mfma_f32_16x16x32_bf16 v[48:51], a[88:91], v[248:251], v[48:51]
    v_mfma_f32_16x16x32_bf16 v[52:55], a[92:95], v[248:251], v[52:55]
    v_mfma_f32_16x16x32_bf16 v[56:59], a[96:99], v[248:251], v[56:59]
    s_nop 1
    s_cbranch_vccz Lok_17
Lsp_16:
    buffer_load_dwordx4 a[212:215], v80, s[16:19], s3 offen sc1
    buffer_load_dwordx4 a[228:231], v81, s[16:19], s3 offen sc1
    buffer_load_dwordx4 a[244:247], v82, s[16:19], s3 offen sc1
    buffer_load_dwordx4 v[236:239], v83, s[16:19], s3 offen sc1
    buffer_load_dwordx4 v[252:255], v84, s[16:19], s3 offen sc1
    buffer_load_dwordx4 a[200:203], v80, s[16:19], s0 offen sc1
    buffer_load_dwordx4 a[216:219], v81, s[16:19], s0 offen sc1
    buffer_load_dwordx4 a[232:235], v82, s[16:19], s0 offen sc1
    buffer_load_dwordx4 a[248:251], v83, s[16:19], s0 offen sc1
    buffer_load_dwordx4 v[240:243], v84, s[16:19], s0 offen sc1
    s_waitcnt vmcnt(9)
    v_accvgpr_read_b32 v176, a212
    v_accvgpr_read_b32 v177, a214
    s_waitcnt vmcnt(8)
    v_accvgpr_read_b32 v178, a228
    v_accvgpr_read_b32 v179, a230
    s_waitcnt vmcnt(7)
    v_accvgpr_read_b32 v180, a244
    v_accvgpr_read_b32 v181, a246
    v_max3_u32 v85, v176, v177, v178
    v_max3_u32 v85, v85, v179, v180
    s_waitcnt vmcnt(6)
    v_max3_u32 v85, v85, v181, v236
    s_waitcnt vmcnt(5)
    v_max3_u32 v85, v85, v238, v252
    v_max_u32 v85, v85, v254
    v_cmp_eq_u32 vcc, -1, v85
    s_nop 4
    s_cbranch_vccz Lok_17
    s_add_u32 s13, s13, 1
    s_cmp_lt_u32 s13, 0x8000
    s_cbranch_scc1 Lsp_16
Lok_17:
    v_mfma_f32_16x16x32_bf16 v[60:63], a[0:3], a[212:215], 0
    v_mfma_f32_16x16x32_bf16 v[64:67], a[4:7], a[212:215], 0
    v_mfma_f32_16x16x32_bf16 v[68:71], a[8:11], a[212:215], 0
    v_mfma_f32_16x16x32_bf16 v[72:75], a[12:15], a[212:215], 0
    v_mfma_f32_16x16x32_bf16 v[76:79], a[16:19], a[212:215], 0
    buffer_load_dwordx4 v[100:103], v80, s[16:19], s5 offen sc1
    v_mfma_f32_16x16x32_bf16 v[60:63], a[20:23], a[228:231], v[60:63]
    v_mfma_f32_16x16x32_bf16 v[64:67], a[24:27], a[228:231], v[64:67]
    buffer_load_dwordx4 v[116:119], v81, s[16:19], s5 offen sc1
    v_mfma_f32_16x16x32_bf16 v[68:71], a[28:31], a[228:231], v[68:71]
    v_mfma_f32_16x16x32_bf16 v[72:75], a[32:35], a[228:231], v[72:75]
    buffer_load_dwordx4 v[132:135], v82, s[16:19], s5 offen sc1
    v_mfma_f32_16x16x32_bf16 v[76:79], a[36:39], a[228:231], v[76:79]
    v_mfma_f32_16x16x32_bf16 v[60:63], a[40:43], a[244:247], v[60:63]
    buffer_load_dwordx4 v[148:151], v83, s[16:19], s5 offen sc1
    v_mfma_f32_16x16x32_bf16 v[64:67], a[44:47], a[244:247], v[64:67]
    v_mfma_f32_16x16x32_bf16 v[68:71], a[48:51], a[244:247], v[68:71]
    buffer_load_dwordx4 v[164:167], v84, s[16:19], s5 offen sc1
    v_mfma_f32_16x16x32_bf16 v[72:75], a[52:55], a[244:247], v[72:75]
    v_mfma_f32_16x16x32_bf16 v[76:79], a[56:59], a[244:247], v[76:79]
    s_waitcnt vmcnt(9)
    v_accvgpr_read_b32 v176, a200
    v_accvgpr_read_b32 v177, a202
    v_mfma_f32_16x16x32_bf16 v[60:63], a[60:63], v[236:239], v[60:63]
    s_waitcnt vmcnt(8)
    v_accvgpr_read_b32 v178, a216
    v_accvgpr_read_b32 v179, a218
    v_mfma_f32_16x16x32_bf16 v[64:67], a[64:67], v[236:239], v[64:67]
    s_waitcnt vmcnt(7)
    v_accvgpr_read_b32 v180, a232
    v_accvgpr_read_b32 v181, a234
    v_mfma_f32_16x16x32_bf16 v[68:71], a[68:71], v[236:239], v[68:71]
    s_waitcnt vmcnt(6)
    v_accvgpr_read_b32 v182, a248
    v_mfma_f32_16x16x32_bf16 v[72:75], a[72:75], v[236:239], v[72:75]
    v_accvgpr_read_b32 v183, a250
    v_max3_u32 v85, v176, v177, v178
    v_mfma_f32_16x16x32_bf16 v[76:79], a[76:79], v[236:239], v[76:79]
    v_max3_u32 v85, v85, v179, v180
    v_max3_u32 v85, v85, v181, v182
    v_mfma_f32_16x16x32_bf16 v[60:63], a[80:83], v[252:255], v[60:63]
    s_waitcnt vmcnt(5)
    v_max3_u32 v85, v85, v183, v240
    v_max_u32 v85, v85, v242
    v_mfma_f32_16x16x32_bf16 v[64:67], a[84:87], v[252:255], v[64:67]
    v_cmp_eq_u32 vcc, -1, v85
    v_mfma_f32_16x16x32_bf16 v[68:71], a[88:91], v[252:255], v[68:71]
    v_mfma_f32_16x16x32_bf16 v[72:75], a[92:95], v[252:255], v[72:75]
    v_mfma_f32_16x16x32_bf16 v[76:79], a[96:99], v[252:255], v[76:79]
    s_nop 1
    s_cbranch_vccz Lok_19
Lsp_18:
    buffer_load_dwordx4 a[200:203], v80, s[16:19], s0 offen sc1
    buffer_load_dwordx4 a[216:219], v81, s[16:19], s0 offen sc1
    buffer_load_dwordx4 a[232:235], v82, s[16:19], s0 offen sc1
    buffer_load_dwordx4 a[248:251], v83, s[16:19], s0 offen sc1
    buffer_load_dwordx4 v[240:243], v84, s[16:19], s0 offen sc1
    buffer_load_dwordx4 v[100:103], v80, s[16:19], s5 offen sc1
    buffer_load_dwordx4 v[116:119], v81, s[16:19], s5 offen sc1
    buffer_load_dwordx4 v[132:135], v82, s[16:19], s5 offen sc1
    buffer_load_dwordx4 v[148:151], v83, s[16:19], s5 offen sc1
    buffer_load_dwordx4 v[164:167], v84, s[16:19], s5 offen sc1
    s_waitcnt vmcnt(9)
    v_accvgpr_read_b32 v176, a200
    v_accvgpr_read_b32 v177, a202
    s_waitcnt vmcnt(8)
    v_accvgpr_read_b32 v178, a216
    v_accvgpr_read_b32 v179, a218
    s_waitcnt vmcnt(7)
    v_accvgpr_read_b32 v180, a232
    v_accvgpr_read_b32 v181, a234
    s_waitcnt vmcnt(6)
    v_accvgpr_read_b32 v182, a248
    v_accvgpr_read_b32 v183, a250
    v_max3_u32 v85, v176, v177, v178
    v_max3_u32 v85, v85, v179, v180
    v_max3_u32 v85, v85, v181, v182
    s_waitcnt vmcnt(5)
    v_max3_u32 v85, v85, v183, v240
    v_max_u32 v85, v85, v242
    v_cmp_eq_u32 vcc, -1, v85
    s_nop 4
    s_cbranch_vccz Lok_19
    s_add_u32 s13, s13, 1
    s_cmp_lt_u32 s13, 0x8000
    s_cbranch_scc1 Lsp_18
Lok_19:
    v_mfma_f32_16x16x32_bf16 v[0:3], a[0:3], a[200:203], 0
    v_mfma_f32_16x16x32_bf16 v[4:7], a[4:7], a[200:203], 0
    v_mfma_f32_16x16x32_bf16 v[8:11], a[8:11], a[200:203], 0
    v_mfma_f32_16x16x32_bf16 v[12:15], a[12:15], a[200:203], 0
    v_mfma_f32_16x16x32_bf16 v[16:19], a[16:19], a[200:203], 0
    buffer_load_dwordx4 v[104:107], v80, s[16:19], s6 offen sc1
    v_mfma_f32_16x16x32_bf16 v[0:3], a[20:23], a[216:219], v[0:3]
    v_mfma_f32_16x16x32_bf16 v[4:7], a[24:27], a[216:219], v[4:7]
    buffer_load_dwordx4 v[120:123], v81, s[16:19], s6 offen sc1
    v_mfma_f32_16x16x32_bf16 v[8:11], a[28:31], a[216:219], v[8:11]
    v_mfma_f32_16x16x32_bf16 v[12:15], a[32:35], a[216:219], v[12:15]
    buffer_load_dwordx4 v[136:139], v82, s[16:19], s6 offen sc1
    v_mfma_f32_16x16x32_bf16 v[16:19], a[36:39], a[216:219], v[16:19]
    v_mfma_f32_16x16x32_bf16 v[0:3], a[40:43], a[232:235], v[0:3]
    buffer_load_dwordx4 v[152:155], v83, s[16:19], s6 offen sc1
    v_mfma_f32_16x16x32_bf16 v[4:7], a[44:47], a[232:235], v[4:7]
    v_mfma_f32_16x16x32_bf16 v[8:11], a[48:51], a[232:235], v[8:11]
    buffer_load_dwordx4 v[168:171], v84, s[16:19], s6 offen sc1
    v_mfma_f32_16x16x32_bf16 v[12:15], a[52:55], a[232:235], v[12:15]
    v_mfma_f32_16x16x32_bf16 v[16:19], a[56:59], a[232:235], v[16:19]
    s_waitcnt vmcnt(8)
    v_max3_u32 v85, v100, v102, v116
    v_mfma_f32_16x16x32_bf16 v[0:3], a[60:63], a[248:251], v[0:3]
    s_waitcnt vmcnt(7)
    v_max3_u32 v85, v85, v118, v132
    v_mfma_f32_16x16x32_bf16 v[4:7], a[64:67], a[248:251], v[4:7]
    s_waitcnt vmcnt(6)
    v_max3_u32 v85, v85, v134, v148
    v_mfma_f32_16x16x32_bf16 v[8:11], a[68:71], a[248:251], v[8:11]
    v_mfma_f32_16x16x32_bf16 v[12:15], a[72:75], a[248:251], v[12:15]
    s_waitcnt vmcnt(5)
    v_max3_u32 v85, v85, v150, v164
    v_mfma_f32_16x16x32_bf16 v[16:19], a[76:79], a[248:251], v[16:19]
    v_max_u32 v85, v85, v166
    v_mfma_f32_16x16x32_bf16 v[0:3], a[80:83], v[240:243], v[0:3]
    v_cmp_eq_u32 vcc, -1, v85
    v_mfma_f32_16x16x32_bf16 v[4:7], a[84:87], v[240:243], v[4:7]
    v_mfma_f32_16x16x32_bf16 v[8:11], a[88:91], v[240:243], v[8:11]
    v_mfma_f32_16x16x32_bf16 v[12:15], a[92:95], v[240:243], v[12:15]
    v_mfma_f32_16x16x32_bf16 v[16:19], a[96:99], v[240:243], v[16:19]
    s_nop 0
    s_cbranch_vccz Lok_21
Lsp_20:
    buffer_load_dwordx4 v[100:103], v80, s[16:19], s5 offen sc1
    buffer_load_dwordx4 v[116:119], v81, s[16:19], s5 offen sc1
    buffer_load_dwordx4 v[132:135], v82, s[16:19], s5 offen sc1
    buffer_load_dwordx4 v[148:151], v83, s[16:19], s5 offen sc1
    buffer_load_dwordx4 v[164:167], v84, s[16:19], s5 offen sc1
    buffer_load_dwordx4 v[104:107], v80, s[16:19], s6 offen sc1
    buffer_load_dwordx4 v[120:123], v81, s[16:19], s6 offen sc1
    buffer_load_dwordx4 v[136:139], v82, s[16:19], s6 offen sc1
    buffer_load_dwordx4 v[152:155], v83, s[16:19], s6 offen sc1
    buffer_load_dwordx4 v[168:171], v84, s[16:19], s6 offen sc1
    s_waitcnt vmcnt(8)
    v_max3_u32 v85, v100, v102, v116
    s_waitcnt vmcnt(7)
    v_max3_u32 v85, v85, v118, v132
    s_waitcnt vmcnt(6)
    v_max3_u32 v85, v85, v134, v148
    s_waitcnt vmcnt(5)
    v_max3_u32 v85, v85, v150, v164
    v_max_u32 v85, v85, v166
    v_cmp_eq_u32 vcc, -1, v85
    s_nop 4
    s_cbranch_vccz Lok_21
    s_add_u32 s13, s13, 1
    s_cmp_lt_u32 s13, 0x8000
    s_cbranch_scc1 Lsp_20
Lok_21:
    v_mfma_f32_16x16x32_bf16 v[20:23], a[100:103], v[100:103], v[20:23]
    v_mfma_f32_16x16x32_bf16 v[24:27], a[104:107], v[100:103], v[24:27]
    v_mfma_f32_16x16x32_bf16 v[28:31], a[108:111], v[100:103], v[28:31]
    v_mfma_f32_16x16x32_bf16 v[32:35], a[112:115], v[100:103], v[32:35]
    v_mfma_f32_16x16x32_bf16 v[36:39], a[116:119], v[100:103], v[36:39]
    buffer_load_dwordx4 v[108:111], v80, s[16:19], s7 offen sc1
    v_mfma_f32_16x16x32_bf16 v[20:23], a[120:123], v[116:119], v[20:23]
    v_mfma_f32_16x16x32_bf16 v[24:27], a[124:127], v[116:119], v[24:27]
    buffer_load_dwordx4 v[124:127], v81, s[16:19], s7 offen sc1
    v_mfma_f32_16x16x32_bf16 v[28:31], a[128:131], v[116:119], v[28:31]
    v_mfma_f32_16x16x32_bf16 v[32:35], a[132:135], v[116:119], v[32:35]
    buffer_load_dwordx4 v[140:143], v82, s[16:19], s7 offen sc1
    v_mfma_f32_16x16x32_bf16 v[36:39], a[136:139], v[116:119], v[36:39]
    v_mfma_f32_16x16x32_bf16 v[20:23], a[140:143], v[132:135], v[20:23]
    buffer_load_dwordx4 v[156:159], v83, s[16:19], s7 offen sc1
    v_mfma_f32_16x16x32_bf16 v[24:27], a[144:147], v[132:135], v[24:27]
    v_mfma_f32_16x16x32_bf16 v[28:31], a[148:151], v[132:135], v[28:31]
    buffer_load_dwordx4 v[172:175], v84, s[16:19], s7 offen sc1
    v_mfma_f32_16x16x32_bf16 v[32:35], a[152:155], v[132:135], v[32:35]
    v_mfma_f32_16x16x32_bf16 v[36:39], a[156:159], v[132:135], v[36:39]
    s_waitcnt vmcnt(8)
    v_max3_u32 v85, v104, v106, v120
    v_mfma_f32_16x16x32_bf16 v[20:23], a[160:163], v[148:151], v[20:23]
    s_waitcnt vmcnt(7)
    v_max3_u32 v85, v85, v122, v136
    v_mfma_f32_16x16x32_bf16 v[24:27], a[164:167], v[148:151], v[24:27]
    s_waitcnt vmcnt(6)
    v_max3_u32 v85, v85, v138, v152
    v_mfma_f32_16x16x32_bf16 v[28:31], a[168:171], v[148:151], v[28:31]
    v_mfma_f32_16x16x32_bf16 v[32:35], a[172:175], v[148:151], v[32:35]
    s_waitcnt vmcnt(5)
    v_max3_u32 v85, v85, v154, v168
    v_mfma_f32_16x16x32_bf16 v[36:39], a[176:179], v[148:151], v[36:39]
    v_max_u32 v85, v85, v170
    v_mfma_f32_16x16x32_bf16 v[20:23], a[180:183], v[164:167], v[20:23]
    v_cmp_eq_u32 vcc, -1, v85
    v_mfma_f32_16x16x32_bf16 v[24:27], a[184:187], v[164:167], v[24:27]
    v_mfma_f32_16x16x32_bf16 v[28:31], a[188:191], v[164:167], v[28:31]
    v_mfma_f32_16x16x32_bf16 v[32:35], a[192:195], v[164:167], v[32:35]
    v_mfma_f32_16x16x32_bf16 v[36:39], a[196:199], v[164:167], v[36:39]
    s_nop 0
    s_cbranch_vccz Lok_23
Lsp_22:
    buffer_load_dwordx4 v[104:107], v80, s[16:19], s6 offen sc1
    buffer_load_dwordx4 v[120:123], v81, s[16:19], s6 offen sc1
    buffer_load_dwordx4 v[136:139], v82, s[16:19], s6 offen sc1
    buffer_load_dwordx4 v[152:155], v83, s[16:19], s6 offen sc1
    buffer_load_dwordx4 v[168:171], v84, s[16:19], s6 offen sc1
    buffer_load_dwordx4 v[108:111], v80, s[16:19], s7 offen sc1
    buffer_load_dwordx4 v[124:127], v81, s[16:19], s7 offen sc1
    buffer_load_dwordx4 v[140:143], v82, s[16:19], s7 offen sc1
    buffer_load_dwordx4 v[156:159], v83, s[16:19], s7 offen sc1
    buffer_load_dwordx4 v[172:175], v84, s[16:19], s7 offen sc1
    s_waitcnt vmcnt(8)
    v_max3_u32 v85, v104, v106, v120
    s_waitcnt vmcnt(7)
    v_max3_u32 v85, v85, v122, v136
    s_waitcnt vmcnt(6)
    v_max3_u32 v85, v85, v138, v152
    s_waitcnt vmcnt(5)
    v_max3_u32 v85, v85, v154, v168
    v_max_u32 v85, v85, v170
    v_cmp_eq_u32 vcc, -1, v85
    s_nop 4
    s_cbranch_vccz Lok_23
    s_add_u32 s13, s13, 1
    s_cmp_lt_u32 s13, 0x8000
    s_cbranch_scc1 Lsp_22
Lok_23:
    v_mfma_f32_16x16x32_bf16 v[40:43], a[100:103], v[104:107], v[40:43]
    v_mfma_f32_16x16x32_bf16 v[44:47], a[104:107], v[104:107], v[44:47]
    v_mfma_f32_16x16x32_bf16 v[48:51], a[108:111], v[104:107], v[48:51]
    v_mfma_f32_16x16x32_bf16 v[52:55], a[112:115], v[104:107], v[52:55]
    v_mfma_f32_16x16x32_bf16 v[56:59], a[116:119], v[104:107], v[56:59]
    buffer_load_dwordx4 v[96:99], v80, s[16:19], s4 offen sc1
    v_mfma_f32_16x16x32_bf16 v[40:43], a[120:123], v[120:123], v[40:43]
    ds_write_b128 v91, v[20:23] offset:0
    v_mfma_f32_16x16x32_bf16 v[44:47], a[124:127], v[120:123], v[44:47]
    buffer_load_dwordx4 v[112:115], v81, s[16:19], s4 offen sc1
    v_mfma_f32_16x16x32_bf16 v[48:51], a[128:131], v[120:123], v[48:51]
    ds_write_b128 v91, v[24:27] offset:1024
    v_mfma_f32_16x16x32_bf16 v[52:55], a[132:135], v[120:123], v[52:55]
    buffer_load_dwordx4 v[128:131], v82, s[16:19], s4 offen sc1
    v_mfma_f32_16x16x32_bf16 v[56:59], a[136:139], v[120:123], v[56:59]
    ds_write_b128 v91, v[28:31] offset:2048
    v_mfma_f32_16x16x32_bf16 v[40:43], a[140:143], v[136:139], v[40:43]
    buffer_load_dwordx4 v[144:147], v83, s[16:19], s4 offen sc1
    v_mfma_f32_16x16x32_bf16 v[44:47], a[144:147], v[136:139], v[44:47]
    ds_write_b128 v91, v[32:35] offset:3072
    v_mfma_f32_16x16x32_bf16 v[48:51], a[148:151], v[136:139], v[48:51]
    buffer_load_dwordx4 v[160:163], v84, s[16:19], s4 offen sc1
    v_mfma_f32_16x16x32_bf16 v[52:55], a[152:155], v[136:139], v[52:55]
    ds_write_b128 v91, v[36:39] offset:4096
    v_mfma_f32_16x16x32_bf16 v[56:59], a[156:159], v[136:139], v[56:59]
    s_waitcnt vmcnt(8)
    v_max3_u32 v85, v108, v110, v124
    v_mfma_f32_16x16x32_bf16 v[40:43], a[160:163], v[152:155], v[40:43]
    s_waitcnt vmcnt(7)
    v_max3_u32 v85, v85, v126, v140
    v_mfma_f32_16x16x32_bf16 v[44:47], a[164:167], v[152:155], v[44:47]
    s_waitcnt vmcnt(6)
    v_max3_u32 v85, v85, v142, v156
    v_mfma_f32_16x16x32_bf16 v[48:51], a[168:171], v[152:155], v[48:51]
    v_mfma_f32_16x16x32_bf16 v[52:55], a[172:175], v[152:155], v[52:55]
    s_waitcnt vmcnt(5)
    v_max3_u32 v85, v85, v158, v172
    v_mfma_f32_16x16x32_bf16 v[56:59], a[176:179], v[152:155], v[56:59]
    v_max_u32 v85, v85, v174
    v_mfma_f32_16x16x32_bf16 v[40:43], a[180:183], v[168:171], v[40:43]
    v_cmp_eq_u32 vcc, -1, v85
    v_mfma_f32_16x16x32_bf16 v[44:47], a[184:187], v[168:171], v[44:47]
    v_mfma_f32_16x16x32_bf16 v[48:51], a[188:191], v[168:171], v[48:51]
    v_mfma_f32_16x16x32_bf16 v[52:55], a[192:195], v[168:171], v[52:55]
    v_mfma_f32_16x16x32_bf16 v[56:59], a[196:199], v[168:171], v[56:59]
    s_nop 0
    s_cbranch_vccz Lok_25
Lsp_24:
    buffer_load_dwordx4 v[108:111], v80, s[16:19], s7 offen sc1
    buffer_load_dwordx4 v[124:127], v81, s[16:19], s7 offen sc1
    buffer_load_dwordx4 v[140:143], v82, s[16:19], s7 offen sc1
    buffer_load_dwordx4 v[156:159], v83, s[16:19], s7 offen sc1
    buffer_load_dwordx4 v[172:175], v84, s[16:19], s7 offen sc1
    buffer_load_dwordx4 v[96:99], v80, s[16:19], s4 offen sc1
    buffer_load_dwordx4 v[112:115], v81, s[16:19], s4 offen sc1
    buffer_load_dwordx4 v[128:131], v82, s[16:19], s4 offen sc1
    buffer_load_dwordx4 v[144:147], v83, s[16:19], s4 offen sc1
    buffer_load_dwordx4 v[160:163], v84, s[16:19], s4 offen sc1
    s_waitcnt vmcnt(8)
    v_max3_u32 v85, v108, v110, v124
    s_waitcnt vmcnt(7)
    v_max3_u32 v85, v85, v126, v140
    s_waitcnt vmcnt(6)
    v_max3_u32 v85, v85, v142, v156
    s_waitcnt vmcnt(5)
    v_max3_u32 v85, v85, v158, v172
    v_max_u32 v85, v85, v174
    v_cmp_eq_u32 vcc, -1, v85
    s_nop 4
    s_cbranch_vccz Lok_25
    s_add_u32 s13, s13, 1
    s_cmp_lt_u32 s13, 0x8000
    s_cbranch_scc1 Lsp_24
Lok_25:
    v_mfma_f32_16x16x32_bf16 v[60:63], a[100:103], v[108:111], v[60:63]
    v_mfma_f32_16x16x32_bf16 v[64:67], a[104:107], v[108:111], v[64:67]
    v_mfma_f32_16x16x32_bf16 v[68:71], a[108:111], v[108:111], v[68:71]
    v_mfma_f32_16x16x32_bf16 v[72:75], a[112:115], v[108:111], v[72:75]
    v_mfma_f32_16x16x32_bf16 v[76:79], a[116:119], v[108:111], v[76:79]
    ds_write_b128 v92, v[40:43] offset:0
    v_mfma_f32_16x16x32_bf16 v[60:63], a[120:123], v[124:127], v[60:63]
    v_mfma_f32_16x16x32_bf16 v[64:67], a[124:127], v[124:127], v[64:67]
    ds_write_b128 v92, v[44:47] offset:1024
    v_mfma_f32_16x16x32_bf16 v[68:71], a[128:131], v[124:127], v[68:71]
    v_mfma_f32_16x16x32_bf16 v[72:75], a[132:135], v[124:127], v[72:75]
    ds_write_b128 v92, v[48:51] offset:2048
    v_mfma_f32_16x16x32_bf16 v[76:79], a[136:139], v[124:127], v[76:79]
    v_mfma_f32_16x16x32_bf16 v[60:63], a[140:143], v[140:143], v[60:63]
    ds_write_b128 v92, v[52:55] offset:3072
    v_mfma_f32_16x16x32_bf16 v[64:67], a[144:147], v[140:143], v[64:67]
    v_mfma_f32_16x16x32_bf16 v[68:71], a[148:151], v[140:143], v[68:71]
    ds_write_b128 v92, v[56:59] offset:4096
    v_mfma_f32_16x16x32_bf16 v[72:75], a[152:155], v[140:143], v[72:75]
    v_mfma_f32_16x16x32_bf16 v[76:79], a[156:159], v[140:143], v[76:79]
    s_waitcnt vmcnt(3)
    v_max3_u32 v85, v96, v98, v112
    v_mfma_f32_16x16x32_bf16 v[60:63], a[160:163], v[156:159], v[60:63]
    s_waitcnt vmcnt(2)
    v_max3_u32 v85, v85, v114, v128
    v_mfma_f32_16x16x32_bf16 v[64:67], a[164:167], v[156:159], v[64:67]
    s_waitcnt vmcnt(1)
    v_max3_u32 v85, v85, v130, v144
    v_mfma_f32_16x16x32_bf16 v[68:71], a[168:171], v[156:159], v[68:71]
    v_mfma_f32_16x16x32_bf16 v[72:75], a[172:175], v[156:159], v[72:75]
    s_waitcnt vmcnt(0)
    v_max3_u32 v85, v85, v146, v160
    v_mfma_f32_16x16x32_bf16 v[76:79], a[176:179], v[156:159], v[76:79]
    v_max_u32 v85, v85, v162
    v_mfma_f32_16x16x32_bf16 v[60:63], a[180:183], v[172:175], v[60:63]
    v_cmp_eq_u32 vcc, -1, v85
    v_mfma_f32_16x16x32_bf16 v[64:67], a[184:187], v[172:175], v[64:67]
    v_mfma_f32_16x16x32_bf16 v[68:71], a[188:191], v[172:175], v[68:71]
    v_mfma_f32_16x16x32_bf16 v[72:75], a[192:195], v[172:175], v[72:75]
    v_mfma_f32_16x16x32_bf16 v[76:79], a[196:199], v[172:175], v[76:79]
    s_nop 0
    s_cbranch_vccz Lok_27
Lsp_26:
    buffer_load_dwordx4 v[96:99], v80, s[16:19], s4 offen sc1
    buffer_load_dwordx4 v[112:115], v81, s[16:19], s4 offen sc1
    buffer_load_dwordx4 v[128:131], v82, s[16:19], s4 offen sc1
    buffer_load_dwordx4 v[144:147], v83, s[16:19], s4 offen sc1
    buffer_load_dwordx4 v[160:163], v84, s[16:19], s4 offen sc1
    s_waitcnt vmcnt(3)
    v_max3_u32 v85, v96, v98, v112
    s_waitcnt vmcnt(2)
    v_max3_u32 v85, v85, v114, v128
    s_waitcnt vmcnt(1)
    v_max3_u32 v85, v85, v130, v144
    s_waitcnt vmcnt(0)
    v_max3_u32 v85, v85, v146, v160
    v_max_u32 v85, v85, v162
    v_cmp_eq_u32 vcc, -1, v85
    s_nop 4
    s_cbranch_vccz Lok_27
    s_add_u32 s13, s13, 1
    s_cmp_lt_u32 s13, 0x8000
    s_cbranch_scc1 Lsp_26
Lok_27:
    v_mfma_f32_16x16x32_bf16 v[0:3], a[100:103], v[96:99], v[0:3]
    v_mfma_f32_16x16x32_bf16 v[4:7], a[104:107], v[96:99], v[4:7]
    v_mfma_f32_16x16x32_bf16 v[8:11], a[108:111], v[96:99], v[8:11]
    ds_write_b128 v93, v[60:63] offset:0
    v_mfma_f32_16x16x32_bf16 v[12:15], a[112:115], v[96:99], v[12:15]
    ds_write_b128 v93, v[64:67] offset:1024
    v_mfma_f32_16x16x32_bf16 v[16:19], a[116:119], v[96:99], v[16:19]
    ds_write_b128 v93, v[68:71] offset:2048
    v_mfma_f32_16x16x32_bf16 v[0:3], a[120:123], v[112:115], v[0:3]
    ds_write_b128 v93, v[72:75] offset:3072
    v_mfma_f32_16x16x32_bf16 v[4:7], a[124:127], v[112:115], v[4:7]
    ds_write_b128 v93, v[76:79] offset:4096
    v_mfma_f32_16x16x32_bf16 v[8:11], a[128:131], v[112:115], v[8:11]
    s_waitcnt lgkmcnt(0)
    s_barrier
    v_mfma_f32_16x16x32_bf16 v[12:15], a[132:135], v[112:115], v[12:15]
    ds_read_b128 v[20:23], v87 offset:0
    ds_read_b128 v[24:27], v87 offset:1024
    v_mfma_f32_16x16x32_bf16 v[16:19], a[136:139], v[112:115], v[16:19]
    ds_read_b128 v[28:31], v87 offset:2048
    v_mfma_f32_16x16x32_bf16 v[0:3], a[140:143], v[128:131], v[0:3]
    ds_read_b128 v[32:35], v87 offset:3072
    ds_read_b128 v[36:39], v87 offset:4096
    v_mfma_f32_16x16x32_bf16 v[4:7], a[144:147], v[128:131], v[4:7]
    ds_read_b128 v[40:43], v87 offset:5120
    v_mfma_f32_16x16x32_bf16 v[8:11], a[148:151], v[128:131], v[8:11]
    ds_read_b128 v[44:47], v87 offset:6144
    ds_read_b128 v[48:51], v87 offset:7168
    v_mfma_f32_16x16x32_bf16 v[12:15], a[152:155], v[128:131], v[12:15]
    ds_read_b128 v[52:55], v87 offset:8192
    v_mfma_f32_16x16x32_bf16 v[16:19], a[156:159], v[128:131], v[16:19]
    ds_read_b128 v[56:59], v87 offset:9216
    ds_read_b128 v[60:63], v87 offset:10240
    v_mfma_f32_16x16x32_bf16 v[0:3], a[160:163], v[144:147], v[0:3]
    ds_read_b128 v[64:67], v87 offset:11264
    v_mfma_f32_16x16x32_bf16 v[4:7], a[164:167], v[144:147], v[4:7]
    ds_read_b128 v[68:71], v87 offset:12288
    ds_read_b128 v[72:75], v87 offset:13312
    v_mfma_f32_16x16x32_bf16 v[8:11], a[168:171], v[144:147], v[8:11]
    ds_read_b128 v[76:79], v87 offset:14336
    v_mfma_f32_16x16x32_bf16 v[12:15], a[172:175], v[144:147], v[12:15]
    v_mfma_f32_16x16x32_bf16 v[16:19], a[176:179], v[144:147], v[16:19]
    s_waitcnt lgkmcnt(9)
    v_add_f32 v20, v20, v40
    v_add_f32 v21, v21, v41
    v_add_f32 v22, v22, v42
    v_mfma_f32_16x16x32_bf16 v[0:3], a[180:183], v[160:163], v[0:3]
    v_add_f32 v23, v23, v43
    s_waitcnt lgkmcnt(8)
    v_add_f32 v24, v24, v44
    v_mfma_f32_16x16x32_bf16 v[4:7], a[184:187], v[160:163], v[4:7]
    v_add_f32 v25, v25, v45
    v_add_f32 v26, v26, v46
    v_mfma_f32_16x16x32_bf16 v[8:11], a[188:191], v[160:163], v[8:11]
    v_add_f32 v27, v27, v47
    s_waitcnt lgkmcnt(7)
    v_add_f32 v28, v28, v48
    v_add_f32 v29, v29, v49
    v_mfma_f32_16x16x32_bf16 v[12:15], a[192:195], v[160:163], v[12:15]
    v_add_f32 v30, v30, v50
    v_add_f32 v31, v31, v51
    v_mfma_f32_16x16x32_bf16 v[16:19], a[196:199], v[160:163], v[16:19]
    s_waitcnt lgkmcnt(6)
    v_add_f32 v32, v32, v52
    v_add_f32 v33, v33, v53
    v_add_f32 v34, v34, v54
    v_add_f32 v35, v35, v55
    s_waitcnt lgkmcnt(5)
    v_add_f32 v36, v36, v56
    v_add_f32 v37, v37, v57
    v_add_f32 v38, v38, v58
    v_add_f32 v39, v39, v59
    s_waitcnt lgkmcnt(4)
    v_add_f32 v20, v20, v60
    v_add_f32 v21, v21, v61
    v_add_f32 v22, v22, v62
    v_add_f32 v23, v23, v63
    s_waitcnt lgkmcnt(3)
    v_add_f32 v24, v24, v64
    v_add_f32 v25, v25, v65
    v_add_f32 v26, v26, v66
    v_add_f32 v27, v27, v67
    s_waitcnt lgkmcnt(2)
    v_add_f32 v28, v28, v68
    v_add_f32 v29, v29, v69
    v_add_f32 v30, v30, v70
    v_add_f32 v31, v31, v71
    s_waitcnt lgkmcnt(1)
    v_add_f32 v32, v32, v72
    v_add_f32 v33, v33, v73
    v_add_f32 v34, v34, v74
    v_add_f32 v35, v35, v75
    s_waitcnt lgkmcnt(0)
    v_add_f32 v36, v36, v76
    v_add_f32 v37, v37, v77
    v_add_f32 v38, v38, v78
    v_add_f32 v39, v39, v79
    v_add_f32 v0, v0, v20
    v_add_f32 v1, v1, v21
    v_add_f32 v2, v2, v22
    v_add_f32 v3, v3, v23
    v_cvt_pk_bf16_f32 v96, v0, v1
    v_cvt_pk_bf16_f32 v97, v2, v3
    v_add_f32 v4, v4, v24
    v_add_f32 v5, v5, v25
    v_add_f32 v6, v6, v26
    v_add_f32 v7, v7, v27
    v_cvt_pk_bf16_f32 v98, v4, v5
    v_cvt_pk_bf16_f32 v99, v6, v7
    v_add_f32 v8, v8, v28
    v_add_f32 v9, v9, v29
    v_add_f32 v10, v10, v30
    v_add_f32 v11, v11, v31
    v_cvt_pk_bf16_f32 v100, v8, v9
    v_cvt_pk_bf16_f32 v101, v10, v11
    v_add_f32 v12, v12, v32
    v_add_f32 v13, v13, v33
    v_add_f32 v14, v14, v34
    v_add_f32 v15, v15, v35
    v_cvt_pk_bf16_f32 v102, v12, v13
    v_cvt_pk_bf16_f32 v103, v14, v15
    v_add_f32 v16, v16, v36
    v_add_f32 v17, v17, v37
    v_add_f32 v18, v18, v38
    v_add_f32 v19, v19, v39
    v_cvt_pk_bf16_f32 v104, v16, v17
    v_cvt_pk_bf16_f32 v105, v18, v19
    buffer_store_dwordx4 v[96:99], v90, s[8:11], s12 offen
    buffer_store_dwordx4 v[100:103], v90, s[8:11], s12 offen offset:16
    buffer_store_dwordx2 v[104:105], v90, s[8:11], s12 offen offset:32
    s_branch K1_END
K1_B:
    s_lshl_b32 s36, s31, 7
    s_lshl_b32 s37, s35, 3
    s_add_u32 s36, s36, s37
    s_add_u32 s36, s36, s34
    s_sub_u32 s36, s36, 16
    s_mul_i32 s36, s36, 0x500
    s_mov_b32 s37, 0x7fff0000
    s_cmp_eq_u32 s31, 0
    s_cselect_b32 s36, s37, s36
    v_lshrrev_b32 v32, 3, v190
    s_lshl_b32 s37, s35, 2
    v_add_u32 v33, s37, v32
    v_and_b32 v34, 7, v190
    v_xor_b32 v33, v33, v34
    v_and_b32 v33, 7, v33
    v_lshlrev_b32 v33, 4, v33
    v_mul_u32_u24 v32, 0xa00, v32
    v_add3_u32 v32, v32, v33, s36
    v_mov_b32 v33, 0x7fff0000
    v_cmp_gt_u32 vcc, 32, v190
    s_nop 1
    v_cndmask_b32 v182, v33, v32, vcc
    s_lshl_b32 s29, s33, 10
    s_add_u32 s29, s29, 0x1b000
    v_bfe_u32 v32, v190, 2, 2
    v_lshlrev_b32 v32, 10, v32
    v_and_b32 v33, 3, v190
    v_lshlrev_b32 v33, 7, v33
    v_add_u32 v32, v32, v33
    v_lshrrev_b32 v33, 4, v190
    v_and_b32 v34, 7, v190
    v_xor_b32 v33, v33, v34
    v_lshlrev_b32 v33, 4, v33
    v_add3_u32 v183, v32, v33, 0
    v_add_u32 v183, 0x1b000, v183
    v_xor_b32 v184, 64, v183
    s_add_u32 m0, s40, 0
    s_lshl_b32 s38, s92, 7
    buffer_load_dwordx4 v176, s[8:11], s38 offen lds
    buffer_load_dwordx4 v177, s[8:11], s38 offen offset:1024 lds
    s_add_u32 m0, s40, 0x800
    s_nop 0
    buffer_load_dwordx4 v178, s[8:11], s38 offen lds
    buffer_load_dwordx4 v179, s[8:11], s38 offen offset:1024 lds
    s_add_u32 m0, s29, 0
    s_nop 0
    buffer_load_dwordx4 v182, s[8:11], s38 offen lds
    s_add_u32 m0, s41, 0
    s_mul_i32 s39, s92, 0x3c000
    s_add_u32 s92, s92, 1
    s_sub_u32 s36, s92, 10
    s_cmp_lt_u32 s92, 10
    s_cselect_b32 s92, s92, s36
    buffer_load_dwordx4 v171, s[12:15], s39 offen offset:0 lds
    buffer_load_dwordx4 v172, s[12:15], s39 offen offset:1024 lds
    buffer_load_dwordx4 v173, s[12:15], s39 offen offset:2048 lds
    buffer_load_dwordx4 v174, s[12:15], s39 offen offset:3072 lds
    s_add_u32 m0, s41, 0x1000
    s_nop 0
    buffer_load_dwordx4 v175, s[12:15], s39 offen lds
    s_lshr_b32 s36, s29, 3
    s_and_b32 s37, s36, 1
    s_mul_i32 s37, s37, 0x12c000
    s_cmp_lt_u32 s36, 2
    s_cselect_b32 s36, 0x77e00, 0
    s_add_u32 s37, s37, s36
    s_add_u32 s37, s37, 0x78700
    s_and_b32 s36, s29, 7
    s_mul_i32 s36, s36, 0x7800
    s_add_u32 s37, s37, s36
    s_and_b32 s36, s28, 1
    s_mul_i32 s36, s36, 0x280
    s_add_u32 s37, s37, s36
    s_lshl_b32 s36, s33, 2
    v_add_u32 v252, s36, v190
    v_and_b32 v253, 7, v252
    v_mul_u32_u24 v253, 0xf00, v253
    v_lshrrev_b32 v252, 3, v252
    v_mul_u32_u24 v252, 0x500, v252
    v_add_u32 v252, v252, v253
    v_mov_b32 v253, 0x7ffffff0
    v_cmp_gt_u32 vcc, 4, v190
    s_nop 1
    v_cndmask_b32 v252, v253, v252, vcc
    buffer_load_dword v254, v252, s[12:15], s37 offen
    s_mov_b32 s16, s66
    s_mov_b32 s17, s67
    s_mov_b32 s18, 0x1000000
    s_mov_b32 s19, 0x20000
    s_mov_b32 s20, s64
    s_mov_b32 s21, s65
    s_mov_b32 s22, 0x100
    s_mov_b32 s23, 0x20000
    s_mov_b32 s24, s68
    s_mov_b32 s25, s69
    s_mov_b32 s26, 0x500
    s_mov_b32 s27, 0x20000
    s_bitcmp0_b32 s94, 3
    s_cselect_b32 s4, s70, s54
    s_cselect_b32 s5, s71, s55
    s_mov_b32 s6, 0xc8000
    s_mov_b32 s7, 0x20000
    s_mov_b32 s70, s60
    s_mov_b32 s71, s61
    s_mov_b32 s88, 0x3fb8aa3b
    s_mov_b32 s89, 0x358637bd
    s_mov_b32 s90, 0x3f803f80
    s_mov_b32 s91, 0x7ffffff0
    s_add_u32 m0, s40, 0x4000
    s_lshl_b32 s38, s92, 7
    buffer_load_dwordx4 v176, s[8:11], s38 offen lds
    buffer_load_dwordx4 v177, s[8:11], s38 offen offset:1024 lds
    s_add_u32 m0, s40, 0x4800
    s_nop 0
    buffer_load_dwordx4 v178, s[8:11], s38 offen lds
    buffer_load_dwordx4 v179, s[8:11], s38 offen offset:1024 lds
    s_add_u32 m0, s29, 0x1000
    s_nop 0
    buffer_load_dwordx4 v182, s[8:11], s38 offen lds
    s_add_u32 m0, s40, 0x8000
    s_add_u32 s36, s92, 1
    s_sub_u32 s37, s36, 10
    s_cmp_lt_u32 s36, 10
    s_cselect_b32 s36, s36, s37
    s_lshl_b32 s38, s36, 7
    buffer_load_dwordx4 v176, s[8:11], s38 offen lds
    buffer_load_dwordx4 v177, s[8:11], s38 offen offset:1024 lds
    s_add_u32 m0, s40, 0x8800
    s_nop 0
    buffer_load_dwordx4 v178, s[8:11], s38 offen lds
    buffer_load_dwordx4 v179, s[8:11], s38 offen offset:1024 lds
    s_add_u32 m0, s29, 0x2000
    s_nop 0
    buffer_load_dwordx4 v182, s[8:11], s38 offen lds
    s_or_b32 s36, s100, 1
    v_mov_b32 v33, s36
    s_cmp_eq_u32 s94, 0
    s_cselect_b32 s36, 0, s91
    v_mov_b32 v32, s91
    v_cmp_eq_u32 vcc, 0, v191
    s_nop 1
    v_cndmask_b32 v32, v32, 0, vcc
    buffer_store_dword v33, v32, s[20:23], s36 offen sc1
    v_lshrrev_b32 v41, 4, v190
    v_lshrrev_b32 v40, 2, v190
    v_and_b32 v40, 3, v40
    v_lshlrev_b32 v42, 3, v41
    v_add_u32 v40, v40, v42
    v_mul_u32_u24 v47, 0x140, v40
    v_and_b32 v46, 1, v41
    v_lshlrev_b32 v46, 1, v46
    s_mul_i32 s43, s35, 0x50
    s_lshl_b32 s42, s35, 1
    v_and_b32 v48, 3, v190
    v_lshlrev_b32 v0, 3, v48
    v_lshlrev_b32 v4, 3, v48
    v_lshlrev_b32 v8, 3, v48
    v_lshlrev_b32 v12, 3, v48
    v_and_b32 v16, 1, v48
    v_xor_b32 v20, s42, v48
    v_xor_b32 v24, s42, v48
    v_and_b32 v40, 15, v190
    v_add_u32 v0, s43, v0
    v_add_u32 v4, s43, v4
    v_add_u32 v8, s43, v8
    v_add_u32 v12, s43, v12
    v_mul_u32_u24 v16, 40, v16
    v_mul_u32_u24 v20, 40, v20
    v_mul_u32_u24 v24, 40, v24
    s_lshl_b32 s36, s34, 6
    v_lshrrev_b32 v1, 4, v0
    v_add_u32 v4, 40, v4
    v_lshrrev_b32 v9, 4, v8
    v_add_u32 v12, 40, v12
    v_add_u32 v16, s43, v16
    v_add_u32 v20, 32, v20
    v_add_u32 v24, 32, v24
    v_add_u32 v40, s36, v40
    v_and_b32 v0, 8, v0
    v_lshrrev_b32 v5, 4, v4
    v_add_u32 v10, 11, v9
    v_lshrrev_b32 v13, 4, v12
    v_add_u32 v16, 32, v16
    v_lshrrev_b32 v21, 4, v20
    v_lshrrev_b32 v25, 4, v24
    v_lshlrev_b32 v40, 7, v40
    v_add_u32 v1, v1, v46
    v_and_b32 v4, 8, v4
    v_cmp_eq_u32 s[76:77], 9, v9
    v_add_u32 v14, 11, v13
    v_lshrrev_b32 v17, 4, v16
    v_and_b32 v20, 8, v20
    v_add_u32 v26, 11, v25
    v_lshrrev_b32 v41, 4, v190
    v_subrev_u32 v2, 20, v1
    v_add_u32 v5, v5, v46
    v_and_b32 v11, 2, v48
    v_cmp_eq_u32 s[78:79], 9, v13
    v_add_u32 v18, 11, v17
    v_add_u32 v21, v21, v46
    v_cmp_eq_u32 s[84:85], 9, v25
    v_and_b32 v42, 7, v190
    v_cmp_lt_u32 s[72:73], 19, v1
    v_subrev_u32 v6, 20, v5
    v_and_b32 v8, 8, v8
    v_and_b32 v15, 2, v48
    v_cmp_eq_u32 s[80:81], 9, v17
    v_subrev_u32 v22, 20, v21
    v_and_b32 v27, 2, v48
    v_xor_b32 v41, v41, v42
    v_add_u32 v0, v0, v47
    v_cmp_lt_u32 s[74:75], 19, v5
    v_cndmask_b32 v10, v10, 10, s[76:77]
    v_and_b32 v12, 8, v12
    v_and_b32 v19, 2, v48
    v_cmp_lt_u32 s[82:83], 19, v21
    v_and_b32 v24, 8, v24
    v_lshlrev_b32 v41, 4, v41
    v_cndmask_b32 v1, v1, v2, s[72:73]
    v_add_u32 v4, v4, v47
    v_mov_b32 v9, v10
    v_cndmask_b32 v14, v14, 10, s[78:79]
    v_and_b32 v16, 8, v16
    v_add_u32 v20, v20, v47
    v_cndmask_b32 v26, v26, 10, s[84:85]
    v_add_u32 v40, v40, v41
    v_lshlrev_b32 v1, 4, v1
    v_cndmask_b32 v5, v5, v6, s[74:75]
    v_add_u32 v9, v9, v46
    v_mov_b32 v13, v14
    v_cndmask_b32 v18, v18, 10, s[80:81]
    v_cndmask_b32 v21, v21, v22, s[82:83]
    v_mov_b32 v25, v26
    s_lshl_b32 s36, s35, 12
    v_add_u32 v160, v1, v0
    v_lshlrev_b32 v5, 4, v5
    v_subrev_u32 v10, 20, v9
    v_add_u32 v13, v13, v46
    v_cmp_ne_u32 s[80:81], 0, v19
    v_lshlrev_b32 v21, 4, v21
    v_add_u32 v25, v25, v46
    s_add_u32 s37, s36, 0xf000
    v_add_u32 v161, v5, v4
    v_cmp_lt_u32 s[76:77], 19, v9
    v_subrev_u32 v14, 20, v13
    v_cndmask_b32 v17, v17, v18, s[80:81]
    v_add_u32 v165, v21, v20
    v_subrev_u32 v26, 20, v25
    v_add_u32 v167, s37, v40
    v_add_u32 v8, v8, v47
    v_cmp_lt_u32 s[78:79], 19, v13
    v_add_u32 v17, v17, v46
    v_cmp_lt_u32 s[84:85], 19, v25
    s_sub_u32 s37, 0x10000, s36
    v_cndmask_b32 v9, v9, v10, s[76:77]
    v_add_u32 v12, v12, v47
    v_subrev_u32 v18, 20, v17
    v_add_u32 v24, v24, v47
    v_add_u32 v168, s37, v40
    v_lshlrev_b32 v9, 4, v9
    v_cndmask_b32 v13, v13, v14, s[78:79]
    v_cmp_lt_u32 s[80:81], 19, v17
    v_cndmask_b32 v25, v25, v26, s[84:85]
    v_xor_b32 v169, 64, v167
    v_add_u32 v162, v9, v8
    v_lshlrev_b32 v13, 4, v13
    v_add_u32 v16, v16, v47
    v_lshlrev_b32 v25, 4, v25
    v_xor_b32 v170, 64, v168
    v_add_u32 v163, v13, v12
    v_cndmask_b32 v17, v17, v18, s[80:81]
    v_add_u32 v166, v25, v24
    v_lshlrev_b32 v17, 4, v17
    v_add_u32 v164, v17, v16
    s_cmp_eq_u32 s34, 1
    s_cselect_b64 s[72:73], -1, 0
    v_and_b32 v40, 3, v190
    v_cmp_le_u32 s[82:83], 1, v40
    v_cmp_le_u32 s[84:85], 2, v40
    v_cmp_le_u32 s[86:87], 3, v40
    s_add_u32 m0, s41, 0x5000
    s_mul_i32 s39, s92, 0x3c000
    s_add_u32 s92, s92, 1
    s_sub_u32 s36, s92, 10
    s_cmp_lt_u32 s92, 10
    s_cselect_b32 s92, s92, s36
    buffer_load_dwordx4 v171, s[12:15], s39 offen offset:0 lds
    buffer_load_dwordx4 v172, s[12:15], s39 offen offset:1024 lds
    buffer_load_dwordx4 v173, s[12:15], s39 offen offset:2048 lds
    buffer_load_dwordx4 v174, s[12:15], s39 offen offset:3072 lds
    s_add_u32 m0, s41, 0x6000
    s_nop 0
    buffer_load_dwordx4 v175, s[12:15], s39 offen lds
    s_add_u32 m0, s41, 0xa000
    s_mul_i32 s39, s92, 0x3c000
    s_add_u32 s92, s92, 1
    s_sub_u32 s36, s92, 10
    s_cmp_lt_u32 s92, 10
    s_cselect_b32 s92, s92, s36
    buffer_load_dwordx4 v171, s[12:15], s39 offen offset:0 lds
    buffer_load_dwordx4 v172, s[12:15], s39 offen offset:1024 lds
    buffer_load_dwordx4 v173, s[12:15], s39 offen offset:2048 lds
    buffer_load_dwordx4 v174, s[12:15], s39 offen offset:3072 lds
    s_add_u32 m0, s41, 0xb000
    s_nop 0
    buffer_load_dwordx4 v175, s[12:15], s39 offen lds
    s_waitcnt vmcnt(22)
    s_barrier
    ds_read_b64_tr_b16 v[120:121], v160 offset:0
    ds_read_b64_tr_b16 v[122:123], v160 offset:1280
    ds_read_b128 a[0:3], v167 offset:0
    ds_read_b128 a[4:7], v167 offset:2048
    ds_read_b128 a[8:11], v168 offset:0
    ds_read_b128 a[12:15], v168 offset:2048
    ds_read_b64_tr_b16 v[124:125], v161 offset:0
    ds_read_b64_tr_b16 v[126:127], v161 offset:1280
    ds_read_b64_tr_b16 v[128:129], v162 offset:0
    ds_read_b64_tr_b16 v[130:131], v162 offset:1280
    ds_read_b64_tr_b16 v[132:133], v163 offset:0
    ds_read_b64_tr_b16 v[134:135], v163 offset:1280
    ds_read_b64_tr_b16 v[136:137], v165 offset:0
    ds_read_b64_tr_b16 v[138:139], v165 offset:1280
    ds_read_b64_tr_b16 v[140:141], v166 offset:0
    ds_read_b64_tr_b16 v[142:143], v166 offset:1280
    ds_read_b128 v[104:107], v183 offset:0
    s_waitcnt lgkmcnt(14)
    v_mfma_f32_16x16x32_bf16 v[0:3], v[120:123], a[0:3], 0
    ds_read_b64_tr_b16 v[144:145], v160 offset:10240
    s_waitcnt lgkmcnt(14)
    v_mfma_f32_16x16x32_bf16 v[4:7], v[120:123], a[4:7], 0
    ds_read_b64_tr_b16 v[146:147], v160 offset:11520
    s_waitcnt lgkmcnt(14)
    v_mfma_f32_16x16x32_bf16 v[8:11], v[120:123], a[8:11], 0
    ds_read_b128 a[16:19], v169 offset:0
    s_waitcnt lgkmcnt(14)
    v_mfma_f32_16x16x32_bf16 v[12:15], v[120:123], a[12:15], 0
    s_waitcnt lgkmcnt(12)
    v_mfma_f32_16x16x32_bf16 v[16:19], v[124:127], a[0:3], 0
    ds_read_b128 a[20:23], v169 offset:2048
    v_mfma_f32_16x16x32_bf16 v[20:23], v[124:127], a[4:7], 0
    ds_read_b128 a[24:27], v170 offset:0
    v_mfma_f32_16x16x32_bf16 v[24:27], v[124:127], a[8:11], 0
    v_mfma_f32_16x16x32_bf16 v[28:31], v[124:127], a[12:15], 0
    ds_read_b128 a[28:31], v170 offset:2048
    s_waitcnt lgkmcnt(13)
    v_mfma_f32_16x16x32_bf16 v[32:35], a[0:3], v[128:131], 0
    ds_read_b64_tr_b16 v[148:149], v161 offset:10240
    v_cndmask_b32 v92, v120, v128, s[72:73]
    v_cndmask_b32 v93, v121, v129, s[72:73]
    v_cndmask_b32 v94, v122, v130, s[72:73]
    v_cndmask_b32 v95, v123, v131, s[72:73]
    v_mfma_f32_16x16x32_bf16 v[36:39], a[4:7], v[128:131], 0
    ds_read_b64_tr_b16 v[150:151], v161 offset:11520
    v_mfma_f32_16x16x32_bf16 v[40:43], a[8:11], v[128:131], 0
    ds_read_b64_tr_b16 v[152:153], v162 offset:10240
    v_mfma_f32_16x16x32_bf16 v[44:47], a[12:15], v[128:131], 0
    s_waitcnt lgkmcnt(14)
    v_mfma_f32_16x16x32_bf16 v[48:51], a[0:3], v[132:135], 0
    ds_read_b64_tr_b16 v[154:155], v162 offset:11520
    v_cndmask_b32 v96, v124, v132, s[72:73]
    v_cndmask_b32 v97, v125, v133, s[72:73]
    v_cndmask_b32 v98, v126, v134, s[72:73]
    v_cndmask_b32 v99, v127, v135, s[72:73]
    ds_read_b64_tr_b16 v[156:157], v163 offset:10240
    v_mfma_f32_16x16x32_bf16 v[52:55], a[4:7], v[132:135], 0
    ds_read_b64_tr_b16 v[158:159], v163 offset:11520
    v_mfma_f32_16x16x32_bf16 v[56:59], a[8:11], v[132:135], 0
    v_mfma_f32_16x16x32_bf16 v[60:63], a[12:15], v[132:135], 0
    ds_read_b64_tr_b16 v[112:113], v165 offset:10240
    s_waitcnt lgkmcnt(15)
    v_mfma_f32_16x16x32_bf16 v[64:67], v[136:139], a[0:3], 0
    ds_read_b64_tr_b16 v[114:115], v165 offset:11520
    v_mfma_f32_16x16x32_bf16 v[68:71], v[136:139], a[4:7], 0
    s_waitcnt lgkmcnt(15)
    v_mfma_f32_16x16x32_bf16 v[72:75], a[0:3], v[140:143], 0
    ds_read_b64_tr_b16 v[116:117], v166 offset:10240
    v_cndmask_b32 v100, v136, v140, s[72:73]
    v_cndmask_b32 v101, v137, v141, s[72:73]
    v_cndmask_b32 v102, v138, v142, s[72:73]
    v_cndmask_b32 v103, v139, v143, s[72:73]
    ds_read_b64_tr_b16 v[118:119], v166 offset:11520
    v_mfma_f32_16x16x32_bf16 v[76:79], a[4:7], v[140:143], 0
    s_waitcnt lgkmcnt(15)
    v_mfma_f32_16x16x32_bf16 v[80:83], v[104:107], v[92:95], 0
    ds_read_b128 v[108:111], v184 offset:0
    v_mfma_f32_16x16x32_bf16 v[84:87], v[104:107], v[96:99], 0
    s_lshl_b32 s36, s33, 4
    s_lshr_b32 s37, s94, 4
    s_add_u32 s36, s36, s37
    s_cmp_lt_u32 s36, 20
    s_cbranch_scc0 Lwp_28
    s_and_b32 s37, s94, 15
    s_mul_i32 s37, s37, 0x64
    s_mul_i32 s42, s36, 5
    s_add_u32 s37, s37, s42
    s_lshl_b32 s37, s37, 10
    s_add_u32 s99, s37, 0xc00000
    s_mul_i32 s37, s36, 0xcd
    s_lshr_b32 s37, s37, 10
    s_mul_i32 s42, s37, 5
    s_sub_u32 s42, s36, s42
    s_mul_i32 s37, s37, 0xa0
    s_mul_i32 s43, s42, 40
    s_cmp_eq_u32 s42, 4
    s_cselect_b32 s43, 16, s43
    s_cselect_b32 s100, 0x50, 4
    s_cselect_b32 s101, 40, 8
    s_add_u32 s37, s37, s43
    s_mul_i32 s37, s37, 0x500
    s_and_b32 s42, s94, 15
    s_and_b32 s42, s42, 7
    s_mul_i32 s42, s42, 0xa0
    s_add_u32 s98, s37, s42
    s_mul_i32 s100, s100, 0x500
    s_mul_i32 s101, s101, 0x500
    s_movk_i32 s43, 0x500
    s_movk_i32 s42, 0x6400
    v_add_u32 v224, 0, v190
    v_add_u32 v228, 64, v190
    v_add_u32 v232, 0x80, v190
    v_add_u32 v236, 0xc0, v190
    v_add_u32 v240, 0x100, v190
    v_mul_u32_u24 v225, 0xcd, v224
    v_mul_u32_u24 v229, 0xcd, v228
    v_mul_u32_u24 v233, 0xcd, v232
    v_mul_u32_u24 v237, 0xcd, v236
    v_mul_u32_u24 v241, 0xcd, v240
    v_lshrrev_b32 v225, 11, v225
    v_lshrrev_b32 v229, 11, v229
    v_lshrrev_b32 v233, 11, v233
    v_lshrrev_b32 v237, 11, v237
    v_lshrrev_b32 v241, 11, v241
    v_mul_u32_u24 v226, 10, v225
    v_mul_u32_u24 v230, 10, v229
    v_mul_u32_u24 v234, 10, v233
    v_mul_u32_u24 v238, 10, v237
    v_mul_u32_u24 v242, 10, v241
    v_sub_u32 v224, v224, v226
    v_sub_u32 v228, v228, v230
    v_sub_u32 v232, v232, v234
    v_sub_u32 v236, v236, v238
    v_sub_u32 v240, v240, v242
    v_lshlrev_b32 v224, 4, v224
    v_lshlrev_b32 v228, 4, v228
    v_lshlrev_b32 v232, 4, v232
    v_lshlrev_b32 v236, 4, v236
    v_lshlrev_b32 v240, 4, v240
    v_lshrrev_b32 v226, 4, v225
    v_lshrrev_b32 v230, 4, v229
    v_lshrrev_b32 v234, 4, v233
    v_lshrrev_b32 v238, 4, v237
    v_lshrrev_b32 v242, 4, v241
    v_mad_u32_u24 v224, v226, s101, v224
    v_mad_u32_u24 v228, v230, s101, v228
    v_mad_u32_u24 v232, v234, s101, v232
    v_mad_u32_u24 v236, v238, s101, v236
    v_mad_u32_u24 v240, v242, s101, v240
    v_bfe_u32 v226, v225, 3, 1
    v_bfe_u32 v230, v229, 3, 1
    v_bfe_u32 v234, v233, 3, 1
    v_bfe_u32 v238, v237, 3, 1
    v_bfe_u32 v242, v241, 3, 1
    v_mad_u32_u24 v224, v226, s100, v224
    v_mad_u32_u24 v228, v230, s100, v228
    v_mad_u32_u24 v232, v234, s100, v232
    v_mad_u32_u24 v236, v238, s100, v236
    v_mad_u32_u24 v240, v242, s100, v240
    v_bfe_u32 v226, v225, 2, 1
    v_bfe_u32 v230, v229, 2, 1
    v_bfe_u32 v234, v233, 2, 1
    v_bfe_u32 v238, v237, 2, 1
    v_bfe_u32 v242, v241, 2, 1
    v_mad_u32_u24 v224, v226, s42, v224
    v_mad_u32_u24 v228, v230, s42, v228
    v_mad_u32_u24 v232, v234, s42, v232
    v_mad_u32_u24 v236, v238, s42, v236
    v_mad_u32_u24 v240, v242, s42, v240
    v_and_b32 v226, 3, v225
    v_and_b32 v230, 3, v229
    v_and_b32 v234, 3, v233
    v_and_b32 v238, 3, v237
    v_and_b32 v242, 3, v241
    v_mad_u32_u24 v224, v226, s43, v224
    v_mad_u32_u24 v228, v230, s43, v228
    v_mad_u32_u24 v232, v234, s43, v232
    v_mad_u32_u24 v236, v238, s43, v236
    v_mad_u32_u24 v240, v242, s43, v240
    s_mul_i32 s36, s33, 0x1400
    s_add_u32 s36, s36, 0x1e000
    s_add_u32 m0, s36, 0
    s_nop 0
    buffer_load_dwordx4 v224, s[4:7], s98 offen lds
    s_add_u32 m0, s36, 0x400
    s_nop 0
    buffer_load_dwordx4 v228, s[4:7], s98 offen lds
    s_add_u32 m0, s36, 0x800
    s_nop 0
    buffer_load_dwordx4 v232, s[4:7], s98 offen lds
    s_add_u32 m0, s36, 0xc00
    s_nop 0
    buffer_load_dwordx4 v236, s[4:7], s98 offen lds
    s_add_u32 m0, s36, 0x1000
    s_nop 0
    buffer_load_dwordx4 v240, s[4:7], s98 offen lds
Lwp_28:
    v_mfma_f32_16x16x32_bf16 v[88:91], v[104:107], v[100:103], 0
    s_waitcnt vmcnt(5)
    s_waitcnt lgkmcnt(0)
    s_barrier
    v_mfma_f32_16x16x32_bf16 v[0:3], v[144:147], a[16:19], v[0:3]
    ds_read_b64_tr_b16 v[120:121], v160 offset:20480
    v_mfma_f32_16x16x32_bf16 v[4:7], v[144:147], a[20:23], v[4:7]
    s_add_u32 m0, s41, 0
    s_lshl_b32 s38, s92, 7
    s_mul_i32 s39, s92, 0x3c000
    s_add_u32 s92, s92, 1
    s_sub_u32 s36, s92, 10
    s_cmp_lt_u32 s92, 10
    s_cselect_b32 s92, s92, s36
    v_mfma_f32_16x16x32_bf16 v[8:11], v[144:147], a[24:27], v[8:11]
    ds_read_b64_tr_b16 v[122:123], v160 offset:21760
    v_mfma_f32_16x16x32_bf16 v[12:15], v[144:147], a[28:31], v[12:15]
    ds_read_b128 a[32:35], v167 offset:16384
    v_mfma_f32_16x16x32_bf16 v[16:19], v[148:151], a[16:19], v[16:19]
    buffer_load_dwordx4 v171, s[12:15], s39 offen offset:0 lds
    v_mfma_f32_16x16x32_bf16 v[20:23], v[148:151], a[20:23], v[20:23]
    ds_read_b128 a[36:39], v167 offset:18432
    v_mfma_f32_16x16x32_bf16 v[24:27], v[148:151], a[24:27], v[24:27]
    ds_read_b128 a[40:43], v168 offset:16384
    v_mfma_f32_16x16x32_bf16 v[28:31], v[148:151], a[28:31], v[28:31]
    buffer_load_dwordx4 v172, s[12:15], s39 offen offset:1024 lds
    v_mfma_f32_16x16x32_bf16 v[32:35], a[16:19], v[152:155], v[32:35]
    ds_read_b128 a[44:47], v168 offset:18432
    v_cndmask_b32 v92, v144, v152, s[72:73]
    v_cndmask_b32 v93, v145, v153, s[72:73]
    v_cndmask_b32 v94, v146, v154, s[72:73]
    v_cndmask_b32 v95, v147, v155, s[72:73]
    ds_read_b64_tr_b16 v[124:125], v161 offset:20480
    v_mfma_f32_16x16x32_bf16 v[36:39], a[20:23], v[152:155], v[36:39]
    ds_read_b64_tr_b16 v[126:127], v161 offset:21760
    v_mfma_f32_16x16x32_bf16 v[40:43], a[24:27], v[152:155], v[40:43]
    buffer_load_dwordx4 v173, s[12:15], s39 offen offset:2048 lds
    v_mfma_f32_16x16x32_bf16 v[44:47], a[28:31], v[152:155], v[44:47]
    v_mfma_f32_16x16x32_bf16 v[48:51], a[16:19], v[156:159], v[48:51]
    ds_read_b64_tr_b16 v[128:129], v162 offset:20480
    v_cndmask_b32 v96, v148, v156, s[72:73]
    v_cndmask_b32 v97, v149, v157, s[72:73]
    v_cndmask_b32 v98, v150, v158, s[72:73]
    v_cndmask_b32 v99, v151, v159, s[72:73]
    ds_read_b64_tr_b16 v[130:131], v162 offset:21760
    v_mfma_f32_16x16x32_bf16 v[52:55], a[20:23], v[156:159], v[52:55]
    buffer_load_dwordx4 v174, s[12:15], s39 offen offset:3072 lds
    v_mfma_f32_16x16x32_bf16 v[56:59], a[24:27], v[156:159], v[56:59]
    ds_read_b64_tr_b16 v[132:133], v163 offset:20480
    v_mfma_f32_16x16x32_bf16 v[60:63], a[28:31], v[156:159], v[60:63]
    ds_read_b64_tr_b16 v[134:135], v163 offset:21760
    v_mfma_f32_16x16x32_bf16 v[64:67], v[112:115], a[16:19], v[64:67]
    ds_read_b64_tr_b16 v[136:137], v165 offset:20480
    v_mfma_f32_16x16x32_bf16 v[68:71], v[112:115], a[20:23], v[68:71]
    s_add_u32 m0, s41, 0x1000
    v_mfma_f32_16x16x32_bf16 v[72:75], a[16:19], v[116:119], v[72:75]
    ds_read_b64_tr_b16 v[138:139], v165 offset:21760
    v_cndmask_b32 v100, v112, v116, s[72:73]
    v_cndmask_b32 v101, v113, v117, s[72:73]
    v_cndmask_b32 v102, v114, v118, s[72:73]
    v_cndmask_b32 v103, v115, v119, s[72:73]
    ds_read_b64_tr_b16 v[140:141], v166 offset:20480
    v_mfma_f32_16x16x32_bf16 v[76:79], a[20:23], v[116:119], v[76:79]
    buffer_load_dwordx4 v175, s[12:15], s39 offen lds
    v_mfma_f32_16x16x32_bf16 v[80:83], v[108:111], v[92:95], v[80:83]
    ds_read_b64_tr_b16 v[142:143], v166 offset:21760
    v_mfma_f32_16x16x32_bf16 v[84:87], v[108:111], v[96:99], v[84:87]
    ds_read_b128 v[104:107], v183 offset:4096
    v_mfma_f32_16x16x32_bf16 v[88:91], v[108:111], v[100:103], v[88:91]
    s_waitcnt lgkmcnt(14)
    v_mfma_f32_16x16x32_bf16 v[0:3], v[120:123], a[32:35], v[0:3]
    ds_read_b64_tr_b16 v[144:145], v160 offset:30720
    s_waitcnt lgkmcnt(14)
    v_mfma_f32_16x16x32_bf16 v[4:7], v[120:123], a[36:39], v[4:7]
    s_add_u32 m0, s40, 0
    s_waitcnt lgkmcnt(13)
    v_mfma_f32_16x16x32_bf16 v[8:11], v[120:123], a[40:43], v[8:11]
    ds_read_b64_tr_b16 v[146:147], v160 offset:32000
    s_waitcnt lgkmcnt(13)
    v_mfma_f32_16x16x32_bf16 v[12:15], v[120:123], a[44:47], v[12:15]
    buffer_load_dwordx4 v176, s[8:11], s38 offen lds
    s_waitcnt lgkmcnt(11)
    v_mfma_f32_16x16x32_bf16 v[16:19], v[124:127], a[32:35], v[16:19]
    ds_read_b128 a[48:51], v169 offset:16384
    v_mfma_f32_16x16x32_bf16 v[20:23], v[124:127], a[36:39], v[20:23]
    ds_read_b128 a[52:55], v169 offset:18432
    v_mfma_f32_16x16x32_bf16 v[24:27], v[124:127], a[40:43], v[24:27]
    buffer_load_dwordx4 v177, s[8:11], s38 offen offset:1024 lds
    v_mfma_f32_16x16x32_bf16 v[28:31], v[124:127], a[44:47], v[28:31]
    ds_read_b128 a[56:59], v170 offset:16384
    s_waitcnt lgkmcnt(12)
    v_mfma_f32_16x16x32_bf16 v[32:35], a[32:35], v[128:131], v[32:35]
    ds_read_b128 a[60:63], v170 offset:18432
    v_cndmask_b32 v92, v120, v128, s[72:73]
    v_cndmask_b32 v93, v121, v129, s[72:73]
    v_cndmask_b32 v94, v122, v130, s[72:73]
    v_cndmask_b32 v95, v123, v131, s[72:73]
    s_add_u32 m0, s40, 0x800
    v_mfma_f32_16x16x32_bf16 v[36:39], a[36:39], v[128:131], v[36:39]
    ds_read_b64_tr_b16 v[148:149], v161 offset:30720
    v_mfma_f32_16x16x32_bf16 v[40:43], a[40:43], v[128:131], v[40:43]
    ds_read_b64_tr_b16 v[150:151], v161 offset:32000
    v_mfma_f32_16x16x32_bf16 v[44:47], a[44:47], v[128:131], v[44:47]
    buffer_load_dwordx4 v178, s[8:11], s38 offen lds
    s_waitcnt lgkmcnt(13)
    v_mfma_f32_16x16x32_bf16 v[48:51], a[32:35], v[132:135], v[48:51]
    ds_read_b64_tr_b16 v[152:153], v162 offset:30720
    v_cndmask_b32 v96, v124, v132, s[72:73]
    v_cndmask_b32 v97, v125, v133, s[72:73]
    v_cndmask_b32 v98, v126, v134, s[72:73]
    v_cndmask_b32 v99, v127, v135, s[72:73]
    ds_read_b64_tr_b16 v[154:155], v162 offset:32000
    v_mfma_f32_16x16x32_bf16 v[52:55], a[36:39], v[132:135], v[52:55]
    buffer_load_dwordx4 v179, s[8:11], s38 offen offset:1024 lds
    v_mfma_f32_16x16x32_bf16 v[56:59], a[40:43], v[132:135], v[56:59]
    ds_read_b64_tr_b16 v[156:157], v163 offset:30720
    v_mfma_f32_16x16x32_bf16 v[60:63], a[44:47], v[132:135], v[60:63]
    ds_read_b64_tr_b16 v[158:159], v163 offset:32000
    s_waitcnt lgkmcnt(15)
    v_mfma_f32_16x16x32_bf16 v[64:67], v[136:139], a[32:35], v[64:67]
    s_add_u32 m0, s29, 0
    v_mfma_f32_16x16x32_bf16 v[68:71], v[136:139], a[36:39], v[68:71]
    ds_read_b64_tr_b16 v[112:113], v165 offset:30720
    s_waitcnt lgkmcnt(14)
    v_mfma_f32_16x16x32_bf16 v[72:75], a[32:35], v[140:143], v[72:75]
    ds_read_b64_tr_b16 v[114:115], v165 offset:32000
    v_cndmask_b32 v100, v136, v140, s[72:73]
    v_cndmask_b32 v101, v137, v141, s[72:73]
    v_cndmask_b32 v102, v138, v142, s[72:73]
    v_cndmask_b32 v103, v139, v143, s[72:73]
    buffer_load_dwordx4 v182, s[8:11], s38 offen lds
    v_mfma_f32_16x16x32_bf16 v[76:79], a[36:39], v[140:143], v[76:79]
    ds_read_b64_tr_b16 v[116:117], v166 offset:30720
    s_waitcnt lgkmcnt(15)
    v_mfma_f32_16x16x32_bf16 v[80:83], v[104:107], v[92:95], v[80:83]
    ds_read_b64_tr_b16 v[118:119], v166 offset:32000
    v_mfma_f32_16x16x32_bf16 v[84:87], v[104:107], v[96:99], v[84:87]
    v_mfma_f32_16x16x32_bf16 v[88:91], v[104:107], v[100:103], v[88:91]
    ds_read_b128 v[108:111], v184 offset:4096
    s_waitcnt vmcnt(10)
    s_waitcnt lgkmcnt(0)
    s_barrier
    v_mfma_f32_16x16x32_bf16 v[0:3], v[144:147], a[48:51], v[0:3]
    ds_read_b64_tr_b16 v[120:121], v160 offset:40960
    v_mfma_f32_16x16x32_bf16 v[4:7], v[144:147], a[52:55], v[4:7]
    s_add_u32 m0, s41, 0x5000
    s_lshl_b32 s38, s92, 7
    s_mul_i32 s39, s92, 0x3c000
    s_add_u32 s92, s92, 1
    s_sub_u32 s36, s92, 10
    s_cmp_lt_u32 s92, 10
    s_cselect_b32 s92, s92, s36
    v_mfma_f32_16x16x32_bf16 v[8:11], v[144:147], a[56:59], v[8:11]
    ds_read_b64_tr_b16 v[122:123], v160 offset:42240
    v_mfma_f32_16x16x32_bf16 v[12:15], v[144:147], a[60:63], v[12:15]
    ds_read_b128 a[64:67], v167 offset:32768
    v_mfma_f32_16x16x32_bf16 v[16:19], v[148:151], a[48:51], v[16:19]
    buffer_load_dwordx4 v171, s[12:15], s39 offen offset:0 lds
    v_mfma_f32_16x16x32_bf16 v[20:23], v[148:151], a[52:55], v[20:23]
    ds_read_b128 a[68:71], v167 offset:34816
    v_mfma_f32_16x16x32_bf16 v[24:27], v[148:151], a[56:59], v[24:27]
    ds_read_b128 a[72:75], v168 offset:32768
    v_mfma_f32_16x16x32_bf16 v[28:31], v[148:151], a[60:63], v[28:31]
    buffer_load_dwordx4 v172, s[12:15], s39 offen offset:1024 lds
    v_mfma_f32_16x16x32_bf16 v[32:35], a[48:51], v[152:155], v[32:35]
    ds_read_b128 a[76:79], v168 offset:34816
    v_cndmask_b32 v92, v144, v152, s[72:73]
    v_cndmask_b32 v93, v145, v153, s[72:73]
    v_cndmask_b32 v94, v146, v154, s[72:73]
    v_cndmask_b32 v95, v147, v155, s[72:73]
    ds_read_b64_tr_b16 v[124:125], v161 offset:40960
    v_mfma_f32_16x16x32_bf16 v[36:39], a[52:55], v[152:155], v[36:39]
    ds_read_b64_tr_b16 v[126:127], v161 offset:42240
    v_mfma_f32_16x16x32_bf16 v[40:43], a[56:59], v[152:155], v[40:43]
    buffer_load_dwordx4 v173, s[12:15], s39 offen offset:2048 lds
    v_mfma_f32_16x16x32_bf16 v[44:47], a[60:63], v[152:155], v[44:47]
    v_mfma_f32_16x16x32_bf16 v[48:51], a[48:51], v[156:159], v[48:51]
    ds_read_b64_tr_b16 v[128:129], v162 offset:40960
    v_cndmask_b32 v96, v148, v156, s[72:73]
    v_cndmask_b32 v97, v149, v157, s[72:73]
    v_cndmask_b32 v98, v150, v158, s[72:73]
    v_cndmask_b32 v99, v151, v159, s[72:73]
    ds_read_b64_tr_b16 v[130:131], v162 offset:42240
    v_mfma_f32_16x16x32_bf16 v[52:55], a[52:55], v[156:159], v[52:55]
    buffer_load_dwordx4 v174, s[12:15], s39 offen offset:3072 lds
    v_mfma_f32_16x16x32_bf16 v[56:59], a[56:59], v[156:159], v[56:59]
    ds_read_b64_tr_b16 v[132:133], v163 offset:40960
    v_mfma_f32_16x16x32_bf16 v[60:63], a[60:63], v[156:159], v[60:63]
    ds_read_b64_tr_b16 v[134:135], v163 offset:42240
    v_mfma_f32_16x16x32_bf16 v[64:67], v[112:115], a[48:51], v[64:67]
    ds_read_b64_tr_b16 v[136:137], v165 offset:40960
    v_mfma_f32_16x16x32_bf16 v[68:71], v[112:115], a[52:55], v[68:71]
    s_add_u32 m0, s41, 0x6000
    v_mfma_f32_16x16x32_bf16 v[72:75], a[48:51], v[116:119], v[72:75]
    ds_read_b64_tr_b16 v[138:139], v165 offset:42240
    v_cndmask_b32 v100, v112, v116, s[72:73]
    v_cndmask_b32 v101, v113, v117, s[72:73]
    v_cndmask_b32 v102, v114, v118, s[72:73]
    v_cndmask_b32 v103, v115, v119, s[72:73]
    ds_read_b64_tr_b16 v[140:141], v166 offset:40960
    v_mfma_f32_16x16x32_bf16 v[76:79], a[52:55], v[116:119], v[76:79]
    buffer_load_dwordx4 v175, s[12:15], s39 offen lds
    v_mfma_f32_16x16x32_bf16 v[80:83], v[108:111], v[92:95], v[80:83]
    ds_read_b64_tr_b16 v[142:143], v166 offset:42240
    v_mfma_f32_16x16x32_bf16 v[84:87], v[108:111], v[96:99], v[84:87]
    ds_read_b128 v[104:107], v183 offset:8192
    v_mfma_f32_16x16x32_bf16 v[88:91], v[108:111], v[100:103], v[88:91]
    s_waitcnt lgkmcnt(14)
    v_mfma_f32_16x16x32_bf16 v[0:3], v[120:123], a[64:67], v[0:3]
    ds_read_b64_tr_b16 v[144:145], v160 offset:51200
    s_waitcnt lgkmcnt(14)
    v_mfma_f32_16x16x32_bf16 v[4:7], v[120:123], a[68:71], v[4:7]
    s_add_u32 m0, s40, 0x4000
    s_waitcnt lgkmcnt(13)
    v_mfma_f32_16x16x32_bf16 v[8:11], v[120:123], a[72:75], v[8:11]
    ds_read_b64_tr_b16 v[146:147], v160 offset:52480
    s_waitcnt lgkmcnt(13)
    v_mfma_f32_16x16x32_bf16 v[12:15], v[120:123], a[76:79], v[12:15]
    buffer_load_dwordx4 v176, s[8:11], s38 offen lds
    s_waitcnt lgkmcnt(11)
    v_mfma_f32_16x16x32_bf16 v[16:19], v[124:127], a[64:67], v[16:19]
    ds_read_b128 a[80:83], v169 offset:32768
    v_mfma_f32_16x16x32_bf16 v[20:23], v[124:127], a[68:71], v[20:23]
    ds_read_b128 a[84:87], v169 offset:34816
    v_mfma_f32_16x16x32_bf16 v[24:27], v[124:127], a[72:75], v[24:27]
    buffer_load_dwordx4 v177, s[8:11], s38 offen offset:1024 lds
    v_mfma_f32_16x16x32_bf16 v[28:31], v[124:127], a[76:79], v[28:31]
    ds_read_b128 a[88:91], v170 offset:32768
    s_waitcnt lgkmcnt(12)
    v_mfma_f32_16x16x32_bf16 v[32:35], a[64:67], v[128:131], v[32:35]
    ds_read_b128 a[92:95], v170 offset:34816
    v_cndmask_b32 v92, v120, v128, s[72:73]
    v_cndmask_b32 v93, v121, v129, s[72:73]
    v_cndmask_b32 v94, v122, v130, s[72:73]
    v_cndmask_b32 v95, v123, v131, s[72:73]
    s_add_u32 m0, s40, 0x4800
    v_mfma_f32_16x16x32_bf16 v[36:39], a[68:71], v[128:131], v[36:39]
    ds_read_b64_tr_b16 v[148:149], v161 offset:51200
    v_mfma_f32_16x16x32_bf16 v[40:43], a[72:75], v[128:131], v[40:43]
    ds_read_b64_tr_b16 v[150:151], v161 offset:52480
    v_mfma_f32_16x16x32_bf16 v[44:47], a[76:79], v[128:131], v[44:47]
    buffer_load_dwordx4 v178, s[8:11], s38 offen lds
    s_waitcnt lgkmcnt(13)
    v_mfma_f32_16x16x32_bf16 v[48:51], a[64:67], v[132:135], v[48:51]
    ds_read_b64_tr_b16 v[152:153], v162 offset:51200
    v_cndmask_b32 v96, v124, v132, s[72:73]
    v_cndmask_b32 v97, v125, v133, s[72:73]
    v_cndmask_b32 v98, v126, v134, s[72:73]
    v_cndmask_b32 v99, v127, v135, s[72:73]
    ds_read_b64_tr_b16 v[154:155], v162 offset:52480
    v_mfma_f32_16x16x32_bf16 v[52:55], a[68:71], v[132:135], v[52:55]
    buffer_load_dwordx4 v179, s[8:11], s38 offen offset:1024 lds
    v_mfma_f32_16x16x32_bf16 v[56:59], a[72:75], v[132:135], v[56:59]
    ds_read_b64_tr_b16 v[156:157], v163 offset:51200
    v_mfma_f32_16x16x32_bf16 v[60:63], a[76:79], v[132:135], v[60:63]
    ds_read_b64_tr_b16 v[158:159], v163 offset:52480
    s_waitcnt lgkmcnt(15)
    v_mfma_f32_16x16x32_bf16 v[64:67], v[136:139], a[64:67], v[64:67]
    s_add_u32 m0, s29, 0x1000
    v_mfma_f32_16x16x32_bf16 v[68:71], v[136:139], a[68:71], v[68:71]
    ds_read_b64_tr_b16 v[112:113], v165 offset:51200
    s_waitcnt lgkmcnt(14)
    v_mfma_f32_16x16x32_bf16 v[72:75], a[64:67], v[140:143], v[72:75]
    ds_read_b64_tr_b16 v[114:115], v165 offset:52480
    v_cndmask_b32 v100, v136, v140, s[72:73]
    v_cndmask_b32 v101, v137, v141, s[72:73]
    v_cndmask_b32 v102, v138, v142, s[72:73]
    v_cndmask_b32 v103, v139, v143, s[72:73]
    buffer_load_dwordx4 v182, s[8:11], s38 offen lds
    v_mfma_f32_16x16x32_bf16 v[76:79], a[68:71], v[140:143], v[76:79]
    ds_read_b64_tr_b16 v[116:117], v166 offset:51200
    s_waitcnt lgkmcnt(15)
    v_mfma_f32_16x16x32_bf16 v[80:83], v[104:107], v[92:95], v[80:83]
    ds_read_b64_tr_b16 v[118:119], v166 offset:52480
    v_mfma_f32_16x16x32_bf16 v[84:87], v[104:107], v[96:99], v[84:87]
    v_mfma_f32_16x16x32_bf16 v[88:91], v[104:107], v[100:103], v[88:91]
    ds_read_b128 v[108:111], v184 offset:8192
    s_waitcnt vmcnt(10)
    s_waitcnt lgkmcnt(0)
    s_barrier
    v_mfma_f32_16x16x32_bf16 v[0:3], v[144:147], a[80:83], v[0:3]
    ds_read_b64_tr_b16 v[120:121], v160 offset:0
    v_mfma_f32_16x16x32_bf16 v[4:7], v[144:147], a[84:87], v[4:7]
    ds_read_b64_tr_b16 v[122:123], v160 offset:1280
    v_mfma_f32_16x16x32_bf16 v[8:11], v[144:147], a[88:91], v[8:11]
    ds_read_b128 a[96:99], v167 offset:0
    v_mfma_f32_16x16x32_bf16 v[12:15], v[144:147], a[92:95], v[12:15]
    ds_read_b128 a[100:103], v167 offset:2048
    v_mfma_f32_16x16x32_bf16 v[16:19], v[148:151], a[80:83], v[16:19]
    ds_read_b128 a[104:107], v168 offset:0
    v_mfma_f32_16x16x32_bf16 v[20:23], v[148:151], a[84:87], v[20:23]
    ds_read_b128 a[108:111], v168 offset:2048
    v_mfma_f32_16x16x32_bf16 v[24:27], v[148:151], a[88:91], v[24:27]
    ds_read_b64_tr_b16 v[124:125], v161 offset:0
    v_mfma_f32_16x16x32_bf16 v[28:31], v[148:151], a[92:95], v[28:31]
    ds_read_b64_tr_b16 v[126:127], v161 offset:1280
    v_mfma_f32_16x16x32_bf16 v[32:35], a[80:83], v[152:155], v[32:35]
    ds_read_b64_tr_b16 v[128:129], v162 offset:0
    v_cndmask_b32 v92, v144, v152, s[72:73]
    v_cndmask_b32 v93, v145, v153, s[72:73]
    v_cndmask_b32 v94, v146, v154, s[72:73]
    v_cndmask_b32 v95, v147, v155, s[72:73]
    ds_read_b64_tr_b16 v[130:131], v162 offset:1280
    v_mfma_f32_16x16x32_bf16 v[36:39], a[84:87], v[152:155], v[36:39]
    ds_read_b64_tr_b16 v[132:133], v163 offset:0
    v_mfma_f32_16x16x32_bf16 v[40:43], a[88:91], v[152:155], v[40:43]
    ds_read_b64_tr_b16 v[134:135], v163 offset:1280
    v_mfma_f32_16x16x32_bf16 v[44:47], a[92:95], v[152:155], v[44:47]
    ds_read_b64_tr_b16 v[136:137], v165 offset:0
    v_mfma_f32_16x16x32_bf16 v[48:51], a[80:83], v[156:159], v[48:51]
    ds_read_b64_tr_b16 v[138:139], v165 offset:1280
    v_cndmask_b32 v96, v148, v156, s[72:73]
    v_cndmask_b32 v97, v149, v157, s[72:73]
    v_cndmask_b32 v98, v150, v158, s[72:73]
    v_cndmask_b32 v99, v151, v159, s[72:73]
    ds_read_b64_tr_b16 v[140:141], v166 offset:0
    v_mfma_f32_16x16x32_bf16 v[52:55], a[84:87], v[156:159], v[52:55]
    ds_read_b64_tr_b16 v[142:143], v166 offset:1280
    v_mfma_f32_16x16x32_bf16 v[56:59], a[88:91], v[156:159], v[56:59]
    ds_read_b128 v[104:107], v183 offset:0
    v_mfma_f32_16x16x32_bf16 v[60:63], a[92:95], v[156:159], v[60:63]
    s_add_u32 m0, s41, 0xa000
    s_lshl_b32 s38, s92, 7
    s_mul_i32 s39, s92, 0x3c000
    s_add_u32 s92, s92, 1
    s_sub_u32 s36, s92, 10
    s_cmp_lt_u32 s92, 10
    s_cselect_b32 s92, s92, s36
    v_mfma_f32_16x16x32_bf16 v[64:67], v[112:115], a[80:83], v[64:67]
    buffer_load_dwordx4 v171, s[12:15], s39 offen offset:0 lds
    v_mfma_f32_16x16x32_bf16 v[68:71], v[112:115], a[84:87], v[68:71]
    buffer_load_dwordx4 v172, s[12:15], s39 offen offset:1024 lds
    v_mfma_f32_16x16x32_bf16 v[72:75], a[80:83], v[116:119], v[72:75]
    buffer_load_dwordx4 v173, s[12:15], s39 offen offset:2048 lds
    v_cndmask_b32 v100, v112, v116, s[72:73]
    v_cndmask_b32 v101, v113, v117, s[72:73]
    v_cndmask_b32 v102, v114, v118, s[72:73]
    v_cndmask_b32 v103, v115, v119, s[72:73]
    buffer_load_dwordx4 v174, s[12:15], s39 offen offset:3072 lds
    v_mfma_f32_16x16x32_bf16 v[76:79], a[84:87], v[116:119], v[76:79]
    s_add_u32 m0, s41, 0xb000
    v_mfma_f32_16x16x32_bf16 v[80:83], v[108:111], v[92:95], v[80:83]
    buffer_load_dwordx4 v175, s[12:15], s39 offen lds
    v_mfma_f32_16x16x32_bf16 v[84:87], v[108:111], v[96:99], v[84:87]
    s_lshl_b32 s36, s33, 4
    s_lshr_b32 s37, s94, 4
    s_add_u32 s36, s36, s37
    s_cmp_lt_u32 s36, 20
    s_cbranch_scc0 Lwq_29
    s_waitcnt vmcnt(25)
    v_lshrrev_b32 v224, 4, v190
    v_lshlrev_b32 v224, 3, v224
    v_bfe_u32 v225, v190, 2, 2
    v_add_u32 v224, v224, v225
    v_mul_u32_u24 v224, 0xa0, v224
    v_and_b32 v225, 3, v190
    v_mul_u32_u24 v225, 40, v225
    s_mul_i32 s36, s33, 0x1400
    s_add_u32 s36, s36, 0x1e000
    v_add3_u32 v224, v224, v225, s36
    ds_read_b64_tr_b16 v[228:229], v224 offset:0
    ds_read_b64_tr_b16 v[230:231], v224 offset:640
    ds_read_b64_tr_b16 v[232:233], v224 offset:8
    ds_read_b64_tr_b16 v[234:235], v224 offset:648
    ds_read_b64_tr_b16 v[236:237], v224 offset:16
    ds_read_b64_tr_b16 v[238:239], v224 offset:656
    ds_read_b64_tr_b16 v[240:241], v224 offset:24
    ds_read_b64_tr_b16 v[242:243], v224 offset:664
    ds_read_b64_tr_b16 v[244:245], v224 offset:32
    ds_read_b64_tr_b16 v[246:247], v224 offset:672
    v_lshlrev_b32 v225, 4, v190
    s_add_u32 s37, s99, 0x1000
    s_waitcnt lgkmcnt(8)
    buffer_store_dwordx4 v[228:231], v225, s[16:19], s99 offen offset:0 sc1
    s_waitcnt lgkmcnt(6)
    buffer_store_dwordx4 v[232:235], v225, s[16:19], s99 offen offset:1024 sc1
    s_waitcnt lgkmcnt(4)
    buffer_store_dwordx4 v[236:239], v225, s[16:19], s99 offen offset:2048 sc1
    s_waitcnt lgkmcnt(2)
    buffer_store_dwordx4 v[240:243], v225, s[16:19], s99 offen offset:3072 sc1
    s_waitcnt lgkmcnt(0)
    buffer_store_dwordx4 v[244:247], v225, s[16:19], s37 offen offset:0 sc1
    s_waitcnt lgkmcnt(0)
Lwq_29:
    v_mfma_f32_16x16x32_bf16 v[88:91], v[108:111], v[100:103], v[88:91]
    s_waitcnt lgkmcnt(14)
    v_mfma_f32_16x16x32_bf16 v[0:3], v[120:123], a[96:99], v[0:3]
    ds_read_b64_tr_b16 v[144:145], v160 offset:10240
    ds_read_b64_tr_b16 v[146:147], v160 offset:11520
    s_waitcnt lgkmcnt(15)
    v_mfma_f32_16x16x32_bf16 v[4:7], v[120:123], a[100:103], v[4:7]
    ds_read_b128 a[112:115], v169 offset:0
    s_waitcnt lgkmcnt(15)
    v_mfma_f32_16x16x32_bf16 v[8:11], v[120:123], a[104:107], v[8:11]
    ds_read_b128 a[116:119], v169 offset:2048
    s_waitcnt lgkmcnt(15)
    v_mfma_f32_16x16x32_bf16 v[12:15], v[120:123], a[108:111], v[12:15]
    ds_read_b128 a[120:123], v170 offset:0
    s_waitcnt lgkmcnt(14)
    v_mfma_f32_16x16x32_bf16 v[16:19], v[124:127], a[96:99], v[16:19]
    ds_read_b128 a[124:127], v170 offset:2048
    v_mfma_f32_16x16x32_bf16 v[20:23], v[124:127], a[100:103], v[20:23]
    ds_read_b64_tr_b16 v[148:149], v161 offset:10240
    v_mfma_f32_16x16x32_bf16 v[24:27], v[124:127], a[104:107], v[24:27]
    ds_read_b64_tr_b16 v[150:151], v161 offset:11520
    v_mfma_f32_16x16x32_bf16 v[28:31], v[124:127], a[108:111], v[28:31]
    ds_read_b64_tr_b16 v[152:153], v162 offset:10240
    s_waitcnt lgkmcnt(15)
    v_mfma_f32_16x16x32_bf16 v[32:35], a[96:99], v[128:131], v[32:35]
    ds_read_b64_tr_b16 v[154:155], v162 offset:11520
    v_cndmask_b32 v92, v120, v128, s[72:73]
    v_cndmask_b32 v93, v121, v129, s[72:73]
    v_cndmask_b32 v94, v122, v130, s[72:73]
    v_cndmask_b32 v95, v123, v131, s[72:73]
    ds_read_b64_tr_b16 v[156:157], v163 offset:10240
    v_mfma_f32_16x16x32_bf16 v[36:39], a[100:103], v[128:131], v[36:39]
    ds_read_b64_tr_b16 v[158:159], v163 offset:11520
    v_mfma_f32_16x16x32_bf16 v[40:43], a[104:107], v[128:131], v[40:43]
    ds_read_b64_tr_b16 v[112:113], v165 offset:10240
    v_mfma_f32_16x16x32_bf16 v[44:47], a[108:111], v[128:131], v[44:47]
    ds_read_b64_tr_b16 v[114:115], v165 offset:11520
    s_waitcnt lgkmcnt(15)
    v_mfma_f32_16x16x32_bf16 v[48:51], a[96:99], v[132:135], v[48:51]
    ds_read_b64_tr_b16 v[116:117], v166 offset:10240
    v_cndmask_b32 v96, v124, v132, s[72:73]
    v_cndmask_b32 v97, v125, v133, s[72:73]
    v_cndmask_b32 v98, v126, v134, s[72:73]
    v_cndmask_b32 v99, v127, v135, s[72:73]
    ds_read_b64_tr_b16 v[118:119], v166 offset:11520
    v_mfma_f32_16x16x32_bf16 v[52:55], a[100:103], v[132:135], v[52:55]
    ds_read_b128 v[108:111], v184 offset:0
    v_mfma_f32_16x16x32_bf16 v[56:59], a[104:107], v[132:135], v[56:59]
    v_mov_b32 v189, 0
    buffer_load_dword v189, v189, s[20:23], 0 offen sc1
    v_mfma_f32_16x16x32_bf16 v[60:63], a[108:111], v[132:135], v[60:63]
    s_add_u32 m0, s40, 0x8000
    v_mfma_f32_16x16x32_bf16 v[64:67], v[136:139], a[96:99], v[64:67]
    buffer_load_dwordx4 v176, s[8:11], s38 offen lds
    v_mfma_f32_16x16x32_bf16 v[68:71], v[136:139], a[100:103], v[68:71]
    buffer_load_dwordx4 v177, s[8:11], s38 offen offset:1024 lds
    v_mfma_f32_16x16x32_bf16 v[72:75], a[96:99], v[140:143], v[72:75]
    s_add_u32 m0, s40, 0x8800
    v_cndmask_b32 v100, v136, v140, s[72:73]
    v_cndmask_b32 v101, v137, v141, s[72:73]
    v_cndmask_b32 v102, v138, v142, s[72:73]
    v_cndmask_b32 v103, v139, v143, s[72:73]
    buffer_load_dwordx4 v178, s[8:11], s38 offen lds
    v_mfma_f32_16x16x32_bf16 v[76:79], a[100:103], v[140:143], v[76:79]
    buffer_load_dwordx4 v179, s[8:11], s38 offen offset:1024 lds
    s_waitcnt lgkmcnt(15)
    v_mfma_f32_16x16x32_bf16 v[80:83], v[104:107], v[92:95], v[80:83]
    s_add_u32 m0, s29, 0x2000
    v_mfma_f32_16x16x32_bf16 v[84:87], v[104:107], v[96:99], v[84:87]
    buffer_load_dwordx4 v182, s[8:11], s38 offen lds
    v_mfma_f32_16x16x32_bf16 v[88:91], v[104:107], v[100:103], v[88:91]
    s_waitcnt vmcnt(11)
    s_waitcnt lgkmcnt(0)
    s_barrier
    v_mfma_f32_16x16x32_bf16 v[0:3], v[144:147], a[112:115], v[0:3]
    ds_read_b64_tr_b16 v[120:121], v160 offset:20480
    v_mfma_f32_16x16x32_bf16 v[4:7], v[144:147], a[116:119], v[4:7]
    s_add_u32 m0, s41, 0
    s_lshl_b32 s38, s92, 7
    s_mul_i32 s39, s92, 0x3c000
    s_add_u32 s92, s92, 1
    s_sub_u32 s36, s92, 10
    s_cmp_lt_u32 s92, 10
    s_cselect_b32 s92, s92, s36
    v_mfma_f32_16x16x32_bf16 v[8:11], v[144:147], a[120:123], v[8:11]
    ds_read_b64_tr_b16 v[122:123], v160 offset:21760
    v_mfma_f32_16x16x32_bf16 v[12:15], v[144:147], a[124:127], v[12:15]
    ds_read_b128 a[128:131], v167 offset:16384
    v_mfma_f32_16x16x32_bf16 v[16:19], v[148:151], a[112:115], v[16:19]
    buffer_load_dwordx4 v171, s[12:15], s39 offen offset:0 lds
    v_mfma_f32_16x16x32_bf16 v[20:23], v[148:151], a[116:119], v[20:23]
    ds_read_b128 a[132:135], v167 offset:18432
    v_mfma_f32_16x16x32_bf16 v[24:27], v[148:151], a[120:123], v[24:27]
    ds_read_b128 a[136:139], v168 offset:16384
    v_mfma_f32_16x16x32_bf16 v[28:31], v[148:151], a[124:127], v[28:31]
    buffer_load_dwordx4 v172, s[12:15], s39 offen offset:1024 lds
    v_mfma_f32_16x16x32_bf16 v[32:35], a[112:115], v[152:155], v[32:35]
    ds_read_b128 a[140:143], v168 offset:18432
    v_cndmask_b32 v92, v144, v152, s[72:73]
    v_cndmask_b32 v93, v145, v153, s[72:73]
    v_cndmask_b32 v94, v146, v154, s[72:73]
    v_cndmask_b32 v95, v147, v155, s[72:73]
    ds_read_b64_tr_b16 v[124:125], v161 offset:20480
    v_mfma_f32_16x16x32_bf16 v[36:39], a[116:119], v[152:155], v[36:39]
    ds_read_b64_tr_b16 v[126:127], v161 offset:21760
    v_mfma_f32_16x16x32_bf16 v[40:43], a[120:123], v[152:155], v[40:43]
    buffer_load_dwordx4 v173, s[12:15], s39 offen offset:2048 lds
    v_mfma_f32_16x16x32_bf16 v[44:47], a[124:127], v[152:155], v[44:47]
    v_mfma_f32_16x16x32_bf16 v[48:51], a[112:115], v[156:159], v[48:51]
    ds_read_b64_tr_b16 v[128:129], v162 offset:20480
    v_cndmask_b32 v96, v148, v156, s[72:73]
    v_cndmask_b32 v97, v149, v157, s[72:73]
    v_cndmask_b32 v98, v150, v158, s[72:73]
    v_cndmask_b32 v99, v151, v159, s[72:73]
    ds_read_b64_tr_b16 v[130:131], v162 offset:21760
    v_mfma_f32_16x16x32_bf16 v[52:55], a[116:119], v[156:159], v[52:55]
    buffer_load_dwordx4 v174, s[12:15], s39 offen offset:3072 lds
    v_mfma_f32_16x16x32_bf16 v[56:59], a[120:123], v[156:159], v[56:59]
    ds_read_b64_tr_b16 v[132:133], v163 offset:20480
    v_mfma_f32_16x16x32_bf16 v[60:63], a[124:127], v[156:159], v[60:63]
    ds_read_b64_tr_b16 v[134:135], v163 offset:21760
    v_mfma_f32_16x16x32_bf16 v[64:67], v[112:115], a[112:115], v[64:67]
    ds_read_b64_tr_b16 v[136:137], v165 offset:20480
    v_mfma_f32_16x16x32_bf16 v[68:71], v[112:115], a[116:119], v[68:71]
    s_add_u32 m0, s41, 0x1000
    v_mfma_f32_16x16x32_bf16 v[72:75], a[112:115], v[116:119], v[72:75]
    ds_read_b64_tr_b16 v[138:139], v165 offset:21760
    v_cndmask_b32 v100, v112, v116, s[72:73]
    v_cndmask_b32 v101, v113, v117, s[72:73]
    v_cndmask_b32 v102, v114, v118, s[72:73]
    v_cndmask_b32 v103, v115, v119, s[72:73]
    ds_read_b64_tr_b16 v[140:141], v166 offset:20480
    v_mfma_f32_16x16x32_bf16 v[76:79], a[116:119], v[116:119], v[76:79]
    buffer_load_dwordx4 v175, s[12:15], s39 offen lds
    v_mfma_f32_16x16x32_bf16 v[80:83], v[108:111], v[92:95], v[80:83]
    ds_read_b64_tr_b16 v[142:143], v166 offset:21760
    v_mfma_f32_16x16x32_bf16 v[84:87], v[108:111], v[96:99], v[84:87]
    ds_read_b128 v[104:107], v183 offset:4096
    v_mfma_f32_16x16x32_bf16 v[88:91], v[108:111], v[100:103], v[88:91]
    s_waitcnt lgkmcnt(14)
    v_mfma_f32_16x16x32_bf16 v[0:3], v[120:123], a[128:131], v[0:3]
    ds_read_b64_tr_b16 v[144:145], v160 offset:30720
    s_waitcnt lgkmcnt(14)
    v_mfma_f32_16x16x32_bf16 v[4:7], v[120:123], a[132:135], v[4:7]
    s_add_u32 m0, s40, 0
    s_waitcnt lgkmcnt(13)
    v_mfma_f32_16x16x32_bf16 v[8:11], v[120:123], a[136:139], v[8:11]
    ds_read_b64_tr_b16 v[146:147], v160 offset:32000
    s_waitcnt lgkmcnt(13)
    v_mfma_f32_16x16x32_bf16 v[12:15], v[120:123], a[140:143], v[12:15]
    buffer_load_dwordx4 v176, s[8:11], s38 offen lds
    s_waitcnt lgkmcnt(11)
    v_mfma_f32_16x16x32_bf16 v[16:19], v[124:127], a[128:131], v[16:19]
    ds_read_b128 a[144:147], v169 offset:16384
    v_mfma_f32_16x16x32_bf16 v[20:23], v[124:127], a[132:135], v[20:23]
    ds_read_b128 a[148:151], v169 offset:18432
    v_mfma_f32_16x16x32_bf16 v[24:27], v[124:127], a[136:139], v[24:27]
    buffer_load_dwordx4 v177, s[8:11], s38 offen offset:1024 lds
    v_mfma_f32_16x16x32_bf16 v[28:31], v[124:127], a[140:143], v[28:31]
    ds_read_b128 a[152:155], v170 offset:16384
    s_waitcnt lgkmcnt(12)
    v_mfma_f32_16x16x32_bf16 v[32:35], a[128:131], v[128:131], v[32:35]
    ds_read_b128 a[156:159], v170 offset:18432
    v_cndmask_b32 v92, v120, v128, s[72:73]
    v_cndmask_b32 v93, v121, v129, s[72:73]
    v_cndmask_b32 v94, v122, v130, s[72:73]
    v_cndmask_b32 v95, v123, v131, s[72:73]
    s_add_u32 m0, s40, 0x800
    v_mfma_f32_16x16x32_bf16 v[36:39], a[132:135], v[128:131], v[36:39]
    ds_read_b64_tr_b16 v[148:149], v161 offset:30720
    v_mfma_f32_16x16x32_bf16 v[40:43], a[136:139], v[128:131], v[40:43]
    ds_read_b64_tr_b16 v[150:151], v161 offset:32000
    v_mfma_f32_16x16x32_bf16 v[44:47], a[140:143], v[128:131], v[44:47]
    buffer_load_dwordx4 v178, s[8:11], s38 offen lds
    s_waitcnt lgkmcnt(13)
    v_mfma_f32_16x16x32_bf16 v[48:51], a[128:131], v[132:135], v[48:51]
    ds_read_b64_tr_b16 v[152:153], v162 offset:30720
    v_cndmask_b32 v96, v124, v132, s[72:73]
    v_cndmask_b32 v97, v125, v133, s[72:73]
    v_cndmask_b32 v98, v126, v134, s[72:73]
    v_cndmask_b32 v99, v127, v135, s[72:73]
    ds_read_b64_tr_b16 v[154:155], v162 offset:32000
    v_mfma_f32_16x16x32_bf16 v[52:55], a[132:135], v[132:135], v[52:55]
    buffer_load_dwordx4 v179, s[8:11], s38 offen offset:1024 lds
    v_mfma_f32_16x16x32_bf16 v[56:59], a[136:139], v[132:135], v[56:59]
    ds_read_b64_tr_b16 v[156:157], v163 offset:30720
    v_mfma_f32_16x16x32_bf16 v[60:63], a[140:143], v[132:135], v[60:63]
    ds_read_b64_tr_b16 v[158:159], v163 offset:32000
    s_waitcnt lgkmcnt(15)
    v_mfma_f32_16x16x32_bf16 v[64:67], v[136:139], a[128:131], v[64:67]
    s_add_u32 m0, s29, 0
    v_mfma_f32_16x16x32_bf16 v[68:71], v[136:139], a[132:135], v[68:71]
    ds_read_b64_tr_b16 v[112:113], v165 offset:30720
    s_waitcnt lgkmcnt(14)
    v_mfma_f32_16x16x32_bf16 v[72:75], a[128:131], v[140:143], v[72:75]
    ds_read_b64_tr_b16 v[114:115], v165 offset:32000
    v_cndmask_b32 v100, v136, v140, s[72:73]
    v_cndmask_b32 v101, v137, v141, s[72:73]
    v_cndmask_b32 v102, v138, v142, s[72:73]
    v_cndmask_b32 v103, v139, v143, s[72:73]
    buffer_load_dwordx4 v182, s[8:11], s38 offen lds
    v_mfma_f32_16x16x32_bf16 v[76:79], a[132:135], v[140:143], v[76:79]
    ds_read_b64_tr_b16 v[116:117], v166 offset:30720
    s_waitcnt lgkmcnt(15)
    v_mfma_f32_16x16x32_bf16 v[80:83], v[104:107], v[92:95], v[80:83]
    ds_read_b64_tr_b16 v[118:119], v166 offset:32000
    v_mfma_f32_16x16x32_bf16 v[84:87], v[104:107], v[96:99], v[84:87]
    v_mfma_f32_16x16x32_bf16 v[88:91], v[104:107], v[100:103], v[88:91]
    ds_read_b128 v[108:111], v184 offset:4096
    s_waitcnt vmcnt(10)
    s_waitcnt lgkmcnt(0)
    s_barrier
    v_mfma_f32_16x16x32_bf16 v[0:3], v[144:147], a[144:147], v[0:3]
    ds_read_b64_tr_b16 v[120:121], v160 offset:40960
    v_mfma_f32_16x16x32_bf16 v[4:7], v[144:147], a[148:151], v[4:7]
    s_add_u32 m0, s41, 0x5000
    s_lshl_b32 s38, s92, 7
    s_mul_i32 s39, s92, 0x3c000
    s_add_u32 s92, s92, 1
    s_sub_u32 s36, s92, 10
    s_cmp_lt_u32 s92, 10
    s_cselect_b32 s92, s92, s36
    v_mfma_f32_16x16x32_bf16 v[8:11], v[144:147], a[152:155], v[8:11]
    ds_read_b64_tr_b16 v[122:123], v160 offset:42240
    v_mfma_f32_16x16x32_bf16 v[12:15], v[144:147], a[156:159], v[12:15]
    ds_read_b128 a[160:163], v167 offset:32768
    v_mfma_f32_16x16x32_bf16 v[16:19], v[148:151], a[144:147], v[16:19]
    buffer_load_dwordx4 v171, s[12:15], s39 offen offset:0 lds
    v_mfma_f32_16x16x32_bf16 v[20:23], v[148:151], a[148:151], v[20:23]
    ds_read_b128 a[164:167], v167 offset:34816
    v_mfma_f32_16x16x32_bf16 v[24:27], v[148:151], a[152:155], v[24:27]
    ds_read_b128 a[168:171], v168 offset:32768
    v_mfma_f32_16x16x32_bf16 v[28:31], v[148:151], a[156:159], v[28:31]
    buffer_load_dwordx4 v172, s[12:15], s39 offen offset:1024 lds
    v_mfma_f32_16x16x32_bf16 v[32:35], a[144:147], v[152:155], v[32:35]
    ds_read_b128 a[172:175], v168 offset:34816
    v_cndmask_b32 v92, v144, v152, s[72:73]
    v_cndmask_b32 v93, v145, v153, s[72:73]
    v_cndmask_b32 v94, v146, v154, s[72:73]
    v_cndmask_b32 v95, v147, v155, s[72:73]
    ds_read_b64_tr_b16 v[124:125], v161 offset:40960
    v_mfma_f32_16x16x32_bf16 v[36:39], a[148:151], v[152:155], v[36:39]
    buffer_load_dwordx4 v173, s[12:15], s39 offen offset:2048 lds
    v_mfma_f32_16x16x32_bf16 v[40:43], a[152:155], v[152:155], v[40:43]
    ds_read_b64_tr_b16 v[126:127], v161 offset:42240
    v_mfma_f32_16x16x32_bf16 v[44:47], a[156:159], v[152:155], v[44:47]
    ds_read_b64_tr_b16 v[128:129], v162 offset:40960
    v_mfma_f32_16x16x32_bf16 v[48:51], a[144:147], v[156:159], v[48:51]
    buffer_load_dwordx4 v174, s[12:15], s39 offen offset:3072 lds
    v_cndmask_b32 v96, v148, v156, s[72:73]
    v_cndmask_b32 v97, v149, v157, s[72:73]
    v_cndmask_b32 v98, v150, v158, s[72:73]
    v_cndmask_b32 v99, v151, v159, s[72:73]
    ds_read_b64_tr_b16 v[130:131], v162 offset:42240
    v_mfma_f32_16x16x32_bf16 v[52:55], a[148:151], v[156:159], v[52:55]
    ds_read_b64_tr_b16 v[132:133], v163 offset:40960
    v_mfma_f32_16x16x32_bf16 v[56:59], a[152:155], v[156:159], v[56:59]
    s_add_u32 m0, s41, 0x6000
    v_mfma_f32_16x16x32_bf16 v[60:63], a[156:159], v[156:159], v[60:63]
    ds_read_b64_tr_b16 v[134:135], v163 offset:42240
    v_mfma_f32_16x16x32_bf16 v[64:67], v[112:115], a[144:147], v[64:67]
    ds_read_b64_tr_b16 v[136:137], v165 offset:40960
    v_mfma_f32_16x16x32_bf16 v[68:71], v[112:115], a[148:151], v[68:71]
    buffer_load_dwordx4 v175, s[12:15], s39 offen lds
    v_mfma_f32_16x16x32_bf16 v[72:75], a[144:147], v[116:119], v[72:75]
    ds_read_b64_tr_b16 v[138:139], v165 offset:42240
    v_cndmask_b32 v100, v112, v116, s[72:73]
    v_cndmask_b32 v101, v113, v117, s[72:73]
    v_cndmask_b32 v102, v114, v118, s[72:73]
    v_cndmask_b32 v103, v115, v119, s[72:73]
    ds_read_b64_tr_b16 v[140:141], v166 offset:40960
    v_mfma_f32_16x16x32_bf16 v[76:79], a[148:151], v[116:119], v[76:79]
    v_readfirstlane_b32 s28, v189
    s_nop 0
    s_cmp_lg_u32 s28, 0
    s_cbranch_scc1 Lnnd_31
    s_mov_b32 s43, 0
Lnn_30:
    v_mov_b32 v189, 0
    buffer_load_dword v189, v189, s[20:23], 0 offen sc1
    s_waitcnt vmcnt(0)
    v_readfirstlane_b32 s28, v189
    s_nop 0
    s_cmp_lg_u32 s28, 0
    s_cbranch_scc1 Lnnd_31
    s_add_u32 s43, s43, 1
    s_cmp_lt_u32 s43, 0x8000
    s_cbranch_scc1 Lnn_30
Lnnd_31:
    s_lshr_b32 s36, s94, 4
    s_lshl_b32 s36, s36, 7
    s_and_b32 s37, s94, 15
    s_lshl_b32 s37, s37, 2
    s_add_u32 s36, s36, s37
    s_add_u32 s36, s36, 0xb00000
    v_mov_b32 v180, s36
    v_mov_b32 v181, s91
    v_cmp_eq_u32 vcc, 0, v191
    s_nop 1
    v_cndmask_b32 v180, v181, v180, vcc
    v_mov_b32 v181, s28
    buffer_store_dword v181, v180, s[16:19], 0 offen sc1
    v_mfma_f32_16x16x32_bf16 v[80:83], v[108:111], v[92:95], v[80:83]
    ds_read_b64_tr_b16 v[142:143], v166 offset:42240
    v_mfma_f32_16x16x32_bf16 v[84:87], v[108:111], v[96:99], v[84:87]
    ds_read_b128 v[104:107], v183 offset:8192
    v_mfma_f32_16x16x32_bf16 v[88:91], v[108:111], v[100:103], v[88:91]
    s_waitcnt lgkmcnt(14)
    v_mfma_f32_16x16x32_bf16 v[0:3], v[120:123], a[160:163], v[0:3]
    ds_read_b64_tr_b16 v[144:145], v160 offset:51200
    s_waitcnt lgkmcnt(14)
    v_mfma_f32_16x16x32_bf16 v[4:7], v[120:123], a[164:167], v[4:7]
    s_add_u32 m0, s40, 0x4000
    s_waitcnt lgkmcnt(13)
    v_mfma_f32_16x16x32_bf16 v[8:11], v[120:123], a[168:171], v[8:11]
    ds_read_b64_tr_b16 v[146:147], v160 offset:52480
    s_waitcnt lgkmcnt(13)
    v_mfma_f32_16x16x32_bf16 v[12:15], v[120:123], a[172:175], v[12:15]
    buffer_load_dwordx4 v176, s[8:11], s38 offen lds
    s_waitcnt lgkmcnt(11)
    v_mfma_f32_16x16x32_bf16 v[16:19], v[124:127], a[160:163], v[16:19]
    ds_read_b128 a[176:179], v169 offset:32768
    v_mfma_f32_16x16x32_bf16 v[20:23], v[124:127], a[164:167], v[20:23]
    ds_read_b128 a[180:183], v169 offset:34816
    v_mfma_f32_16x16x32_bf16 v[24:27], v[124:127], a[168:171], v[24:27]
    buffer_load_dwordx4 v177, s[8:11], s38 offen offset:1024 lds
    v_mfma_f32_16x16x32_bf16 v[28:31], v[124:127], a[172:175], v[28:31]
    ds_read_b128 a[184:187], v170 offset:32768
    s_waitcnt lgkmcnt(12)
    v_mfma_f32_16x16x32_bf16 v[32:35], a[160:163], v[128:131], v[32:35]
    ds_read_b128 a[188:191], v170 offset:34816
    v_cndmask_b32 v92, v120, v128, s[72:73]
    v_cndmask_b32 v93, v121, v129, s[72:73]
    v_cndmask_b32 v94, v122, v130, s[72:73]
    v_cndmask_b32 v95, v123, v131, s[72:73]
    s_add_u32 m0, s40, 0x4800
    v_mfma_f32_16x16x32_bf16 v[36:39], a[164:167], v[128:131], v[36:39]
    ds_read_b64_tr_b16 v[148:149], v161 offset:51200
    v_mfma_f32_16x16x32_bf16 v[40:43], a[168:171], v[128:131], v[40:43]
    ds_read_b64_tr_b16 v[150:151], v161 offset:52480
    v_mfma_f32_16x16x32_bf16 v[44:47], a[172:175], v[128:131], v[44:47]
    buffer_load_dwordx4 v178, s[8:11], s38 offen lds
    s_waitcnt lgkmcnt(13)
    v_mfma_f32_16x16x32_bf16 v[48:51], a[160:163], v[132:135], v[48:51]
    ds_read_b64_tr_b16 v[152:153], v162 offset:51200
    v_cndmask_b32 v96, v124, v132, s[72:73]
    v_cndmask_b32 v97, v125, v133, s[72:73]
    v_cndmask_b32 v98, v126, v134, s[72:73]
    v_cndmask_b32 v99, v127, v135, s[72:73]
    ds_read_b64_tr_b16 v[154:155], v162 offset:52480
    v_mfma_f32_16x16x32_bf16 v[52:55], a[164:167], v[132:135], v[52:55]
    buffer_load_dwordx4 v179, s[8:11], s38 offen offset:1024 lds
    v_mfma_f32_16x16x32_bf16 v[56:59], a[168:171], v[132:135], v[56:59]
    ds_read_b64_tr_b16 v[156:157], v163 offset:51200
    v_mfma_f32_16x16x32_bf16 v[60:63], a[172:175], v[132:135], v[60:63]
    ds_read_b64_tr_b16 v[158:159], v163 offset:52480
    s_waitcnt lgkmcnt(15)
    v_mfma_f32_16x16x32_bf16 v[64:67], v[136:139], a[160:163], v[64:67]
    s_add_u32 m0, s29, 0x1000
    v_mfma_f32_16x16x32_bf16 v[68:71], v[136:139], a[164:167], v[68:71]
    ds_read_b64_tr_b16 v[112:113], v165 offset:51200
    s_waitcnt lgkmcnt(14)
    v_mfma_f32_16x16x32_bf16 v[72:75], a[160:163], v[140:143], v[72:75]
    ds_read_b64_tr_b16 v[114:115], v165 offset:52480
    v_cndmask_b32 v100, v136, v140, s[72:73]
    v_cndmask_b32 v101, v137, v141, s[72:73]
    v_cndmask_b32 v102, v138, v142, s[72:73]
    v_cndmask_b32 v103, v139, v143, s[72:73]
    buffer_load_dwordx4 v182, s[8:11], s38 offen lds
    v_mfma_f32_16x16x32_bf16 v[76:79], a[164:167], v[140:143], v[76:79]
    ds_read_b64_tr_b16 v[116:117], v166 offset:51200
    s_waitcnt lgkmcnt(15)
    v_mfma_f32_16x16x32_bf16 v[80:83], v[104:107], v[92:95], v[80:83]
    ds_read_b64_tr_b16 v[118:119], v166 offset:52480
    v_mfma_f32_16x16x32_bf16 v[84:87], v[104:107], v[96:99], v[84:87]
    v_mfma_f32_16x16x32_bf16 v[88:91], v[104:107], v[100:103], v[88:91]
    ds_read_b128 v[108:111], v184 offset:8192
    s_waitcnt vmcnt(11)
    s_waitcnt lgkmcnt(0)
    s_barrier
    v_mfma_f32_16x16x32_bf16 v[0:3], v[144:147], a[176:179], v[0:3]
    ds_read_b64_tr_b16 v[120:121], v160 offset:0
    v_mfma_f32_16x16x32_bf16 v[4:7], v[144:147], a[180:183], v[4:7]
    s_add_u32 m0, s41, 0xa000
    s_lshl_b32 s38, s92, 7
    s_mul_i32 s39, s92, 0x3c000
    s_add_u32 s92, s92, 1
    s_sub_u32 s36, s92, 10
    s_cmp_lt_u32 s92, 10
    s_cselect_b32 s92, s92, s36
    v_mfma_f32_16x16x32_bf16 v[8:11], v[144:147], a[184:187], v[8:11]
    ds_read_b64_tr_b16 v[122:123], v160 offset:1280
    v_mfma_f32_16x16x32_bf16 v[12:15], v[144:147], a[188:191], v[12:15]
    ds_read_b128 a[192:195], v167 offset:0
    v_mfma_f32_16x16x32_bf16 v[16:19], v[148:151], a[176:179], v[16:19]
    buffer_load_dwordx4 v171, s[12:15], s39 offen offset:0 lds
    v_mfma_f32_16x16x32_bf16 v[20:23], v[148:151], a[180:183], v[20:23]
    ds_read_b128 a[196:199], v167 offset:2048
    v_mfma_f32_16x16x32_bf16 v[24:27], v[148:151], a[184:187], v[24:27]
    ds_read_b128 a[200:203], v168 offset:0
    v_mfma_f32_16x16x32_bf16 v[28:31], v[148:151], a[188:191], v[28:31]
    buffer_load_dwordx4 v172, s[12:15], s39 offen offset:1024 lds
    v_mfma_f32_16x16x32_bf16 v[32:35], a[176:179], v[152:155], v[32:35]
    ds_read_b128 a[204:207], v168 offset:2048
    v_cndmask_b32 v92, v144, v152, s[72:73]
    v_cndmask_b32 v93, v145, v153, s[72:73]
    v_cndmask_b32 v94, v146, v154, s[72:73]
    v_cndmask_b32 v95, v147, v155, s[72:73]
    ds_read_b64_tr_b16 v[124:125], v161 offset:0
    v_mfma_f32_16x16x32_bf16 v[36:39], a[180:183], v[152:155], v[36:39]
    ds_read_b64_tr_b16 v[126:127], v161 offset:1280
    v_mfma_f32_16x16x32_bf16 v[40:43], a[184:187], v[152:155], v[40:43]
    buffer_load_dwordx4 v173, s[12:15], s39 offen offset:2048 lds
    v_mfma_f32_16x16x32_bf16 v[44:47], a[188:191], v[152:155], v[44:47]
    v_mfma_f32_16x16x32_bf16 v[48:51], a[176:179], v[156:159], v[48:51]
    ds_read_b64_tr_b16 v[128:129], v162 offset:0
    v_cndmask_b32 v96, v148, v156, s[72:73]
    v_cndmask_b32 v97, v149, v157, s[72:73]
    v_cndmask_b32 v98, v150, v158, s[72:73]
    v_cndmask_b32 v99, v151, v159, s[72:73]
    ds_read_b64_tr_b16 v[130:131], v162 offset:1280
    v_mfma_f32_16x16x32_bf16 v[52:55], a[180:183], v[156:159], v[52:55]
    buffer_load_dwordx4 v174, s[12:15], s39 offen offset:3072 lds
    v_mfma_f32_16x16x32_bf16 v[56:59], a[184:187], v[156:159], v[56:59]
    ds_read_b64_tr_b16 v[132:133], v163 offset:0
    v_mfma_f32_16x16x32_bf16 v[60:63], a[188:191], v[156:159], v[60:63]
    ds_read_b64_tr_b16 v[134:135], v163 offset:1280
    v_mfma_f32_16x16x32_bf16 v[64:67], v[112:115], a[176:179], v[64:67]
    ds_read_b64_tr_b16 v[136:137], v165 offset:0
    v_mfma_f32_16x16x32_bf16 v[68:71], v[112:115], a[180:183], v[68:71]
    s_add_u32 m0, s41, 0xb000
    v_mfma_f32_16x16x32_bf16 v[72:75], a[176:179], v[116:119], v[72:75]
    ds_read_b64_tr_b16 v[138:139], v165 offset:1280
    v_cndmask_b32 v100, v112, v116, s[72:73]
    v_cndmask_b32 v101, v113, v117, s[72:73]
    v_cndmask_b32 v102, v114, v118, s[72:73]
    v_cndmask_b32 v103, v115, v119, s[72:73]
    ds_read_b64_tr_b16 v[140:141], v166 offset:0
    v_mfma_f32_16x16x32_bf16 v[76:79], a[180:183], v[116:119], v[76:79]
    buffer_load_dwordx4 v175, s[12:15], s39 offen lds
    v_mfma_f32_16x16x32_bf16 v[80:83], v[108:111], v[92:95], v[80:83]
    ds_read_b64_tr_b16 v[142:143], v166 offset:1280
    v_mfma_f32_16x16x32_bf16 v[84:87], v[108:111], v[96:99], v[84:87]
    ds_read_b128 v[104:107], v183 offset:0
    v_mfma_f32_16x16x32_bf16 v[88:91], v[108:111], v[100:103], v[88:91]
    s_waitcnt lgkmcnt(14)
    v_mfma_f32_16x16x32_bf16 v[0:3], v[120:123], a[192:195], v[0:3]
    ds_read_b64_tr_b16 v[144:145], v160 offset:10240
    s_waitcnt lgkmcnt(14)
    v_mfma_f32_16x16x32_bf16 v[4:7], v[120:123], a[196:199], v[4:7]
    s_add_u32 m0, s40, 0x8000
    s_waitcnt lgkmcnt(13)
    v_mfma_f32_16x16x32_bf16 v[8:11], v[120:123], a[200:203], v[8:11]
    ds_read_b64_tr_b16 v[146:147], v160 offset:11520
    s_waitcnt lgkmcnt(13)
    v_mfma_f32_16x16x32_bf16 v[12:15], v[120:123], a[204:207], v[12:15]
    buffer_load_dwordx4 v176, s[8:11], s38 offen lds
    s_waitcnt lgkmcnt(11)
    v_mfma_f32_16x16x32_bf16 v[16:19], v[124:127], a[192:195], v[16:19]
    ds_read_b128 a[208:211], v169 offset:0
    v_mfma_f32_16x16x32_bf16 v[20:23], v[124:127], a[196:199], v[20:23]
    ds_read_b128 a[212:215], v169 offset:2048
    v_mfma_f32_16x16x32_bf16 v[24:27], v[124:127], a[200:203], v[24:27]
    buffer_load_dwordx4 v177, s[8:11], s38 offen offset:1024 lds
    v_mfma_f32_16x16x32_bf16 v[28:31], v[124:127], a[204:207], v[28:31]
    ds_read_b128 a[216:219], v170 offset:0
    s_waitcnt lgkmcnt(12)
    v_mfma_f32_16x16x32_bf16 v[32:35], a[192:195], v[128:131], v[32:35]
    ds_read_b128 a[220:223], v170 offset:2048
    v_cndmask_b32 v92, v120, v128, s[72:73]
    v_cndmask_b32 v93, v121, v129, s[72:73]
    v_cndmask_b32 v94, v122, v130, s[72:73]
    v_cndmask_b32 v95, v123, v131, s[72:73]
    s_add_u32 m0, s40, 0x8800
    v_mfma_f32_16x16x32_bf16 v[36:39], a[196:199], v[128:131], v[36:39]
    ds_read_b64_tr_b16 v[148:149], v161 offset:10240
    v_mfma_f32_16x16x32_bf16 v[40:43], a[200:203], v[128:131], v[40:43]
    ds_read_b64_tr_b16 v[150:151], v161 offset:11520
    v_mfma_f32_16x16x32_bf16 v[44:47], a[204:207], v[128:131], v[44:47]
    buffer_load_dwordx4 v178, s[8:11], s38 offen lds
    s_waitcnt lgkmcnt(13)
    v_mfma_f32_16x16x32_bf16 v[48:51], a[192:195], v[132:135], v[48:51]
    ds_read_b64_tr_b16 v[152:153], v162 offset:10240
    v_cndmask_b32 v96, v124, v132, s[72:73]
    v_cndmask_b32 v97, v125, v133, s[72:73]
    v_cndmask_b32 v98, v126, v134, s[72:73]
    v_cndmask_b32 v99, v127, v135, s[72:73]
    ds_read_b64_tr_b16 v[154:155], v162 offset:11520
    v_mfma_f32_16x16x32_bf16 v[52:55], a[196:199], v[132:135], v[52:55]
    buffer_load_dwordx4 v179, s[8:11], s38 offen offset:1024 lds
    v_mfma_f32_16x16x32_bf16 v[56:59], a[200:203], v[132:135], v[56:59]
    ds_read_b64_tr_b16 v[156:157], v163 offset:10240
    v_mfma_f32_16x16x32_bf16 v[60:63], a[204:207], v[132:135], v[60:63]
    ds_read_b64_tr_b16 v[158:159], v163 offset:11520
    s_waitcnt lgkmcnt(15)
    v_mfma_f32_16x16x32_bf16 v[64:67], v[136:139], a[192:195], v[64:67]
    s_add_u32 m0, s29, 0x2000
    v_mfma_f32_16x16x32_bf16 v[68:71], v[136:139], a[196:199], v[68:71]
    ds_read_b64_tr_b16 v[112:113], v165 offset:10240
    s_waitcnt lgkmcnt(14)
    v_mfma_f32_16x16x32_bf16 v[72:75], a[192:195], v[140:143], v[72:75]
    ds_read_b64_tr_b16 v[114:115], v165 offset:11520
    v_cndmask_b32 v100, v136, v140, s[72:73]
    v_cndmask_b32 v101, v137, v141, s[72:73]
    v_cndmask_b32 v102, v138, v142, s[72:73]
    v_cndmask_b32 v103, v139, v143, s[72:73]
    buffer_load_dwordx4 v182, s[8:11], s38 offen lds
    v_mfma_f32_16x16x32_bf16 v[76:79], a[196:199], v[140:143], v[76:79]
    ds_read_b64_tr_b16 v[116:117], v166 offset:10240
    s_waitcnt lgkmcnt(15)
    v_mfma_f32_16x16x32_bf16 v[80:83], v[104:107], v[92:95], v[80:83]
    ds_read_b64_tr_b16 v[118:119], v166 offset:11520
    v_mfma_f32_16x16x32_bf16 v[84:87], v[104:107], v[96:99], v[84:87]
    v_mfma_f32_16x16x32_bf16 v[88:91], v[104:107], v[100:103], v[88:91]
    ds_read_b128 v[108:111], v184 offset:0
    s_waitcnt vmcnt(10)
    s_waitcnt lgkmcnt(0)
    s_barrier
    v_mfma_f32_16x16x32_bf16 v[0:3], v[144:147], a[208:211], v[0:3]
    ds_read_b64_tr_b16 v[120:121], v160 offset:20480
    v_mfma_f32_16x16x32_bf16 v[4:7], v[144:147], a[212:215], v[4:7]
    s_add_u32 m0, s41, 0
    s_lshl_b32 s38, s92, 7
    s_mul_i32 s39, s92, 0x3c000
    s_add_u32 s92, s92, 1
    s_sub_u32 s36, s92, 10
    s_cmp_lt_u32 s92, 10
    s_cselect_b32 s92, s92, s36
    v_mfma_f32_16x16x32_bf16 v[8:11], v[144:147], a[216:219], v[8:11]
    ds_read_b64_tr_b16 v[122:123], v160 offset:21760
    v_mfma_f32_16x16x32_bf16 v[12:15], v[144:147], a[220:223], v[12:15]
    ds_read_b128 a[224:227], v167 offset:16384
    v_mfma_f32_16x16x32_bf16 v[16:19], v[148:151], a[208:211], v[16:19]
    buffer_load_dwordx4 v171, s[12:15], s39 offen offset:0 lds
    v_mfma_f32_16x16x32_bf16 v[20:23], v[148:151], a[212:215], v[20:23]
    ds_read_b128 a[228:231], v167 offset:18432
    v_mfma_f32_16x16x32_bf16 v[24:27], v[148:151], a[216:219], v[24:27]
    ds_read_b128 a[232:235], v168 offset:16384
    v_mfma_f32_16x16x32_bf16 v[28:31], v[148:151], a[220:223], v[28:31]
    buffer_load_dwordx4 v172, s[12:15], s39 offen offset:1024 lds
    v_mfma_f32_16x16x32_bf16 v[32:35], a[208:211], v[152:155], v[32:35]
    ds_read_b128 a[236:239], v168 offset:18432
    v_cndmask_b32 v92, v144, v152, s[72:73]
    v_cndmask_b32 v93, v145, v153, s[72:73]
    v_cndmask_b32 v94, v146, v154, s[72:73]
    v_cndmask_b32 v95, v147, v155, s[72:73]
    ds_read_b64_tr_b16 v[124:125], v161 offset:20480
    v_mfma_f32_16x16x32_bf16 v[36:39], a[212:215], v[152:155], v[36:39]
    ds_read_b64_tr_b16 v[126:127], v161 offset:21760
    v_mfma_f32_16x16x32_bf16 v[40:43], a[216:219], v[152:155], v[40:43]
    buffer_load_dwordx4 v173, s[12:15], s39 offen offset:2048 lds
    v_mfma_f32_16x16x32_bf16 v[44:47], a[220:223], v[152:155], v[44:47]
    v_mfma_f32_16x16x32_bf16 v[48:51], a[208:211], v[156:159], v[48:51]
    ds_read_b64_tr_b16 v[128:129], v162 offset:20480
    v_cndmask_b32 v96, v148, v156, s[72:73]
    v_cndmask_b32 v97, v149, v157, s[72:73]
    v_cndmask_b32 v98, v150, v158, s[72:73]
    v_cndmask_b32 v99, v151, v159, s[72:73]
    ds_read_b64_tr_b16 v[130:131], v162 offset:21760
    v_mfma_f32_16x16x32_bf16 v[52:55], a[212:215], v[156:159], v[52:55]
    buffer_load_dwordx4 v174, s[12:15], s39 offen offset:3072 lds
    v_mfma_f32_16x16x32_bf16 v[56:59], a[216:219], v[156:159], v[56:59]
    ds_read_b64_tr_b16 v[132:133], v163 offset:20480
    v_mfma_f32_16x16x32_bf16 v[60:63], a[220:223], v[156:159], v[60:63]
    ds_read_b64_tr_b16 v[134:135], v163 offset:21760
    v_mfma_f32_16x16x32_bf16 v[64:67], v[112:115], a[208:211], v[64:67]
    ds_read_b64_tr_b16 v[136:137], v165 offset:20480
    v_mfma_f32_16x16x32_bf16 v[68:71], v[112:115], a[212:215], v[68:71]
    s_add_u32 m0, s41, 0x1000
    v_mfma_f32_16x16x32_bf16 v[72:75], a[208:211], v[116:119], v[72:75]
    ds_read_b64_tr_b16 v[138:139], v165 offset:21760
    v_cndmask_b32 v100, v112, v116, s[72:73]
    v_cndmask_b32 v101, v113, v117, s[72:73]
    v_cndmask_b32 v102, v114, v118, s[72:73]
    v_cndmask_b32 v103, v115, v119, s[72:73]
    ds_read_b64_tr_b16 v[140:141], v166 offset:20480
    v_mfma_f32_16x16x32_bf16 v[76:79], a[212:215], v[116:119], v[76:79]
    buffer_load_dwordx4 v175, s[12:15], s39 offen lds
    v_mfma_f32_16x16x32_bf16 v[80:83], v[108:111], v[92:95], v[80:83]
    ds_read_b64_tr_b16 v[142:143], v166 offset:21760
    v_mfma_f32_16x16x32_bf16 v[84:87], v[108:111], v[96:99], v[84:87]
    ds_read_b128 v[104:107], v183 offset:4096
    v_mfma_f32_16x16x32_bf16 v[88:91], v[108:111], v[100:103], v[88:91]
    s_waitcnt lgkmcnt(14)
    v_mfma_f32_16x16x32_bf16 v[0:3], v[120:123], a[224:227], v[0:3]
    ds_read_b64_tr_b16 v[144:145], v160 offset:30720
    s_waitcnt lgkmcnt(14)
    v_mfma_f32_16x16x32_bf16 v[4:7], v[120:123], a[228:231], v[4:7]
    s_add_u32 m0, s40, 0
    s_waitcnt lgkmcnt(13)
    v_mfma_f32_16x16x32_bf16 v[8:11], v[120:123], a[232:235], v[8:11]
    ds_read_b64_tr_b16 v[146:147], v160 offset:32000
    s_waitcnt lgkmcnt(13)
    v_mfma_f32_16x16x32_bf16 v[12:15], v[120:123], a[236:239], v[12:15]
    buffer_load_dwordx4 v176, s[8:11], s38 offen lds
    s_waitcnt lgkmcnt(11)
    v_mfma_f32_16x16x32_bf16 v[16:19], v[124:127], a[224:227], v[16:19]
    ds_read_b128 a[240:243], v169 offset:16384
    v_mfma_f32_16x16x32_bf16 v[20:23], v[124:127], a[228:231], v[20:23]
    ds_read_b128 a[244:247], v169 offset:18432
    v_mfma_f32_16x16x32_bf16 v[24:27], v[124:127], a[232:235], v[24:27]
    buffer_load_dwordx4 v177, s[8:11], s38 offen offset:1024 lds
    v_mfma_f32_16x16x32_bf16 v[28:31], v[124:127], a[236:239], v[28:31]
    ds_read_b128 a[248:251], v170 offset:16384
    s_waitcnt lgkmcnt(12)
    v_mfma_f32_16x16x32_bf16 v[32:35], a[224:227], v[128:131], v[32:35]
    ds_read_b128 a[252:255], v170 offset:18432
    v_cndmask_b32 v92, v120, v128, s[72:73]
    v_cndmask_b32 v93, v121, v129, s[72:73]
    v_cndmask_b32 v94, v122, v130, s[72:73]
    v_cndmask_b32 v95, v123, v131, s[72:73]
    s_add_u32 m0, s40, 0x800
    v_mfma_f32_16x16x32_bf16 v[36:39], a[228:231], v[128:131], v[36:39]
    ds_read_b64_tr_b16 v[148:149], v161 offset:30720
    v_mfma_f32_16x16x32_bf16 v[40:43], a[232:235], v[128:131], v[40:43]
    ds_read_b64_tr_b16 v[150:151], v161 offset:32000
    v_mfma_f32_16x16x32_bf16 v[44:47], a[236:239], v[128:131], v[44:47]
    buffer_load_dwordx4 v178, s[8:11], s38 offen lds
    s_waitcnt lgkmcnt(13)
    v_mfma_f32_16x16x32_bf16 v[48:51], a[224:227], v[132:135], v[48:51]
    ds_read_b64_tr_b16 v[152:153], v162 offset:30720
    v_cndmask_b32 v96, v124, v132, s[72:73]
    v_cndmask_b32 v97, v125, v133, s[72:73]
    v_cndmask_b32 v98, v126, v134, s[72:73]
    v_cndmask_b32 v99, v127, v135, s[72:73]
    ds_read_b64_tr_b16 v[154:155], v162 offset:32000
    v_mfma_f32_16x16x32_bf16 v[52:55], a[228:231], v[132:135], v[52:55]
    buffer_load_dwordx4 v179, s[8:11], s38 offen offset:1024 lds
    v_mfma_f32_16x16x32_bf16 v[56:59], a[232:235], v[132:135], v[56:59]
    ds_read_b64_tr_b16 v[156:157], v163 offset:30720
    v_mfma_f32_16x16x32_bf16 v[60:63], a[236:239], v[132:135], v[60:63]
    ds_read_b64_tr_b16 v[158:159], v163 offset:32000
    s_waitcnt lgkmcnt(15)
    v_mfma_f32_16x16x32_bf16 v[64:67], v[136:139], a[224:227], v[64:67]
    s_add_u32 m0, s29, 0
    v_mfma_f32_16x16x32_bf16 v[68:71], v[136:139], a[228:231], v[68:71]
    ds_read_b64_tr_b16 v[112:113], v165 offset:30720
    s_waitcnt lgkmcnt(14)
    v_mfma_f32_16x16x32_bf16 v[72:75], a[224:227], v[140:143], v[72:75]
    ds_read_b64_tr_b16 v[114:115], v165 offset:32000
    v_cndmask_b32 v100, v136, v140, s[72:73]
    v_cndmask_b32 v101, v137, v141, s[72:73]
    v_cndmask_b32 v102, v138, v142, s[72:73]
    v_cndmask_b32 v103, v139, v143, s[72:73]
    buffer_load_dwordx4 v182, s[8:11], s38 offen lds
    v_mfma_f32_16x16x32_bf16 v[76:79], a[228:231], v[140:143], v[76:79]
    ds_read_b64_tr_b16 v[116:117], v166 offset:30720
    s_waitcnt lgkmcnt(15)
    v_mfma_f32_16x16x32_bf16 v[80:83], v[104:107], v[92:95], v[80:83]
    ds_read_b64_tr_b16 v[118:119], v166 offset:32000
    v_mfma_f32_16x16x32_bf16 v[84:87], v[104:107], v[96:99], v[84:87]
    v_mfma_f32_16x16x32_bf16 v[88:91], v[104:107], v[100:103], v[88:91]
    ds_read_b128 v[108:111], v184 offset:4096
    s_waitcnt vmcnt(10)
    s_waitcnt lgkmcnt(0)
    s_barrier
    v_mfma_f32_16x16x32_bf16 v[0:3], v[144:147], a[240:243], v[0:3]
    ds_read_b64_tr_b16 v[120:121], v160 offset:40960
    v_subrev_u32 v180, 0x500, v171
    v_add_u32 v181, 0x3b600, v171
    v_cndmask_b32 v171, v180, v181, s[44:45]
    v_mfma_f32_16x16x32_bf16 v[4:7], v[144:147], a[244:247], v[4:7]
    ds_read_b64_tr_b16 v[122:123], v160 offset:42240
    v_mfma_f32_16x16x32_bf16 v[8:11], v[144:147], a[248:251], v[8:11]
    v_subrev_u32 v180, 0x500, v172
    v_add_u32 v181, 0x3b600, v172
    v_cndmask_b32 v172, v180, v181, s[46:47]
    v_mfma_f32_16x16x32_bf16 v[12:15], v[144:147], a[252:255], v[12:15]
    ds_read_b128 v[192:195], v167 offset:32768
    v_mfma_f32_16x16x32_bf16 v[16:19], v[148:151], a[240:243], v[16:19]
    v_subrev_u32 v180, 0x500, v173
    v_add_u32 v181, 0x3b600, v173
    v_cndmask_b32 v173, v180, v181, s[48:49]
    v_mfma_f32_16x16x32_bf16 v[20:23], v[148:151], a[244:247], v[20:23]
    ds_read_b128 v[196:199], v167 offset:34816
    v_mfma_f32_16x16x32_bf16 v[24:27], v[148:151], a[248:251], v[24:27]
    ds_read_b128 v[200:203], v168 offset:32768
    v_mfma_f32_16x16x32_bf16 v[28:31], v[148:151], a[252:255], v[28:31]
    v_subrev_u32 v180, 0x500, v174
    v_add_u32 v181, 0x3b600, v174
    v_cndmask_b32 v174, v180, v181, s[50:51]
    v_mfma_f32_16x16x32_bf16 v[32:35], a[240:243], v[152:155], v[32:35]
    ds_read_b128 v[204:207], v168 offset:34816
    v_subrev_u32 v180, 0x500, v175
    v_add_u32 v181, 0x3b600, v175
    v_cndmask_b32 v175, v180, v181, s[52:53]
    v_cndmask_b32 v92, v144, v152, s[72:73]
    v_cndmask_b32 v93, v145, v153, s[72:73]
    v_cndmask_b32 v94, v146, v154, s[72:73]
    v_cndmask_b32 v95, v147, v155, s[72:73]
    ds_read_b64_tr_b16 v[124:125], v161 offset:40960
    v_mfma_f32_16x16x32_bf16 v[36:39], a[244:247], v[152:155], v[36:39]
    ds_read_b64_tr_b16 v[126:127], v161 offset:42240
    v_mfma_f32_16x16x32_bf16 v[40:43], a[248:251], v[152:155], v[40:43]
    s_add_u32 m0, s41, 0x5000
    s_mul_i32 s39, s92, 0x3c000
    s_cmp_eq_u32 s92, 9
    s_cselect_b32 s39, 0, s39
    s_cselect_b32 s93, 0x21c000, 0
    s_cselect_b32 s95, 0xfffc4000, 0
    s_add_u32 s92, s92, 2
    s_sub_u32 s36, s92, 10
    s_cmp_lt_u32 s92, 10
    s_cselect_b32 s92, s92, s36
    v_mfma_f32_16x16x32_bf16 v[44:47], a[252:255], v[152:155], v[44:47]
    ds_read_b64_tr_b16 v[128:129], v162 offset:40960
    v_mfma_f32_16x16x32_bf16 v[48:51], a[240:243], v[156:159], v[48:51]
    v_add_u32 v180, s93, v171
    v_add_u32 v181, s95, v171
    v_cmp_le_u32 vcc, 0x3b920, v171
    s_nop 1
    v_cndmask_b32 v180, v180, v181, vcc
    buffer_load_dwordx4 v180, s[12:15], s39 offen offset:0 lds
    v_cndmask_b32 v96, v148, v156, s[72:73]
    v_cndmask_b32 v97, v149, v157, s[72:73]
    v_cndmask_b32 v98, v150, v158, s[72:73]
    v_cndmask_b32 v99, v151, v159, s[72:73]
    ds_read_b64_tr_b16 v[130:131], v162 offset:42240
    v_mfma_f32_16x16x32_bf16 v[52:55], a[244:247], v[156:159], v[52:55]
    v_add_u32 v180, s93, v172
    v_add_u32 v181, s95, v172
    v_cmp_le_u32 vcc, 0x3b920, v172
    s_nop 1
    v_cndmask_b32 v180, v180, v181, vcc
    buffer_load_dwordx4 v180, s[12:15], s39 offen offset:1024 lds
    v_mfma_f32_16x16x32_bf16 v[56:59], a[248:251], v[156:159], v[56:59]
    ds_read_b64_tr_b16 v[132:133], v163 offset:40960
    v_mfma_f32_16x16x32_bf16 v[60:63], a[252:255], v[156:159], v[60:63]
    ds_read_b64_tr_b16 v[134:135], v163 offset:42240
    v_add_u32 v180, s93, v173
    v_add_u32 v181, s95, v173
    v_cmp_le_u32 vcc, 0x3b920, v173
    s_nop 1
    v_cndmask_b32 v180, v180, v181, vcc
    buffer_load_dwordx4 v180, s[12:15], s39 offen offset:2048 lds
    v_mfma_f32_16x16x32_bf16 v[64:67], v[112:115], a[240:243], v[64:67]
    ds_read_b64_tr_b16 v[136:137], v165 offset:40960
    v_mfma_f32_16x16x32_bf16 v[68:71], v[112:115], a[244:247], v[68:71]
    v_add_u32 v180, s93, v174
    v_add_u32 v181, s95, v174
    v_cmp_le_u32 vcc, 0x3b920, v174
    s_nop 1
    v_cndmask_b32 v180, v180, v181, vcc
    buffer_load_dwordx4 v180, s[12:15], s39 offen offset:3072 lds
    v_mfma_f32_16x16x32_bf16 v[72:75], a[240:243], v[116:119], v[72:75]
    ds_read_b64_tr_b16 v[138:139], v165 offset:42240
    v_cndmask_b32 v100, v112, v116, s[72:73]
    v_cndmask_b32 v101, v113, v117, s[72:73]
    v_cndmask_b32 v102, v114, v118, s[72:73]
    v_cndmask_b32 v103, v115, v119, s[72:73]
    ds_read_b64_tr_b16 v[140:141], v166 offset:40960
    v_mfma_f32_16x16x32_bf16 v[76:79], a[244:247], v[116:119], v[76:79]
    v_add_u32 v180, s93, v175
    v_add_u32 v181, s95, v175
    v_cmp_le_u32 vcc, 0x3b920, v175
    s_nop 1
    v_cndmask_b32 v180, v180, v181, vcc
    s_add_u32 m0, s41, 0x6000
    s_nop 0
    buffer_load_dwordx4 v180, s[12:15], s39 offen lds
    v_mfma_f32_16x16x32_bf16 v[80:83], v[108:111], v[92:95], v[80:83]
    ds_read_b64_tr_b16 v[142:143], v166 offset:42240
    v_mfma_f32_16x16x32_bf16 v[84:87], v[108:111], v[96:99], v[84:87]
    v_mfma_f32_16x16x32_bf16 v[88:91], v[108:111], v[100:103], v[88:91]
    ds_read_b128 v[104:107], v183 offset:8192
    s_waitcnt lgkmcnt(14)
    v_mfma_f32_16x16x32_bf16 v[0:3], v[120:123], v[192:195], v[0:3]
    ds_read_b64_tr_b16 v[144:145], v160 offset:51200
    s_waitcnt lgkmcnt(14)
    v_mfma_f32_16x16x32_bf16 v[4:7], v[120:123], v[196:199], v[4:7]
    ds_read_b64_tr_b16 v[146:147], v160 offset:52480
    s_waitcnt lgkmcnt(14)
    v_mfma_f32_16x16x32_bf16 v[8:11], v[120:123], v[200:203], v[8:11]
    s_waitcnt lgkmcnt(13)
    v_mfma_f32_16x16x32_bf16 v[12:15], v[120:123], v[204:207], v[12:15]
    ds_read_b128 v[208:211], v169 offset:32768
    s_waitcnt lgkmcnt(12)
    v_mfma_f32_16x16x32_bf16 v[16:19], v[124:127], v[192:195], v[16:19]
    ds_read_b128 v[212:215], v169 offset:34816
    v_mfma_f32_16x16x32_bf16 v[20:23], v[124:127], v[196:199], v[20:23]
    v_mfma_f32_16x16x32_bf16 v[24:27], v[124:127], v[200:203], v[24:27]
    ds_read_b128 v[216:219], v170 offset:32768
    v_mfma_f32_16x16x32_bf16 v[28:31], v[124:127], v[204:207], v[28:31]
    ds_read_b128 v[220:223], v170 offset:34816
    s_waitcnt lgkmcnt(13)
    v_mfma_f32_16x16x32_bf16 v[32:35], v[192:195], v[128:131], v[32:35]
    v_cndmask_b32 v92, v120, v128, s[72:73]
    v_cndmask_b32 v93, v121, v129, s[72:73]
    v_cndmask_b32 v94, v122, v130, s[72:73]
    v_cndmask_b32 v95, v123, v131, s[72:73]
    ds_read_b64_tr_b16 v[148:149], v161 offset:51200
    v_mfma_f32_16x16x32_bf16 v[36:39], v[196:199], v[128:131], v[36:39]
    ds_read_b64_tr_b16 v[150:151], v161 offset:52480
    v_mfma_f32_16x16x32_bf16 v[40:43], v[200:203], v[128:131], v[40:43]
    v_mfma_f32_16x16x32_bf16 v[44:47], v[204:207], v[128:131], v[44:47]
    ds_read_b64_tr_b16 v[152:153], v162 offset:51200
    s_waitcnt lgkmcnt(14)
    v_mfma_f32_16x16x32_bf16 v[48:51], v[192:195], v[132:135], v[48:51]
    ds_read_b64_tr_b16 v[154:155], v162 offset:52480
    v_cndmask_b32 v96, v124, v132, s[72:73]
    v_cndmask_b32 v97, v125, v133, s[72:73]
    v_cndmask_b32 v98, v126, v134, s[72:73]
    v_cndmask_b32 v99, v127, v135, s[72:73]
    v_mfma_f32_16x16x32_bf16 v[52:55], v[196:199], v[132:135], v[52:55]
    ds_read_b64_tr_b16 v[156:157], v163 offset:51200
    v_mfma_f32_16x16x32_bf16 v[56:59], v[200:203], v[132:135], v[56:59]
    ds_read_b64_tr_b16 v[158:159], v163 offset:52480
    v_mfma_f32_16x16x32_bf16 v[60:63], v[204:207], v[132:135], v[60:63]
    s_waitcnt lgkmcnt(15)
    v_mfma_f32_16x16x32_bf16 v[64:67], v[136:139], v[192:195], v[64:67]
    ds_read_b64_tr_b16 v[112:113], v165 offset:51200
    v_mfma_f32_16x16x32_bf16 v[68:71], v[136:139], v[196:199], v[68:71]
    ds_read_b64_tr_b16 v[114:115], v165 offset:52480
    s_waitcnt lgkmcnt(15)
    v_mfma_f32_16x16x32_bf16 v[72:75], v[192:195], v[140:143], v[72:75]
    v_cndmask_b32 v100, v136, v140, s[72:73]
    v_cndmask_b32 v101, v137, v141, s[72:73]
    v_cndmask_b32 v102, v138, v142, s[72:73]
    v_cndmask_b32 v103, v139, v143, s[72:73]
    ds_read_b64_tr_b16 v[116:117], v166 offset:51200
    v_mfma_f32_16x16x32_bf16 v[76:79], v[196:199], v[140:143], v[76:79]
    ds_read_b64_tr_b16 v[118:119], v166 offset:52480
    s_waitcnt lgkmcnt(15)
    v_mfma_f32_16x16x32_bf16 v[80:83], v[104:107], v[92:95], v[80:83]
    v_mfma_f32_16x16x32_bf16 v[84:87], v[104:107], v[96:99], v[84:87]
    ds_read_b128 v[108:111], v184 offset:8192
    v_mfma_f32_16x16x32_bf16 v[88:91], v[104:107], v[100:103], v[88:91]
    s_waitcnt vmcnt(5)
    s_waitcnt lgkmcnt(0)
    s_barrier
    v_mfma_f32_16x16x32_bf16 v[0:3], v[144:147], v[208:211], v[0:3]
    ds_read_b64_tr_b16 v[120:121], v160 offset:0
    v_mfma_f32_16x16x32_bf16 v[4:7], v[144:147], v[212:215], v[4:7]
    s_add_u32 m0, s41, 0xa000
    s_mul_i32 s39, s92, 0x3c000
    s_cmp_eq_u32 s92, 9
    s_cselect_b32 s39, 0, s39
    s_cselect_b32 s93, 0x21c000, 0
    s_cselect_b32 s95, 0xfffc4000, 0
    s_add_u32 s92, s92, 2
    s_sub_u32 s36, s92, 10
    s_cmp_lt_u32 s92, 10
    s_cselect_b32 s92, s92, s36
    v_mfma_f32_16x16x32_bf16 v[8:11], v[144:147], v[216:219], v[8:11]
    ds_read_b64_tr_b16 v[122:123], v160 offset:1280
    v_mfma_f32_16x16x32_bf16 v[12:15], v[144:147], v[220:223], v[12:15]
    ds_read_b128 v[224:227], v167 offset:0
    v_mfma_f32_16x16x32_bf16 v[16:19], v[148:151], v[208:211], v[16:19]
    v_add_u32 v180, s93, v171
    v_add_u32 v181, s95, v171
    v_cmp_le_u32 vcc, 0x3b920, v171
    s_nop 1
    v_cndmask_b32 v180, v180, v181, vcc
    buffer_load_dwordx4 v180, s[12:15], s39 offen offset:0 lds
    v_mfma_f32_16x16x32_bf16 v[20:23], v[148:151], v[212:215], v[20:23]
    ds_read_b128 v[228:231], v167 offset:2048
    v_mfma_f32_16x16x32_bf16 v[24:27], v[148:151], v[216:219], v[24:27]
    ds_read_b128 v[232:235], v168 offset:0
    v_mfma_f32_16x16x32_bf16 v[28:31], v[148:151], v[220:223], v[28:31]
    v_add_u32 v180, s93, v172
    v_add_u32 v181, s95, v172
    v_cmp_le_u32 vcc, 0x3b920, v172
    s_nop 1
    v_cndmask_b32 v180, v180, v181, vcc
    buffer_load_dwordx4 v180, s[12:15], s39 offen offset:1024 lds
    v_mfma_f32_16x16x32_bf16 v[32:35], v[208:211], v[152:155], v[32:35]
    ds_read_b128 v[236:239], v168 offset:2048
    v_cndmask_b32 v92, v144, v152, s[72:73]
    v_cndmask_b32 v93, v145, v153, s[72:73]
    v_cndmask_b32 v94, v146, v154, s[72:73]
    v_cndmask_b32 v95, v147, v155, s[72:73]
    ds_read_b64_tr_b16 v[124:125], v161 offset:0
    v_mfma_f32_16x16x32_bf16 v[36:39], v[212:215], v[152:155], v[36:39]
    ds_read_b64_tr_b16 v[126:127], v161 offset:1280
    v_mfma_f32_16x16x32_bf16 v[40:43], v[216:219], v[152:155], v[40:43]
    v_add_u32 v180, s93, v173
    v_add_u32 v181, s95, v173
    v_cmp_le_u32 vcc, 0x3b920, v173
    s_nop 1
    v_cndmask_b32 v180, v180, v181, vcc
    buffer_load_dwordx4 v180, s[12:15], s39 offen offset:2048 lds
    v_mfma_f32_16x16x32_bf16 v[44:47], v[220:223], v[152:155], v[44:47]
    v_mfma_f32_16x16x32_bf16 v[48:51], v[208:211], v[156:159], v[48:51]
    ds_read_b64_tr_b16 v[128:129], v162 offset:0
    v_cndmask_b32 v96, v148, v156, s[72:73]
    v_cndmask_b32 v97, v149, v157, s[72:73]
    v_cndmask_b32 v98, v150, v158, s[72:73]
    v_cndmask_b32 v99, v151, v159, s[72:73]
    ds_read_b64_tr_b16 v[130:131], v162 offset:1280
    v_mfma_f32_16x16x32_bf16 v[52:55], v[212:215], v[156:159], v[52:55]
    v_add_u32 v180, s93, v174
    v_add_u32 v181, s95, v174
    v_cmp_le_u32 vcc, 0x3b920, v174
    s_nop 1
    v_cndmask_b32 v180, v180, v181, vcc
    buffer_load_dwordx4 v180, s[12:15], s39 offen offset:3072 lds
    v_mfma_f32_16x16x32_bf16 v[56:59], v[216:219], v[156:159], v[56:59]
    ds_read_b64_tr_b16 v[132:133], v163 offset:0
    v_mfma_f32_16x16x32_bf16 v[60:63], v[220:223], v[156:159], v[60:63]
    ds_read_b64_tr_b16 v[134:135], v163 offset:1280
    v_mfma_f32_16x16x32_bf16 v[64:67], v[112:115], v[208:211], v[64:67]
    ds_read_b64_tr_b16 v[136:137], v165 offset:0
    v_mfma_f32_16x16x32_bf16 v[68:71], v[112:115], v[212:215], v[68:71]
    v_add_u32 v180, s93, v175
    v_add_u32 v181, s95, v175
    v_cmp_le_u32 vcc, 0x3b920, v175
    s_nop 1
    v_cndmask_b32 v180, v180, v181, vcc
    s_add_u32 m0, s41, 0xb000
    s_nop 0
    buffer_load_dwordx4 v180, s[12:15], s39 offen lds
    v_mfma_f32_16x16x32_bf16 v[72:75], v[208:211], v[116:119], v[72:75]
    ds_read_b64_tr_b16 v[138:139], v165 offset:1280
    v_cndmask_b32 v100, v112, v116, s[72:73]
    v_cndmask_b32 v101, v113, v117, s[72:73]
    v_cndmask_b32 v102, v114, v118, s[72:73]
    v_cndmask_b32 v103, v115, v119, s[72:73]
    ds_read_b64_tr_b16 v[140:141], v166 offset:0
    v_mfma_f32_16x16x32_bf16 v[76:79], v[212:215], v[116:119], v[76:79]
    v_mfma_f32_16x16x32_bf16 v[80:83], v[108:111], v[92:95], v[80:83]
    ds_read_b64_tr_b16 v[142:143], v166 offset:1280
    v_mfma_f32_16x16x32_bf16 v[84:87], v[108:111], v[96:99], v[84:87]
    ds_read_b128 v[104:107], v183 offset:0
    v_mfma_f32_16x16x32_bf16 v[88:91], v[108:111], v[100:103], v[88:91]
    s_waitcnt lgkmcnt(14)
    v_mfma_f32_16x16x32_bf16 v[0:3], v[120:123], v[224:227], v[0:3]
    ds_read_b64_tr_b16 v[144:145], v160 offset:10240
    s_waitcnt lgkmcnt(14)
    v_mfma_f32_16x16x32_bf16 v[4:7], v[120:123], v[228:231], v[4:7]
    ds_read_b64_tr_b16 v[146:147], v160 offset:11520
    s_waitcnt lgkmcnt(14)
    v_mfma_f32_16x16x32_bf16 v[8:11], v[120:123], v[232:235], v[8:11]
    s_waitcnt lgkmcnt(13)
    v_mfma_f32_16x16x32_bf16 v[12:15], v[120:123], v[236:239], v[12:15]
    ds_read_b128 v[240:243], v169 offset:0
    s_waitcnt lgkmcnt(12)
    v_mfma_f32_16x16x32_bf16 v[16:19], v[124:127], v[224:227], v[16:19]
    ds_read_b128 v[244:247], v169 offset:2048
    v_mfma_f32_16x16x32_bf16 v[20:23], v[124:127], v[228:231], v[20:23]
    v_mfma_f32_16x16x32_bf16 v[24:27], v[124:127], v[232:235], v[24:27]
    ds_read_b128 v[248:251], v170 offset:0
    v_mfma_f32_16x16x32_bf16 v[28:31], v[124:127], v[236:239], v[28:31]
    ds_read_b128 v[252:255], v170 offset:2048
    s_waitcnt lgkmcnt(13)
    v_mfma_f32_16x16x32_bf16 v[32:35], v[224:227], v[128:131], v[32:35]
    v_cndmask_b32 v92, v120, v128, s[72:73]
    v_cndmask_b32 v93, v121, v129, s[72:73]
    v_cndmask_b32 v94, v122, v130, s[72:73]
    v_cndmask_b32 v95, v123, v131, s[72:73]
    ds_read_b64_tr_b16 v[148:149], v161 offset:10240
    v_mfma_f32_16x16x32_bf16 v[36:39], v[228:231], v[128:131], v[36:39]
    ds_read_b64_tr_b16 v[150:151], v161 offset:11520
    v_mfma_f32_16x16x32_bf16 v[40:43], v[232:235], v[128:131], v[40:43]
    v_mfma_f32_16x16x32_bf16 v[44:47], v[236:239], v[128:131], v[44:47]
    ds_read_b64_tr_b16 v[152:153], v162 offset:10240
    s_waitcnt lgkmcnt(14)
    v_mfma_f32_16x16x32_bf16 v[48:51], v[224:227], v[132:135], v[48:51]
    ds_read_b64_tr_b16 v[154:155], v162 offset:11520
    v_cndmask_b32 v96, v124, v132, s[72:73]
    v_cndmask_b32 v97, v125, v133, s[72:73]
    v_cndmask_b32 v98, v126, v134, s[72:73]
    v_cndmask_b32 v99, v127, v135, s[72:73]
    v_mfma_f32_16x16x32_bf16 v[52:55], v[228:231], v[132:135], v[52:55]
    ds_read_b64_tr_b16 v[156:157], v163 offset:10240
    v_mfma_f32_16x16x32_bf16 v[56:59], v[232:235], v[132:135], v[56:59]
    ds_read_b64_tr_b16 v[158:159], v163 offset:11520
    v_mfma_f32_16x16x32_bf16 v[60:63], v[236:239], v[132:135], v[60:63]
    s_waitcnt lgkmcnt(15)
    v_mfma_f32_16x16x32_bf16 v[64:67], v[136:139], v[224:227], v[64:67]
    ds_read_b64_tr_b16 v[112:113], v165 offset:10240
    v_mfma_f32_16x16x32_bf16 v[68:71], v[136:139], v[228:231], v[68:71]
    ds_read_b64_tr_b16 v[114:115], v165 offset:11520
    s_waitcnt lgkmcnt(15)
    v_mfma_f32_16x16x32_bf16 v[72:75], v[224:227], v[140:143], v[72:75]
    v_cndmask_b32 v100, v136, v140, s[72:73]
    v_cndmask_b32 v101, v137, v141, s[72:73]
    v_cndmask_b32 v102, v138, v142, s[72:73]
    v_cndmask_b32 v103, v139, v143, s[72:73]
    ds_read_b64_tr_b16 v[116:117], v166 offset:10240
    v_mfma_f32_16x16x32_bf16 v[76:79], v[228:231], v[140:143], v[76:79]
    ds_read_b64_tr_b16 v[118:119], v166 offset:11520
    s_waitcnt lgkmcnt(15)
    v_mfma_f32_16x16x32_bf16 v[80:83], v[104:107], v[92:95], v[80:83]
    v_mfma_f32_16x16x32_bf16 v[84:87], v[104:107], v[96:99], v[84:87]
    ds_read_b128 v[108:111], v184 offset:0
    v_mfma_f32_16x16x32_bf16 v[88:91], v[104:107], v[100:103], v[88:91]
    s_waitcnt lgkmcnt(0)
    s_barrier
    v_mfma_f32_16x16x32_bf16 v[0:3], v[144:147], v[240:243], v[0:3]
    s_add_u32 m0, s41, 0
    s_mul_i32 s39, s92, 0x3c000
    s_cmp_eq_u32 s92, 9
    s_cselect_b32 s39, 0, s39
    s_cselect_b32 s93, 0x21c000, 0
    s_cselect_b32 s95, 0xfffc4000, 0
    s_add_u32 s92, s92, 2
    s_sub_u32 s36, s92, 10
    s_cmp_lt_u32 s92, 10
    s_cselect_b32 s92, s92, s36
    v_mfma_f32_16x16x32_bf16 v[4:7], v[144:147], v[244:247], v[4:7]
    v_mfma_f32_16x16x32_bf16 v[8:11], v[144:147], v[248:251], v[8:11]
    v_mfma_f32_16x16x32_bf16 v[12:15], v[144:147], v[252:255], v[12:15]
    v_add_u32 v180, s93, v171
    v_add_u32 v181, s95, v171
    v_cmp_le_u32 vcc, 0x3b920, v171
    s_nop 1
    v_cndmask_b32 v180, v180, v181, vcc
    buffer_load_dwordx4 v180, s[12:15], s39 offen offset:0 lds
    v_mfma_f32_16x16x32_bf16 v[16:19], v[148:151], v[240:243], v[16:19]
    v_mfma_f32_16x16x32_bf16 v[20:23], v[148:151], v[244:247], v[20:23]
    v_mfma_f32_16x16x32_bf16 v[24:27], v[148:151], v[248:251], v[24:27]
    v_add_u32 v180, s93, v172
    v_add_u32 v181, s95, v172
    v_cmp_le_u32 vcc, 0x3b920, v172
    s_nop 1
    v_cndmask_b32 v180, v180, v181, vcc
    buffer_load_dwordx4 v180, s[12:15], s39 offen offset:1024 lds
    v_mfma_f32_16x16x32_bf16 v[28:31], v[148:151], v[252:255], v[28:31]
    v_mfma_f32_16x16x32_bf16 v[32:35], v[240:243], v[152:155], v[32:35]
    v_cndmask_b32 v92, v144, v152, s[72:73]
    v_cndmask_b32 v93, v145, v153, s[72:73]
    v_cndmask_b32 v94, v146, v154, s[72:73]
    v_cndmask_b32 v95, v147, v155, s[72:73]
    v_add_u32 v180, s93, v173
    v_add_u32 v181, s95, v173
    v_cmp_le_u32 vcc, 0x3b920, v173
    s_nop 1
    v_cndmask_b32 v180, v180, v181, vcc
    buffer_load_dwordx4 v180, s[12:15], s39 offen offset:2048 lds
    v_mfma_f32_16x16x32_bf16 v[36:39], v[244:247], v[152:155], v[36:39]
    v_mfma_f32_16x16x32_bf16 v[40:43], v[248:251], v[152:155], v[40:43]
    v_mfma_f32_16x16x32_bf16 v[44:47], v[252:255], v[152:155], v[44:47]
    v_mfma_f32_16x16x32_bf16 v[48:51], v[240:243], v[156:159], v[48:51]
    v_add_u32 v180, s93, v174
    v_add_u32 v181, s95, v174
    v_cmp_le_u32 vcc, 0x3b920, v174
    s_nop 1
    v_cndmask_b32 v180, v180, v181, vcc
    buffer_load_dwordx4 v180, s[12:15], s39 offen offset:3072 lds
    v_cndmask_b32 v96, v148, v156, s[72:73]
    v_cndmask_b32 v97, v149, v157, s[72:73]
    v_cndmask_b32 v98, v150, v158, s[72:73]
    v_cndmask_b32 v99, v151, v159, s[72:73]
    v_mfma_f32_16x16x32_bf16 v[52:55], v[244:247], v[156:159], v[52:55]
    v_mfma_f32_16x16x32_bf16 v[56:59], v[248:251], v[156:159], v[56:59]
    v_add_u32 v180, s93, v175
    v_add_u32 v181, s95, v175
    v_cmp_le_u32 vcc, 0x3b920, v175
    s_nop 1
    v_cndmask_b32 v180, v180, v181, vcc
    s_add_u32 m0, s41, 0x1000
    s_nop 0
    buffer_load_dwordx4 v180, s[12:15], s39 offen lds
    v_mfma_f32_16x16x32_bf16 v[60:63], v[252:255], v[156:159], v[60:63]
    v_mfma_f32_16x16x32_bf16 v[64:67], v[112:115], v[240:243], v[64:67]
    v_mfma_f32_16x16x32_bf16 v[68:71], v[112:115], v[244:247], v[68:71]
    v_mfma_f32_16x16x32_bf16 v[72:75], v[240:243], v[116:119], v[72:75]
    v_cndmask_b32 v100, v112, v116, s[72:73]
    v_cndmask_b32 v101, v113, v117, s[72:73]
    v_cndmask_b32 v102, v114, v118, s[72:73]
    v_cndmask_b32 v103, v115, v119, s[72:73]
    v_mfma_f32_16x16x32_bf16 v[76:79], v[244:247], v[116:119], v[76:79]
    s_mov_b32 s47, 0x3b920
    v_mfma_f32_16x16x32_bf16 v[80:83], v[108:111], v[92:95], v[80:83]
    v_mfma_f32_16x16x32_bf16 v[84:87], v[108:111], v[96:99], v[84:87]
    v_mfma_f32_16x16x32_bf16 v[88:91], v[108:111], v[100:103], v[88:91]
    v_lshrrev_b32 v100, 2, v190
    v_lshlrev_b32 v100, 7, v100
    v_and_b32 v101, 3, v190
    v_lshlrev_b32 v101, 4, v101
    v_add_u32 v100, v100, v101
    v_add_u32 v100, 0xb00000, v100
    v_mov_b32 v92, -1
    v_mov_b32 v93, -1
    v_mov_b32 v94, -1
    v_mov_b32 v95, -1
    s_lshl_b32 s36, s31, 3
    s_lshl_b32 s37, s34, 2
    s_add_u32 s36, s36, s37
    s_lshl_b32 s36, s36, 2
    s_lshr_b32 s37, s32, 1
    s_add_u32 s36, s36, s37
    s_mul_i32 s36, s36, 0x1400
    s_add_u32 s48, s36, 0x280000
    s_add_u32 s49, s48, 0x5000
    s_add_u32 s50, s48, 0xa000
    s_add_u32 s51, s48, 0xf000
    s_add_u32 s52, s48, 0x1000
    s_add_u32 s53, s48, 0xb000
    s_and_b32 s42, s32, 1
    s_lshl_b32 s37, s42, 1
    s_add_u32 s37, s37, s35
    s_lshl_b32 s37, s37, 10
    v_lshlrev_b32 v96, 4, v190
    v_add_u32 v96, s37, v96
    s_lshl_b32 s37, s35, 9
    s_lshl_b32 s42, s42, 8
    s_add_u32 s37, s37, s42
    v_lshrrev_b32 v97, 4, v190
    v_mul_u32_u24 v97, 0x5000, v97
    v_and_b32 v95, 15, v190
    v_lshlrev_b32 v95, 4, v95
    v_add3_u32 v97, v95, v97, s37
    v_mov_b32 v95, -1
    s_lshl_b32 s36, s34, 1
    s_add_u32 s42, s36, s35
    s_xor_b32 s43, s42, 1
    v_and_b32 v180, 15, v190
    v_lshrrev_b32 v181, 4, v190
    s_lshl_b32 s36, s42, 4
    s_mul_i32 s37, s35, 0x120
    s_add_u32 s36, s36, s37
    buffer_load_dwordx4 v[156:159], v100, s[16:19], 0 offen sc1
    s_add_u32 s36, s36, 8
    v_add_u32 v184, s36, v180
    v_mul_u32_u24 v184, 40, v184
    v_lshlrev_b32 v185, 3, v181
    v_add_u32 v185, v185, v184
    v_add_u32 v185, 0xf000, v185
    s_lshl_b32 s36, s43, 4
    s_mul_i32 s37, s35, 0x120
    s_add_u32 m0, s41, 0x1e000
    s_mul_i32 s100, s92, 0x3c000
    s_cmp_eq_u32 s92, 9
    s_cselect_b32 s100, 0, s100
    s_cselect_b32 s93, 0x21c000, 0
    s_cselect_b32 s95, 0xfffc4000, 0
    s_add_u32 s92, s92, 2
    s_sub_u32 s46, s92, 10
    s_cmp_lt_u32 s92, 10
    s_cselect_b32 s92, s92, s46
    s_add_u32 s36, s36, s37
    s_add_u32 s36, s36, 8
    v_add_u32 v184, s36, v180
    v_mul_u32_u24 v184, 40, v184
    v_lshlrev_b32 v186, 3, v181
    v_add_u32 v186, v186, v184
    v_add_u32 v186, 0xf000, v186
    v_cvt_pk_bf16_f32 v0, v0, v1
    v_add_u32 v120, s93, v171
    v_add_u32 v121, s95, v171
    v_cmp_le_u32 s[44:45], s47, v171
    s_nop 1
    v_cndmask_b32 v120, v120, v121, s[44:45]
    buffer_load_dwordx4 v120, s[12:15], s100 offen offset:0 lds
    v_cvt_pk_bf16_f32 v1, v2, v3
    ds_write_b64 v185, v[0:1] offset:0
    v_cvt_pk_bf16_f32 v4, v4, v5
    v_cvt_pk_bf16_f32 v5, v6, v7
    ds_write_b64 v185, v[4:5] offset:2880
    v_cvt_pk_bf16_f32 v8, v8, v9
    v_cvt_pk_bf16_f32 v9, v10, v11
    ds_write_b64 v186, v[8:9] offset:0
    v_add_u32 v120, s93, v172
    v_add_u32 v121, s95, v172
    v_cmp_le_u32 s[44:45], s47, v172
    s_nop 1
    v_cndmask_b32 v120, v120, v121, s[44:45]
    buffer_load_dwordx4 v120, s[12:15], s100 offen offset:1024 lds
    v_cvt_pk_bf16_f32 v12, v12, v13
    v_cvt_pk_bf16_f32 v13, v14, v15
    ds_write_b64 v186, v[12:13] offset:2880
    v_cvt_pk_bf16_f32 v16, v16, v17
    v_cvt_pk_bf16_f32 v17, v18, v19
    ds_write_b64 v185, v[16:17] offset:5760
    v_cvt_pk_bf16_f32 v20, v20, v21
    v_cvt_pk_bf16_f32 v21, v22, v23
    v_add_u32 v120, s93, v173
    v_add_u32 v121, s95, v173
    v_cmp_le_u32 s[44:45], s47, v173
    s_nop 1
    v_cndmask_b32 v120, v120, v121, s[44:45]
    buffer_load_dwordx4 v120, s[12:15], s100 offen offset:2048 lds
    ds_write_b64 v185, v[20:21] offset:8640
    v_cvt_pk_bf16_f32 v24, v24, v25
    v_cvt_pk_bf16_f32 v25, v26, v27
    ds_write_b64 v186, v[24:25] offset:5760
    v_cvt_pk_bf16_f32 v28, v28, v29
    v_cvt_pk_bf16_f32 v29, v30, v31
    ds_write_b64 v186, v[28:29] offset:8640
    s_lshl_b32 s37, s35, 1
    v_add_u32 v120, s93, v174
    v_add_u32 v121, s95, v174
    v_cmp_le_u32 s[44:45], s47, v174
    s_nop 1
    v_cndmask_b32 v120, v120, v121, s[44:45]
    buffer_load_dwordx4 v120, s[12:15], s100 offen offset:3072 lds
    v_xor_b32 v184, s37, v181
    v_mul_u32_u24 v184, 0x1680, v184
    s_lshl_b32 s36, s42, 4
    s_add_u32 s36, s36, 8
    v_add_u32 v182, s36, v180
    v_mul_u32_u24 v182, 40, v182
    v_add_u32 v182, v182, v184
    v_add_u32 v182, 0xf020, v182
    v_add_u32 v120, s93, v175
    v_add_u32 v121, s95, v175
    v_cmp_le_u32 s[44:45], s47, v175
    s_nop 1
    v_cndmask_b32 v120, v120, v121, s[44:45]
    s_add_u32 m0, s41, 0x1f000
    s_nop 0
    buffer_load_dwordx4 v120, s[12:15], s100 offen lds
    v_cvt_pk_bf16_f32 v64, v64, v65
    v_cvt_pk_bf16_f32 v65, v66, v67
    ds_write_b64 v182, v[64:65] offset:0
    v_cvt_pk_bf16_f32 v68, v68, v69
    v_cvt_pk_bf16_f32 v69, v70, v71
    ds_write_b64 v182, v[68:69] offset:2880
    v_lshrrev_b32 v184, 2, v180
    v_mul_u32_u24 v184, 0x310, v184
    v_and_b32 v183, 3, v180
    v_mul_u32_u24 v183, 0xc0, v183
    v_add_u32 v183, v183, v184
    v_lshlrev_b32 v184, 3, v181
    v_add_u32 v183, v183, v184
    s_lshl_b32 s36, s42, 5
    s_mul_i32 s37, s35, 0x3d40
    s_add_u32 s36, s36, s37
    s_add_u32 m0, s41, 0x23000
    s_mul_i32 s100, s92, 0x3c000
    s_cmp_eq_u32 s92, 9
    s_cselect_b32 s100, 0, s100
    s_cselect_b32 s93, 0x21c000, 0
    s_cselect_b32 s95, 0xfffc4000, 0
    s_add_u32 s92, s92, 2
    s_sub_u32 s46, s92, 10
    s_cmp_lt_u32 s92, 10
    s_cselect_b32 s92, s92, s46
    s_add_u32 s36, s36, 0x14a10
    v_add_u32 v185, s36, v183
    s_lshl_b32 s36, s43, 5
    s_mul_i32 s37, s35, 0x3d40
    s_add_u32 s36, s36, s37
    s_add_u32 s36, s36, 0x14a10
    v_add_u32 v186, s36, v183
    v_cvt_pk_bf16_f32 v32, v32, v33
    v_add_u32 v120, s93, v171
    v_add_u32 v121, s95, v171
    v_cmp_le_u32 s[44:45], s47, v171
    s_nop 1
    v_cndmask_b32 v120, v120, v121, s[44:45]
    buffer_load_dwordx4 v120, s[12:15], s100 offen offset:0 lds
    v_cvt_pk_bf16_f32 v33, v34, v35
    ds_write_b64 v185, v[32:33] offset:0
    v_cvt_pk_bf16_f32 v36, v36, v37
    v_cvt_pk_bf16_f32 v37, v38, v39
    ds_write_b64 v185, v[36:37] offset:3920
    v_cvt_pk_bf16_f32 v40, v40, v41
    v_cvt_pk_bf16_f32 v41, v42, v43
    ds_write_b64 v186, v[40:41] offset:0
    v_add_u32 v120, s93, v172
    v_add_u32 v121, s95, v172
    v_cmp_le_u32 s[44:45], s47, v172
    s_nop 1
    v_cndmask_b32 v120, v120, v121, s[44:45]
    buffer_load_dwordx4 v120, s[12:15], s100 offen offset:1024 lds
    v_cvt_pk_bf16_f32 v44, v44, v45
    v_cvt_pk_bf16_f32 v45, v46, v47
    ds_write_b64 v186, v[44:45] offset:3920
    v_cvt_pk_bf16_f32 v48, v48, v49
    v_cvt_pk_bf16_f32 v49, v50, v51
    ds_write_b64 v185, v[48:49] offset:7840
    v_cvt_pk_bf16_f32 v52, v52, v53
    v_cvt_pk_bf16_f32 v53, v54, v55
    v_add_u32 v120, s93, v173
    v_add_u32 v121, s95, v173
    v_cmp_le_u32 s[44:45], s47, v173
    s_nop 1
    v_cndmask_b32 v120, v120, v121, s[44:45]
    buffer_load_dwordx4 v120, s[12:15], s100 offen offset:2048 lds
    ds_write_b64 v185, v[52:53] offset:11760
    v_cvt_pk_bf16_f32 v56, v56, v57
    v_cvt_pk_bf16_f32 v57, v58, v59
    ds_write_b64 v186, v[56:57] offset:7840
    v_cvt_pk_bf16_f32 v60, v60, v61
    v_cvt_pk_bf16_f32 v61, v62, v63
    ds_write_b64 v186, v[60:61] offset:11760
    v_lshrrev_b32 v184, 2, v180
    v_add_u32 v120, s93, v174
    v_add_u32 v121, s95, v174
    v_cmp_le_u32 s[44:45], s47, v174
    s_nop 1
    v_cndmask_b32 v120, v120, v121, s[44:45]
    buffer_load_dwordx4 v120, s[12:15], s100 offen offset:3072 lds
    s_lshl_b32 s37, s35, 1
    v_xor_b32 v184, s37, v184
    v_mul_u32_u24 v184, 0x1ea0, v184
    v_and_b32 v183, 3, v180
    v_mul_u32_u24 v183, 0xc0, v183
    v_add_u32 v183, v183, v184
    v_lshlrev_b32 v184, 3, v181
    v_add_u32 v183, v183, v184
    v_add_u32 v120, s93, v175
    v_add_u32 v121, s95, v175
    v_cmp_le_u32 s[44:45], s47, v175
    s_nop 1
    v_cndmask_b32 v120, v120, v121, s[44:45]
    s_add_u32 m0, s41, 0x24000
    s_nop 0
    buffer_load_dwordx4 v120, s[12:15], s100 offen lds
    s_lshl_b32 s36, s42, 5
    s_add_u32 s36, s36, 0x15650
    v_add_u32 v183, s36, v183
    v_cvt_pk_bf16_f32 v72, v72, v73
    v_cvt_pk_bf16_f32 v73, v74, v75
    ds_write_b64 v183, v[72:73] offset:0
    v_cvt_pk_bf16_f32 v76, v76, v77
    v_cvt_pk_bf16_f32 v77, v78, v79
    ds_write_b64 v183, v[76:77] offset:3920
    v_and_b32 v180, 15, v190
    v_lshrrev_b32 v181, 4, v190
    s_cmp_eq_u32 s34, 1
    s_cselect_b32 s38, 2, 40
    s_mov_b32 s36, 0x1ea0
    s_mov_b32 s37, 0x1680
    s_cselect_b32 s39, s36, s37
    v_lshrrev_b32 v182, 1, v181
    buffer_store_dwordx4 v[92:95], v96, s[16:19], s48 offen sc1
    v_and_b32 v183, 1, v181
    v_mul_u32_u24 v184, 0xb40, v182
    v_mul_u32_u24 v185, 0xa0, v183
    v_add_u32 v184, v184, v185
    v_add_u32 v184, 0xf000, v184
    v_mul_u32_u24 v185, 0xf50, v182
    v_lshlrev_b32 v183, 3, v183
    v_add_u32 v185, v185, v183
    buffer_store_dwordx4 v[92:95], v96, s[16:19], s49 offen sc1
    v_add_u32 v185, 0x14a00, v185
    v_lshlrev_b32 v182, 1, v180
    s_mul_i32 s36, s35, 0x2d00
    v_add3_u32 v186, v184, v182, s36
    v_lshrrev_b32 v182, 2, v180
    v_mul_u32_u24 v182, 0x310, v182
    v_and_b32 v183, 3, v180
    v_mul_u32_u24 v183, 0xc0, v183
    buffer_store_dwordx4 v[92:95], v96, s[16:19], s50 offen sc1
    v_add_u32 v182, v182, v183
    s_mul_i32 s36, s35, 0x3d40
    v_add3_u32 v182, v185, v182, s36
    v_cndmask_b32 v186, v186, v182, s[72:73]
    v_lshrrev_b32 v182, 2, v180
    s_lshl_b32 s36, s35, 1
    v_xor_b32 v182, s36, v182
    v_and_b32 v183, 3, v180
    buffer_store_dwordx4 v[92:95], v96, s[16:19], s51 offen sc1
    v_mul_u32_u24 v187, 0x1680, v182
    v_add_u32 v187, v187, v184
    v_lshlrev_b32 v184, 1, v183
    v_add_u32 v187, v187, v184
    v_add_u32 v187, 32, v187
    v_mul_u32_u24 v182, 0x1ea0, v182
    v_add_u32 v182, v182, v185
    v_mul_u32_u24 v183, 0xc0, v183
    buffer_store_dwordx4 v[92:95], v97, s[16:19], s52 offen sc1
    v_add_u32 v182, v182, v183
    v_add_u32 v182, 0xc40, v182
    v_cndmask_b32 v187, v187, v182, s[72:73]
    v_add_u32 v188, s39, v186
    v_cvt_pk_bf16_f32 v80, v80, v81
    v_cvt_pk_bf16_f32 v81, v82, v83
    v_add_u32 v182, s38, v186
    ds_write_b16 v186, v80
    ds_write_b16_d16_hi v182, v80
    v_add_u32 v183, s38, v182
    v_add_u32 v180, s38, v183
    ds_write_b16 v183, v81
    ds_write_b16_d16_hi v180, v81
    v_cvt_pk_bf16_f32 v84, v84, v85
    v_cvt_pk_bf16_f32 v85, v86, v87
    v_add_u32 v182, s38, v188
    ds_write_b16 v188, v84
    ds_write_b16_d16_hi v182, v84
    v_add_u32 v183, s38, v182
    v_add_u32 v180, s38, v183
    ds_write_b16 v183, v85
    ds_write_b16_d16_hi v180, v85
    v_cvt_pk_bf16_f32 v88, v88, v89
    v_cvt_pk_bf16_f32 v89, v90, v91
    v_add_u32 v182, s38, v187
    ds_write_b16 v187, v88
    ds_write_b16_d16_hi v182, v88
    v_add_u32 v183, s38, v182
    v_add_u32 v180, s38, v183
    ds_write_b16 v183, v89
    ds_write_b16_d16_hi v180, v89
    s_waitcnt vmcnt(21)
    s_barrier
    ds_read_b64_tr_b16 v[120:121], v160 offset:20480
    ds_read_b64_tr_b16 v[122:123], v160 offset:21760
    ds_read_b64_tr_b16 v[124:125], v161 offset:20480
    ds_read_b64_tr_b16 v[126:127], v161 offset:21760
    ds_read_b64_tr_b16 v[128:129], v165 offset:20480
    ds_read_b64_tr_b16 v[130:131], v165 offset:21760
    ds_read_b64_tr_b16 v[144:145], v160 offset:30720
    ds_read_b64_tr_b16 v[146:147], v160 offset:32000
    ds_read_b64_tr_b16 v[148:149], v161 offset:30720
    ds_read_b64_tr_b16 v[150:151], v161 offset:32000
    ds_read_b64_tr_b16 v[152:153], v165 offset:30720
    ds_read_b64_tr_b16 v[154:155], v165 offset:32000
    s_waitcnt lgkmcnt(10)
    v_mfma_f32_16x16x32_bf16 v[80:83], v[120:123], a[0:3], 0
    ds_read_b64_tr_b16 v[132:133], v162 offset:20480
    v_mfma_f32_16x16x32_bf16 v[84:87], v[120:123], a[4:7], 0
    ds_read_b64_tr_b16 v[134:135], v162 offset:21760
    v_mfma_f32_16x16x32_bf16 v[88:91], v[120:123], a[8:11], 0
    v_mfma_f32_16x16x32_bf16 v[92:95], v[120:123], a[12:15], 0
    ds_read_b64_tr_b16 v[136:137], v163 offset:20480
    s_waitcnt lgkmcnt(11)
    v_mfma_f32_16x16x32_bf16 v[96:99], v[124:127], a[0:3], 0
    v_mfma_f32_16x16x32_bf16 v[100:103], v[124:127], a[4:7], 0
    ds_read_b64_tr_b16 v[138:139], v163 offset:21760
    v_mfma_f32_16x16x32_bf16 v[104:107], v[124:127], a[8:11], 0
    ds_read_b64_tr_b16 v[140:141], v166 offset:20480
    v_mfma_f32_16x16x32_bf16 v[108:111], v[124:127], a[12:15], 0
    s_waitcnt lgkmcnt(11)
    v_mfma_f32_16x16x32_bf16 v[112:115], v[128:131], a[0:3], 0
    ds_read_b64_tr_b16 v[142:143], v166 offset:21760
    v_mfma_f32_16x16x32_bf16 v[116:119], v[128:131], a[4:7], 0
    s_waitcnt lgkmcnt(10)
    v_mfma_f32_16x16x32_bf16 v[80:83], v[144:147], a[16:19], v[80:83]
    ds_read_b64_tr_b16 v[120:121], v162 offset:30720
    v_mfma_f32_16x16x32_bf16 v[84:87], v[144:147], a[20:23], v[84:87]
    ds_read_b64_tr_b16 v[122:123], v162 offset:32000
    v_mfma_f32_16x16x32_bf16 v[88:91], v[144:147], a[24:27], v[88:91]
    v_mfma_f32_16x16x32_bf16 v[92:95], v[144:147], a[28:31], v[92:95]
    ds_read_b64_tr_b16 v[124:125], v163 offset:30720
    s_waitcnt lgkmcnt(11)
    v_mfma_f32_16x16x32_bf16 v[96:99], v[148:151], a[16:19], v[96:99]
    v_mfma_f32_16x16x32_bf16 v[100:103], v[148:151], a[20:23], v[100:103]
    ds_read_b64_tr_b16 v[126:127], v163 offset:32000
    v_mfma_f32_16x16x32_bf16 v[104:107], v[148:151], a[24:27], v[104:107]
    ds_read_b64_tr_b16 v[128:129], v166 offset:30720
    v_mfma_f32_16x16x32_bf16 v[108:111], v[148:151], a[28:31], v[108:111]
    s_waitcnt lgkmcnt(11)
    v_mfma_f32_16x16x32_bf16 v[112:115], v[152:155], a[16:19], v[112:115]
    ds_read_b64_tr_b16 v[130:131], v166 offset:32000
    v_mfma_f32_16x16x32_bf16 v[116:119], v[152:155], a[20:23], v[116:119]
    s_waitcnt vmcnt(16)
    s_barrier
    s_waitcnt lgkmcnt(10)
    v_mfma_f32_16x16x32_bf16 v[80:83], v[132:135], a[32:35], v[80:83]
    ds_read_b64_tr_b16 v[144:145], v160 offset:40960
    ds_read_b64_tr_b16 v[146:147], v160 offset:42240
    ds_read_b64_tr_b16 v[148:149], v161 offset:40960
    ds_read_b64_tr_b16 v[150:151], v161 offset:42240
    ds_read_b64_tr_b16 v[152:153], v165 offset:40960
    ds_read_b64_tr_b16 v[154:155], v165 offset:42240
    v_mfma_f32_16x16x32_bf16 v[84:87], v[132:135], a[36:39], v[84:87]
    s_waitcnt vmcnt(15)
    v_xor_b32 v156, s28, v156
    v_xor_b32 v157, s28, v157
    v_xor_b32 v158, s28, v158
    v_xor_b32 v159, s28, v159
    v_or3_b32 v156, v156, v157, v158
    v_or_b32 v156, v156, v159
    v_cmp_ne_u32 vcc, 0, v156
    s_nop 4
    s_cbranch_vccz Lfbd_33
    s_mov_b32 s43, 0
Lfb_32:
    v_lshrrev_b32 v187, 2, v190
    v_lshlrev_b32 v187, 7, v187
    v_and_b32 v185, 3, v190
    v_lshlrev_b32 v185, 4, v185
    v_add_u32 v187, v187, v185
    s_mov_b32 s36, 0xb00000
    buffer_load_dwordx4 v[156:159], v187, s[16:19], s36 offen sc1
    s_waitcnt vmcnt(0)
    v_xor_b32 v156, s28, v156
    v_xor_b32 v157, s28, v157
    v_xor_b32 v158, s28, v158
    v_xor_b32 v159, s28, v159
    v_or3_b32 v156, v156, v157, v158
    v_or_b32 v156, v156, v159
    v_cmp_ne_u32 vcc, 0, v156
    s_nop 4
    s_cbranch_vccz Lfbd_33
    s_add_u32 s43, s43, 1
    s_cmp_lt_u32 s43, 0x8000
    s_cbranch_scc1 Lfb_32
Lfbd_33:
    s_not_b32 s36, s94
    s_and_b32 s36, s36, 2
    s_lshl_b32 s36, s36, 1
    s_lshr_b32 s44, s94, 1
    s_and_b32 s44, s44, 2
    v_mfma_f32_16x16x32_bf16 v[88:91], v[132:135], a[40:43], v[88:91]
    s_add_u32 s44, s44, s36
    s_and_b32 s36, s94, 1
    s_add_u32 s44, s44, s36
    s_lshl_b32 s44, s44, 2
    s_lshr_b32 s36, s94, 3
    s_and_b32 s36, s36, 3
    v_mfma_f32_16x16x32_bf16 v[92:95], v[132:135], a[44:47], v[92:95]
    s_add_u32 s44, s44, s36
    s_lshr_b32 s45, s94, 5
    s_and_b32 s36, s44, 3
    s_mul_i32 s36, s36, 1
    s_add_u32 s46, s45, s36
    s_sub_u32 s36, s46, 5
    s_waitcnt lgkmcnt(14)
    v_mfma_f32_16x16x32_bf16 v[96:99], v[136:139], a[32:35], v[96:99]
    s_cmp_lt_u32 s46, 5
    s_cselect_b32 s46, s46, s36
    s_sub_u32 s36, s46, 5
    s_cmp_lt_u32 s46, 5
    s_cselect_b32 s46, s46, s36
    s_sub_u32 s36, s46, 5
    v_mfma_f32_16x16x32_bf16 v[100:103], v[136:139], a[36:39], v[100:103]
    s_cmp_lt_u32 s46, 5
    s_cselect_b32 s46, s46, s36
    s_and_b32 s47, s45, 3
    s_mul_i32 s36, s45, 0x64
    s_mul_i32 s37, s33, 25
    s_add_u32 s36, s36, s37
    v_mfma_f32_16x16x32_bf16 v[104:107], v[136:139], a[40:43], v[104:107]
    s_lshl_b32 s36, s36, 10
    s_add_u32 s24, s36, 0xcc8000
    s_add_u32 s25, s24, 0x1000
    s_mul_i32 s36, s45, 0x64
    s_mul_i32 s37, s33, 25
    s_add_u32 s36, s36, s37
    v_mfma_f32_16x16x32_bf16 v[108:111], v[136:139], a[44:47], v[108:111]
    s_lshl_b32 s36, s36, 10
    s_add_u32 s26, s36, 0xc00000
    s_add_u32 s27, s26, 0x1000
    s_lshl_b32 s36, s35, 2
    s_add_u32 s36, s36, s34
    v_mul_u32_u24 v167, 40, v190
    s_waitcnt lgkmcnt(12)
    v_mfma_f32_16x16x32_bf16 v[112:115], v[140:143], a[32:35], v[112:115]
    s_mul_i32 s37, s36, 0xb40
    s_add_u32 s37, s37, 0xf000
    v_add_u32 v167, s37, v167
    v_and_b32 v168, 3, v190
    v_mul_u32_u24 v168, 0xc0, v168
    v_lshrrev_b32 v169, 2, v190
    v_mfma_f32_16x16x32_bf16 v[116:119], v[140:143], a[36:39], v[116:119]
    v_lshlrev_b32 v169, 3, v169
    v_add_u32 v168, v168, v169
    s_mul_i32 s37, s36, 0xf50
    s_add_u32 s37, s37, 0x14a00
    v_add_u32 v168, s37, v168
    s_waitcnt lgkmcnt(10)
    v_mfma_f32_16x16x32_bf16 v[80:83], v[120:123], a[48:51], v[80:83]
    ds_read_b64_tr_b16 v[132:133], v160 offset:51200
    ds_read_b64_tr_b16 v[134:135], v160 offset:52480
    ds_read_b64_tr_b16 v[136:137], v161 offset:51200
    ds_read_b64_tr_b16 v[138:139], v161 offset:52480
    ds_read_b64_tr_b16 v[140:141], v165 offset:51200
    v_mfma_f32_16x16x32_bf16 v[84:87], v[120:123], a[52:55], v[84:87]
    ds_read_b64_tr_b16 v[142:143], v165 offset:52480
    s_add_u32 s36, s46, 0
    s_mul_i32 s36, s36, 0x1400
    v_lshlrev_b32 v156, 4, v190
    v_mfma_f32_16x16x32_bf16 v[88:91], v[120:123], a[56:59], v[88:91]
    v_add_u32 v156, s36, v156
    s_add_u32 s36, s46, 1
    s_sub_u32 s43, s36, 5
    s_cmp_ge_u32 s36, 5
    v_mfma_f32_16x16x32_bf16 v[92:95], v[120:123], a[60:63], v[92:95]
    s_cselect_b32 s36, s43, s36
    s_mul_i32 s36, s36, 0x1400
    v_lshlrev_b32 v157, 4, v190
    v_add_u32 v157, s36, v157
    s_waitcnt lgkmcnt(14)
    v_mfma_f32_16x16x32_bf16 v[96:99], v[124:127], a[48:51], v[96:99]
    s_add_u32 s36, s46, 2
    s_sub_u32 s43, s36, 5
    s_cmp_ge_u32 s36, 5
    s_cselect_b32 s36, s43, s36
    v_mfma_f32_16x16x32_bf16 v[100:103], v[124:127], a[52:55], v[100:103]
    s_mul_i32 s36, s36, 0x1400
    v_lshlrev_b32 v158, 4, v190
    v_add_u32 v158, s36, v158
    s_add_u32 s36, s46, 3
    s_sub_u32 s43, s36, 5
    v_mfma_f32_16x16x32_bf16 v[104:107], v[124:127], a[56:59], v[104:107]
    s_cmp_ge_u32 s36, 5
    s_cselect_b32 s36, s43, s36
    s_mul_i32 s36, s36, 0x1400
    v_lshlrev_b32 v159, 4, v190
    v_mfma_f32_16x16x32_bf16 v[108:111], v[124:127], a[60:63], v[108:111]
    v_add_u32 v159, s36, v159
    s_add_u32 s36, s46, 4
    s_sub_u32 s43, s36, 5
    s_cmp_ge_u32 s36, 5
    s_waitcnt lgkmcnt(12)
    v_mfma_f32_16x16x32_bf16 v[112:115], v[128:131], a[48:51], v[112:115]
    s_cselect_b32 s36, s43, s36
    s_mul_i32 s36, s36, 0x1400
    v_lshlrev_b32 v189, 4, v190
    v_add_u32 v189, s36, v189
    v_mfma_f32_16x16x32_bf16 v[116:119], v[128:131], a[52:55], v[116:119]
    ds_read_b64 v[10:11], v167 offset:0
    ds_read_b64 v[20:21], v167 offset:160
    buffer_load_dwordx4 a[0:3], v156, s[16:19], s24 offen offset:0 sc1
    buffer_load_dwordx4 a[4:7], v156, s[16:19], s24 offen offset:1024 sc1
    s_waitcnt lgkmcnt(12)
    v_mfma_f32_16x16x32_bf16 v[80:83], v[144:147], a[64:67], v[80:83]
    ds_read_b64_tr_b16 v[120:121], v162 offset:40960
    v_mfma_f32_16x16x32_bf16 v[84:87], v[144:147], a[68:71], v[84:87]
    ds_read_b64_tr_b16 v[122:123], v162 offset:42240
    v_mfma_f32_16x16x32_bf16 v[88:91], v[144:147], a[72:75], v[88:91]
    ds_read_b64_tr_b16 v[124:125], v163 offset:40960
    v_mfma_f32_16x16x32_bf16 v[92:95], v[144:147], a[76:79], v[92:95]
    ds_read_b64_tr_b16 v[126:127], v163 offset:42240
    s_waitcnt lgkmcnt(14)
    v_mfma_f32_16x16x32_bf16 v[96:99], v[148:151], a[64:67], v[96:99]
    ds_read_b64_tr_b16 v[128:129], v166 offset:40960
    v_mfma_f32_16x16x32_bf16 v[100:103], v[148:151], a[68:71], v[100:103]
    ds_read_b64_tr_b16 v[130:131], v166 offset:42240
    v_mfma_f32_16x16x32_bf16 v[104:107], v[148:151], a[72:75], v[104:107]
    ds_read_b64 v[30:31], v167 offset:320
    v_mfma_f32_16x16x32_bf16 v[108:111], v[148:151], a[76:79], v[108:111]
    ds_read_b64 v[12:13], v167 offset:8
    s_waitcnt lgkmcnt(15)
    v_mfma_f32_16x16x32_bf16 v[112:115], v[152:155], a[64:67], v[112:115]
    buffer_load_dwordx4 a[8:11], v156, s[16:19], s24 offen offset:2048 sc1
    v_mfma_f32_16x16x32_bf16 v[116:119], v[152:155], a[68:71], v[116:119]
    buffer_load_dwordx4 a[12:15], v156, s[16:19], s24 offen offset:3072 sc1
    s_waitcnt lgkmcnt(14)
    v_mfma_f32_16x16x32_bf16 v[80:83], v[132:135], a[80:83], v[80:83]
    ds_read_b64_tr_b16 v[144:145], v162 offset:51200
    v_mfma_f32_16x16x32_bf16 v[84:87], v[132:135], a[84:87], v[84:87]
    ds_read_b64_tr_b16 v[146:147], v162 offset:52480
    v_mfma_f32_16x16x32_bf16 v[88:91], v[132:135], a[88:91], v[88:91]
    ds_read_b64_tr_b16 v[148:149], v163 offset:51200
    v_mfma_f32_16x16x32_bf16 v[92:95], v[132:135], a[92:95], v[92:95]
    ds_read_b64_tr_b16 v[150:151], v163 offset:52480
    s_waitcnt lgkmcnt(15)
    v_mfma_f32_16x16x32_bf16 v[96:99], v[136:139], a[80:83], v[96:99]
    ds_read_b64_tr_b16 v[152:153], v166 offset:51200
    v_mfma_f32_16x16x32_bf16 v[100:103], v[136:139], a[84:87], v[100:103]
    ds_read_b64_tr_b16 v[154:155], v166 offset:52480
    v_mfma_f32_16x16x32_bf16 v[104:107], v[136:139], a[88:91], v[104:107]
    ds_read_b64 v[22:23], v167 offset:168
    v_mfma_f32_16x16x32_bf16 v[108:111], v[136:139], a[92:95], v[108:111]
    ds_read_b64 v[32:33], v167 offset:328
    s_waitcnt lgkmcnt(15)
    v_mfma_f32_16x16x32_bf16 v[112:115], v[140:143], a[80:83], v[112:115]
    buffer_load_dwordx4 a[16:19], v156, s[16:19], s25 offen offset:0 sc1
    v_mfma_f32_16x16x32_bf16 v[116:119], v[140:143], a[84:87], v[116:119]
    buffer_load_dwordx4 a[20:23], v157, s[16:19], s24 offen offset:0 sc1
    s_waitcnt vmcnt(6)
    s_barrier
    s_waitcnt lgkmcnt(14)
    v_mfma_f32_16x16x32_bf16 v[80:83], v[120:123], a[96:99], v[80:83]
    ds_read_b64_tr_b16 v[132:133], v160 offset:0
    ds_read_b64_tr_b16 v[134:135], v160 offset:1280
    ds_read_b64_tr_b16 v[136:137], v161 offset:0
    v_mfma_f32_16x16x32_bf16 v[84:87], v[120:123], a[100:103], v[84:87]
    ds_read_b64_tr_b16 v[138:139], v161 offset:1280
    ds_read_b64_tr_b16 v[140:141], v165 offset:0
    v_mfma_f32_16x16x32_bf16 v[88:91], v[120:123], a[104:107], v[88:91]
    ds_read_b64_tr_b16 v[142:143], v165 offset:1280
    s_lshr_b32 s36, s94, 4
    v_mfma_f32_16x16x32_bf16 v[92:95], v[120:123], a[108:111], v[92:95]
    s_lshl_b32 s36, s36, 7
    s_and_b32 s37, s94, 15
    s_lshl_b32 s37, s37, 2
    s_waitcnt lgkmcnt(15)
    v_mfma_f32_16x16x32_bf16 v[96:99], v[124:127], a[96:99], v[96:99]
    s_add_u32 s36, s36, s37
    s_add_u32 s36, s36, 0xb01000
    v_mfma_f32_16x16x32_bf16 v[100:103], v[124:127], a[100:103], v[100:103]
    v_mov_b32 v180, s36
    v_mov_b32 v181, s91
    v_mfma_f32_16x16x32_bf16 v[104:107], v[124:127], a[104:107], v[104:107]
    v_cmp_eq_u32 vcc, 0, v191
    s_nop 1
    v_cndmask_b32 v180, v181, v180, vcc
    v_mov_b32 v181, s28
    v_mfma_f32_16x16x32_bf16 v[108:111], v[124:127], a[108:111], v[108:111]
    buffer_store_dword v181, v180, s[16:19], 0 offen sc1
    ds_read_b64 v[14:15], v167 offset:16
    v_mfma_f32_16x16x32_bf16 v[112:115], v[128:131], a[96:99], v[112:115]
    ds_read_b64 v[24:25], v167 offset:176
    ds_read_b64 v[34:35], v167 offset:336
    v_mfma_f32_16x16x32_bf16 v[116:119], v[128:131], a[100:103], v[116:119]
    buffer_load_dwordx4 a[24:27], v157, s[16:19], s24 offen offset:1024 sc1
    buffer_load_dwordx4 a[28:31], v157, s[16:19], s24 offen offset:2048 sc1
    s_waitcnt lgkmcnt(15)
    v_mfma_f32_16x16x32_bf16 v[80:83], v[144:147], a[112:115], v[80:83]
    ds_read_b64_tr_b16 v[120:121], v160 offset:10240
    v_mfma_f32_16x16x32_bf16 v[84:87], v[144:147], a[116:119], v[84:87]
    ds_read_b64_tr_b16 v[122:123], v160 offset:11520
    v_mfma_f32_16x16x32_bf16 v[88:91], v[144:147], a[120:123], v[88:91]
    ds_read_b64_tr_b16 v[124:125], v161 offset:10240
    v_mfma_f32_16x16x32_bf16 v[92:95], v[144:147], a[124:127], v[92:95]
    ds_read_b64_tr_b16 v[126:127], v161 offset:11520
    s_waitcnt lgkmcnt(15)
    v_mfma_f32_16x16x32_bf16 v[96:99], v[148:151], a[112:115], v[96:99]
    ds_read_b64_tr_b16 v[128:129], v165 offset:10240
    v_mfma_f32_16x16x32_bf16 v[100:103], v[148:151], a[116:119], v[100:103]
    ds_read_b64_tr_b16 v[130:131], v165 offset:11520
    v_mfma_f32_16x16x32_bf16 v[104:107], v[148:151], a[120:123], v[104:107]
    ds_read_b64 v[16:17], v167 offset:24
    v_mfma_f32_16x16x32_bf16 v[108:111], v[148:151], a[124:127], v[108:111]
    ds_read_b64 v[26:27], v167 offset:184
    v_mfma_f32_16x16x32_bf16 v[112:115], v[152:155], a[112:115], v[112:115]
    buffer_load_dwordx4 a[32:35], v157, s[16:19], s24 offen offset:3072 sc1
    v_mfma_f32_16x16x32_bf16 v[116:119], v[152:155], a[116:119], v[116:119]
    buffer_load_dwordx4 a[36:39], v157, s[16:19], s25 offen offset:0 sc1
    s_waitcnt lgkmcnt(15)
    v_mfma_f32_16x16x32_bf16 v[80:83], v[132:135], a[128:131], v[80:83]
    ds_read_b64_tr_b16 v[144:145], v162 offset:0
    v_mfma_f32_16x16x32_bf16 v[84:87], v[132:135], a[132:135], v[84:87]
    ds_read_b64_tr_b16 v[146:147], v162 offset:1280
    v_mfma_f32_16x16x32_bf16 v[88:91], v[132:135], a[136:139], v[88:91]
    ds_read_b64_tr_b16 v[148:149], v163 offset:0
    v_mfma_f32_16x16x32_bf16 v[92:95], v[132:135], a[140:143], v[92:95]
    ds_read_b64_tr_b16 v[150:151], v163 offset:1280
    s_waitcnt lgkmcnt(15)
    v_mfma_f32_16x16x32_bf16 v[96:99], v[136:139], a[128:131], v[96:99]
    ds_read_b64_tr_b16 v[152:153], v166 offset:0
    v_mfma_f32_16x16x32_bf16 v[100:103], v[136:139], a[132:135], v[100:103]
    ds_read_b64_tr_b16 v[154:155], v166 offset:1280
    v_mfma_f32_16x16x32_bf16 v[104:107], v[136:139], a[136:139], v[104:107]
    ds_read_b64 v[36:37], v167 offset:344
    v_mfma_f32_16x16x32_bf16 v[108:111], v[136:139], a[140:143], v[108:111]
    ds_read_b64 v[18:19], v167 offset:32
    v_mfma_f32_16x16x32_bf16 v[112:115], v[140:143], a[128:131], v[112:115]
    buffer_load_dwordx4 a[40:43], v158, s[16:19], s24 offen offset:0 sc1
    v_mfma_f32_16x16x32_bf16 v[116:119], v[140:143], a[132:135], v[116:119]
    buffer_load_dwordx4 a[44:47], v158, s[16:19], s24 offen offset:1024 sc1
    s_waitcnt lgkmcnt(14)
    v_mfma_f32_16x16x32_bf16 v[80:83], v[120:123], a[144:147], v[80:83]
    ds_read_b64_tr_b16 v[132:133], v162 offset:10240
    ds_read_b64_tr_b16 v[134:135], v162 offset:11520
    v_mfma_f32_16x16x32_bf16 v[84:87], v[120:123], a[148:151], v[84:87]
    ds_read_b64_tr_b16 v[136:137], v163 offset:10240
    v_mfma_f32_16x16x32_bf16 v[88:91], v[120:123], a[152:155], v[88:91]
    ds_read_b64_tr_b16 v[138:139], v163 offset:11520
    v_mfma_f32_16x16x32_bf16 v[92:95], v[120:123], a[156:159], v[92:95]
    ds_read_b64_tr_b16 v[140:141], v166 offset:10240
    s_waitcnt lgkmcnt(15)
    v_mfma_f32_16x16x32_bf16 v[96:99], v[124:127], a[144:147], v[96:99]
    ds_read_b64_tr_b16 v[142:143], v166 offset:11520
    v_mfma_f32_16x16x32_bf16 v[100:103], v[124:127], a[148:151], v[100:103]
    ds_read_b64 v[28:29], v167 offset:192
    v_mfma_f32_16x16x32_bf16 v[104:107], v[124:127], a[152:155], v[104:107]
    ds_read_b64 v[38:39], v167 offset:352
    v_mfma_f32_16x16x32_bf16 v[108:111], v[124:127], a[156:159], v[108:111]
    ds_read_b64 v[40:41], v168 offset:0
    v_mfma_f32_16x16x32_bf16 v[112:115], v[128:131], a[144:147], v[112:115]
    buffer_load_dwordx4 a[48:51], v158, s[16:19], s24 offen offset:2048 sc1
    v_mfma_f32_16x16x32_bf16 v[116:119], v[128:131], a[148:151], v[116:119]
    buffer_load_dwordx4 a[52:55], v158, s[16:19], s24 offen offset:3072 sc1
    s_barrier
    s_waitcnt lgkmcnt(15)
    v_mfma_f32_16x16x32_bf16 v[80:83], v[144:147], a[160:163], v[80:83]
    v_add_u32 v160, 0x1e000, v160
    v_add_u32 v161, 0x1e000, v161
    v_mfma_f32_16x16x32_bf16 v[84:87], v[144:147], a[164:167], v[84:87]
    v_add_u32 v165, 0x1e000, v165
    v_add_u32 v162, 0x1e000, v162
    v_mfma_f32_16x16x32_bf16 v[88:91], v[144:147], a[168:171], v[88:91]
    v_add_u32 v163, 0x1e000, v163
    v_mfma_f32_16x16x32_bf16 v[92:95], v[144:147], a[172:175], v[92:95]
    v_add_u32 v166, 0x1e000, v166
    ds_read_b64_tr_b16 v[120:121], v160 offset:0
    s_waitcnt lgkmcnt(14)
    v_mfma_f32_16x16x32_bf16 v[96:99], v[148:151], a[160:163], v[96:99]
    ds_read_b64_tr_b16 v[122:123], v160 offset:1280
    v_mfma_f32_16x16x32_bf16 v[100:103], v[148:151], a[164:167], v[100:103]
    ds_read_b64_tr_b16 v[124:125], v161 offset:0
    ds_read_b64_tr_b16 v[126:127], v161 offset:1280
    v_mfma_f32_16x16x32_bf16 v[104:107], v[148:151], a[168:171], v[104:107]
    ds_read_b64_tr_b16 v[128:129], v165 offset:0
    ds_read_b64_tr_b16 v[130:131], v165 offset:1280
    v_mfma_f32_16x16x32_bf16 v[108:111], v[148:151], a[172:175], v[108:111]
    ds_read_b64 v[42:43], v168 offset:784
    s_waitcnt lgkmcnt(15)
    v_mfma_f32_16x16x32_bf16 v[112:115], v[152:155], a[160:163], v[112:115]
    ds_read_b64 v[44:45], v168 offset:1568
    buffer_load_dwordx4 a[56:59], v158, s[16:19], s25 offen offset:0 sc1
    v_mfma_f32_16x16x32_bf16 v[116:119], v[152:155], a[164:167], v[116:119]
    buffer_load_dwordx4 a[60:63], v159, s[16:19], s24 offen offset:0 sc1
    s_waitcnt lgkmcnt(15)
    v_mfma_f32_16x16x32_bf16 v[80:83], v[132:135], a[176:179], v[80:83]
    ds_read_b64_tr_b16 v[144:145], v160 offset:10240
    v_mfma_f32_16x16x32_bf16 v[84:87], v[132:135], a[180:183], v[84:87]
    ds_read_b64_tr_b16 v[146:147], v160 offset:11520
    v_mfma_f32_16x16x32_bf16 v[88:91], v[132:135], a[184:187], v[88:91]
    ds_read_b64_tr_b16 v[148:149], v161 offset:10240
    v_mfma_f32_16x16x32_bf16 v[92:95], v[132:135], a[188:191], v[92:95]
    ds_read_b64_tr_b16 v[150:151], v161 offset:11520
    s_waitcnt lgkmcnt(15)
    v_mfma_f32_16x16x32_bf16 v[96:99], v[136:139], a[176:179], v[96:99]
    ds_read_b64_tr_b16 v[152:153], v165 offset:10240
    v_mfma_f32_16x16x32_bf16 v[100:103], v[136:139], a[180:183], v[100:103]
    ds_read_b64_tr_b16 v[154:155], v165 offset:11520
    v_mfma_f32_16x16x32_bf16 v[104:107], v[136:139], a[184:187], v[104:107]
    ds_read_b64 v[46:47], v168 offset:2352
    v_mfma_f32_16x16x32_bf16 v[108:111], v[136:139], a[188:191], v[108:111]
    ds_read_b64 v[48:49], v168 offset:3136
    v_mfma_f32_16x16x32_bf16 v[112:115], v[140:143], a[176:179], v[112:115]
    buffer_load_dwordx4 a[64:67], v159, s[16:19], s24 offen offset:1024 sc1
    v_mfma_f32_16x16x32_bf16 v[116:119], v[140:143], a[180:183], v[116:119]
    buffer_load_dwordx4 a[68:71], v159, s[16:19], s24 offen offset:2048 sc1
    s_waitcnt lgkmcnt(14)
    v_mfma_f32_16x16x32_bf16 v[80:83], v[120:123], a[192:195], v[80:83]
    ds_read_b64_tr_b16 v[132:133], v162 offset:0
    ds_read_b64_tr_b16 v[134:135], v162 offset:1280
    ds_read_b64_tr_b16 v[136:137], v163 offset:0
    v_mfma_f32_16x16x32_bf16 v[84:87], v[120:123], a[196:199], v[84:87]
    ds_read_b64_tr_b16 v[138:139], v163 offset:1280
    ds_read_b64_tr_b16 v[140:141], v166 offset:0
    v_mfma_f32_16x16x32_bf16 v[88:91], v[120:123], a[200:203], v[88:91]
    ds_read_b64_tr_b16 v[142:143], v166 offset:1280
    v_lshrrev_b32 v185, 4, v190
    v_mfma_f32_16x16x32_bf16 v[92:95], v[120:123], a[204:207], v[92:95]
    v_lshlrev_b32 v185, 7, v185
    v_and_b32 v177, 15, v190
    s_waitcnt lgkmcnt(15)
    v_mfma_f32_16x16x32_bf16 v[96:99], v[124:127], a[192:195], v[96:99]
    v_lshlrev_b32 v177, 3, v177
    v_add_u32 v185, v185, v177
    v_mfma_f32_16x16x32_bf16 v[100:103], v[124:127], a[196:199], v[100:103]
    s_lshl_b32 s36, s31, 7
    s_add_u32 s36, s36, s34
    v_mfma_f32_16x16x32_bf16 v[104:107], v[124:127], a[200:203], v[104:107]
    s_lshl_b32 s36, s36, 2
    s_add_u32 s36, s36, 0x800000
    v_mfma_f32_16x16x32_bf16 v[108:111], v[124:127], a[204:207], v[108:111]
    buffer_load_dword v176, v185, s[16:19], s36 offen sc1
    ds_read_b64 v[50:51], v168 offset:8
    v_mfma_f32_16x16x32_bf16 v[112:115], v[128:131], a[192:195], v[112:115]
    ds_read_b64 v[52:53], v168 offset:792
    ds_read_b64 v[54:55], v168 offset:1576
    v_mfma_f32_16x16x32_bf16 v[116:119], v[128:131], a[196:199], v[116:119]
    buffer_load_dwordx4 a[72:75], v159, s[16:19], s24 offen offset:3072 sc1
    buffer_load_dwordx4 a[76:79], v159, s[16:19], s25 offen offset:0 sc1
    s_waitcnt lgkmcnt(15)
    v_mfma_f32_16x16x32_bf16 v[80:83], v[144:147], a[208:211], v[80:83]
    ds_read_b64_tr_b16 v[120:121], v162 offset:10240
    v_mfma_f32_16x16x32_bf16 v[84:87], v[144:147], a[212:215], v[84:87]
    ds_read_b64_tr_b16 v[122:123], v162 offset:11520
    v_mfma_f32_16x16x32_bf16 v[88:91], v[144:147], a[216:219], v[88:91]
    ds_read_b64_tr_b16 v[124:125], v163 offset:10240
    v_mfma_f32_16x16x32_bf16 v[92:95], v[144:147], a[220:223], v[92:95]
    ds_read_b64_tr_b16 v[126:127], v163 offset:11520
    s_waitcnt lgkmcnt(15)
    v_mfma_f32_16x16x32_bf16 v[96:99], v[148:151], a[208:211], v[96:99]
    ds_read_b64_tr_b16 v[128:129], v166 offset:10240
    v_mfma_f32_16x16x32_bf16 v[100:103], v[148:151], a[212:215], v[100:103]
    ds_read_b64_tr_b16 v[130:131], v166 offset:11520
    v_mfma_f32_16x16x32_bf16 v[104:107], v[148:151], a[216:219], v[104:107]
    ds_read_b64 v[56:57], v168 offset:2360
    v_mfma_f32_16x16x32_bf16 v[108:111], v[148:151], a[220:223], v[108:111]
    ds_read_b64 v[58:59], v168 offset:3144
    v_mfma_f32_16x16x32_bf16 v[112:115], v[152:155], a[208:211], v[112:115]
    buffer_load_dwordx4 a[80:83], v189, s[16:19], s24 offen offset:0 sc1
    v_mfma_f32_16x16x32_bf16 v[116:119], v[152:155], a[212:215], v[116:119]
    buffer_load_dwordx4 a[84:87], v189, s[16:19], s24 offen offset:1024 sc1
    s_waitcnt lgkmcnt(15)
    v_mfma_f32_16x16x32_bf16 v[80:83], v[132:135], a[224:227], v[80:83]
    ds_read_b64_tr_b16 v[144:145], v160 offset:20480
    v_mfma_f32_16x16x32_bf16 v[84:87], v[132:135], a[228:231], v[84:87]
    ds_read_b64_tr_b16 v[146:147], v160 offset:21760
    v_mfma_f32_16x16x32_bf16 v[88:91], v[132:135], a[232:235], v[88:91]
    ds_read_b64_tr_b16 v[148:149], v161 offset:20480
    v_mfma_f32_16x16x32_bf16 v[92:95], v[132:135], a[236:239], v[92:95]
    ds_read_b64_tr_b16 v[150:151], v161 offset:21760
    s_waitcnt lgkmcnt(15)
    v_mfma_f32_16x16x32_bf16 v[96:99], v[136:139], a[224:227], v[96:99]
    ds_read_b64_tr_b16 v[152:153], v165 offset:20480
    v_mfma_f32_16x16x32_bf16 v[100:103], v[136:139], a[228:231], v[100:103]
    ds_read_b64_tr_b16 v[154:155], v165 offset:21760
    v_mfma_f32_16x16x32_bf16 v[104:107], v[136:139], a[232:235], v[104:107]
    ds_read_b64 v[60:61], v168 offset:16
    v_mfma_f32_16x16x32_bf16 v[108:111], v[136:139], a[236:239], v[108:111]
    ds_read_b64 v[62:63], v168 offset:800
    v_mfma_f32_16x16x32_bf16 v[112:115], v[140:143], a[224:227], v[112:115]
    buffer_load_dwordx4 a[88:91], v189, s[16:19], s24 offen offset:2048 sc1
    v_mfma_f32_16x16x32_bf16 v[116:119], v[140:143], a[228:231], v[116:119]
    buffer_load_dwordx4 a[92:95], v189, s[16:19], s24 offen offset:3072 sc1
    s_waitcnt lgkmcnt(14)
    v_mfma_f32_16x16x32_bf16 v[80:83], v[120:123], a[240:243], v[80:83]
    ds_read_b64_tr_b16 v[132:133], v160 offset:30720
    ds_read_b64_tr_b16 v[134:135], v160 offset:32000
    v_mfma_f32_16x16x32_bf16 v[84:87], v[120:123], a[244:247], v[84:87]
    ds_read_b64_tr_b16 v[136:137], v161 offset:30720
    v_mfma_f32_16x16x32_bf16 v[88:91], v[120:123], a[248:251], v[88:91]
    ds_read_b64_tr_b16 v[138:139], v161 offset:32000
    v_mfma_f32_16x16x32_bf16 v[92:95], v[120:123], a[252:255], v[92:95]
    ds_read_b64_tr_b16 v[140:141], v165 offset:30720
    s_waitcnt lgkmcnt(15)
    v_mfma_f32_16x16x32_bf16 v[96:99], v[124:127], a[240:243], v[96:99]
    ds_read_b64_tr_b16 v[142:143], v165 offset:32000
    v_mfma_f32_16x16x32_bf16 v[100:103], v[124:127], a[244:247], v[100:103]
    ds_read_b64 v[64:65], v168 offset:1584
    v_mfma_f32_16x16x32_bf16 v[104:107], v[124:127], a[248:251], v[104:107]
    ds_read_b64 v[66:67], v168 offset:2368
    v_mfma_f32_16x16x32_bf16 v[108:111], v[124:127], a[252:255], v[108:111]
    ds_read_b64 v[68:69], v168 offset:3152
    v_mfma_f32_16x16x32_bf16 v[112:115], v[128:131], a[240:243], v[112:115]
    buffer_load_dwordx4 a[96:99], v189, s[16:19], s25 offen offset:0 sc1
    v_mfma_f32_16x16x32_bf16 v[116:119], v[128:131], a[244:247], v[116:119]
    buffer_load_dwordx4 a[100:103], v156, s[16:19], s26 offen offset:0 sc1
    s_waitcnt lgkmcnt(15)
    v_mfma_f32_16x16x32_bf16 v[80:83], v[144:147], v[192:195], v[80:83]
    ds_read_b64_tr_b16 v[120:121], v162 offset:20480
    ds_read_b64_tr_b16 v[122:123], v162 offset:21760
    v_mfma_f32_16x16x32_bf16 v[84:87], v[144:147], v[196:199], v[84:87]
    ds_read_b64_tr_b16 v[124:125], v163 offset:20480
    v_mfma_f32_16x16x32_bf16 v[88:91], v[144:147], v[200:203], v[88:91]
    ds_read_b64_tr_b16 v[126:127], v163 offset:21760
    v_mfma_f32_16x16x32_bf16 v[92:95], v[144:147], v[204:207], v[92:95]
    ds_read_b64_tr_b16 v[128:129], v166 offset:20480
    s_waitcnt lgkmcnt(15)
    v_mfma_f32_16x16x32_bf16 v[96:99], v[148:151], v[192:195], v[96:99]
    ds_read_b64_tr_b16 v[130:131], v166 offset:21760
    v_mfma_f32_16x16x32_bf16 v[100:103], v[148:151], v[196:199], v[100:103]
    ds_read_b64 a[200:201], v167 offset:5760
    ds_read_b64 a[210:211], v167 offset:5920
    v_mfma_f32_16x16x32_bf16 v[104:107], v[148:151], v[200:203], v[104:107]
    ds_read_b64 a[220:221], v167 offset:6080
    v_mfma_f32_16x16x32_bf16 v[108:111], v[148:151], v[204:207], v[108:111]
    ds_read_b64 a[202:203], v167 offset:5768
    v_mfma_f32_16x16x32_bf16 v[112:115], v[152:155], v[192:195], v[112:115]
    buffer_load_dwordx4 a[104:107], v156, s[16:19], s26 offen offset:1024 sc1
    v_mfma_f32_16x16x32_bf16 v[116:119], v[152:155], v[196:199], v[116:119]
    buffer_load_dwordx4 a[108:111], v156, s[16:19], s26 offen offset:2048 sc1
    s_waitcnt lgkmcnt(15)
    v_mfma_f32_16x16x32_bf16 v[80:83], v[132:135], v[208:211], v[80:83]
    ds_read_b64_tr_b16 v[144:145], v162 offset:30720
    ds_read_b64_tr_b16 v[146:147], v162 offset:32000
    v_mfma_f32_16x16x32_bf16 v[84:87], v[132:135], v[212:215], v[84:87]
    ds_read_b64_tr_b16 v[148:149], v163 offset:30720
    v_mfma_f32_16x16x32_bf16 v[88:91], v[132:135], v[216:219], v[88:91]
    ds_read_b64_tr_b16 v[150:151], v163 offset:32000
    v_mfma_f32_16x16x32_bf16 v[92:95], v[132:135], v[220:223], v[92:95]
    ds_read_b64_tr_b16 v[152:153], v166 offset:30720
    v_mfma_f32_16x16x32_bf16 v[96:99], v[136:139], v[208:211], v[96:99]
    ds_read_b64_tr_b16 v[154:155], v166 offset:32000
    v_mfma_f32_16x16x32_bf16 v[100:103], v[136:139], v[212:215], v[100:103]
    ds_read_b64 a[212:213], v167 offset:5928
    ds_read_b64 a[222:223], v167 offset:6088
    v_mfma_f32_16x16x32_bf16 v[104:107], v[136:139], v[216:219], v[104:107]
    ds_read_b64 a[204:205], v167 offset:5776
    v_mfma_f32_16x16x32_bf16 v[108:111], v[136:139], v[220:223], v[108:111]
    ds_read_b64 a[214:215], v167 offset:5936
    s_waitcnt lgkmcnt(15)
    v_mfma_f32_16x16x32_bf16 v[112:115], v[140:143], v[208:211], v[112:115]
    buffer_load_dwordx4 a[112:115], v156, s[16:19], s26 offen offset:3072 sc1
    v_mfma_f32_16x16x32_bf16 v[116:119], v[140:143], v[212:215], v[116:119]
    buffer_load_dwordx4 a[116:119], v156, s[16:19], s27 offen offset:0 sc1
    v_mfma_f32_16x16x32_bf16 v[80:83], v[120:123], v[224:227], v[80:83]
    ds_read_b64 a[224:225], v167 offset:6096
    v_mfma_f32_16x16x32_bf16 v[84:87], v[120:123], v[228:231], v[84:87]
    ds_read_b64 a[206:207], v167 offset:5784
    v_mfma_f32_16x16x32_bf16 v[88:91], v[120:123], v[232:235], v[88:91]
    v_mfma_f32_16x16x32_bf16 v[92:95], v[120:123], v[236:239], v[92:95]
    ds_read_b64 a[216:217], v167 offset:5944
    v_mfma_f32_16x16x32_bf16 v[96:99], v[124:127], v[224:227], v[96:99]
    v_mfma_f32_16x16x32_bf16 v[100:103], v[124:127], v[228:231], v[100:103]
    ds_read_b64 a[226:227], v167 offset:6104
    v_mfma_f32_16x16x32_bf16 v[104:107], v[124:127], v[232:235], v[104:107]
    buffer_load_dwordx4 a[120:123], v157, s[16:19], s26 offen offset:0 sc1
    v_mfma_f32_16x16x32_bf16 v[108:111], v[124:127], v[236:239], v[108:111]
    s_waitcnt lgkmcnt(15)
    v_mfma_f32_16x16x32_bf16 v[112:115], v[128:131], v[224:227], v[112:115]
    buffer_load_dwordx4 a[124:127], v157, s[16:19], s26 offen offset:1024 sc1
    v_mfma_f32_16x16x32_bf16 v[116:119], v[128:131], v[228:231], v[116:119]
    s_waitcnt lgkmcnt(12)
    v_mfma_f32_16x16x32_bf16 v[80:83], v[144:147], v[240:243], v[80:83]
    ds_read_b64 a[208:209], v167 offset:5792
    v_mfma_f32_16x16x32_bf16 v[84:87], v[144:147], v[244:247], v[84:87]
    ds_read_b64 a[218:219], v167 offset:5952
    v_mfma_f32_16x16x32_bf16 v[88:91], v[144:147], v[248:251], v[88:91]
    v_mfma_f32_16x16x32_bf16 v[92:95], v[144:147], v[252:255], v[92:95]
    ds_read_b64 a[228:229], v167 offset:6112
    s_waitcnt lgkmcnt(13)
    v_mfma_f32_16x16x32_bf16 v[96:99], v[148:151], v[240:243], v[96:99]
    v_mfma_f32_16x16x32_bf16 v[100:103], v[148:151], v[244:247], v[100:103]
    ds_read_b64 a[230:231], v168 offset:7840
    v_mfma_f32_16x16x32_bf16 v[104:107], v[148:151], v[248:251], v[104:107]
    buffer_load_dwordx4 a[128:131], v157, s[16:19], s26 offen offset:2048 sc1
    v_mfma_f32_16x16x32_bf16 v[108:111], v[148:151], v[252:255], v[108:111]
    s_waitcnt lgkmcnt(12)
    v_mfma_f32_16x16x32_bf16 v[112:115], v[152:155], v[240:243], v[112:115]
    buffer_load_dwordx4 a[132:135], v157, s[16:19], s26 offen offset:3072 sc1
    v_mfma_f32_16x16x32_bf16 v[116:119], v[152:155], v[244:247], v[116:119]
    s_lshl_b32 s36, s34, 1
    s_add_u32 s42, s36, s35
    s_xor_b32 s43, s42, 1
    v_and_b32 v180, 15, v190
    v_lshrrev_b32 v181, 4, v190
    s_lshl_b32 s36, s42, 4
    s_lshl_b32 s37, s35, 8
    s_add_u32 s36, s36, s37
    v_add_u32 v182, s36, v180
    v_mul_u32_u24 v182, 40, v182
    v_lshlrev_b32 v185, 3, v181
    v_add_u32 v185, v185, v182
    s_lshl_b32 s36, s43, 4
    s_lshl_b32 s37, s35, 8
    s_add_u32 s36, s36, s37
    v_add_u32 v182, s36, v180
    v_mul_u32_u24 v182, 40, v182
    v_lshlrev_b32 v186, 3, v181
    v_add_u32 v186, v186, v182
    v_cvt_pk_bf16_f32 v80, v80, v81
    v_cvt_pk_bf16_f32 v81, v82, v83
    ds_write_b64 v185, v[80:81] offset:0
    v_cvt_pk_bf16_f32 v84, v84, v85
    v_cvt_pk_bf16_f32 v85, v86, v87
    ds_write_b64 v185, v[84:85] offset:2560
    v_cvt_pk_bf16_f32 v88, v88, v89
    v_cvt_pk_bf16_f32 v89, v90, v91
    ds_write_b64 v186, v[88:89] offset:0
    v_cvt_pk_bf16_f32 v92, v92, v93
    v_cvt_pk_bf16_f32 v93, v94, v95
    ds_write_b64 v186, v[92:93] offset:2560
    v_cvt_pk_bf16_f32 v96, v96, v97
    v_cvt_pk_bf16_f32 v97, v98, v99
    ds_write_b64 v185, v[96:97] offset:5120
    v_cvt_pk_bf16_f32 v100, v100, v101
    v_cvt_pk_bf16_f32 v101, v102, v103
    ds_write_b64 v185, v[100:101] offset:7680
    v_cvt_pk_bf16_f32 v104, v104, v105
    v_cvt_pk_bf16_f32 v105, v106, v107
    ds_write_b64 v186, v[104:105] offset:5120
    v_cvt_pk_bf16_f32 v108, v108, v109
    v_cvt_pk_bf16_f32 v109, v110, v111
    ds_write_b64 v186, v[108:109] offset:7680
    s_lshl_b32 s37, s35, 1
    v_xor_b32 v182, s37, v181
    v_mul_u32_u24 v182, 0x1400, v182
    s_lshl_b32 s36, s42, 4
    v_add_u32 v183, s36, v180
    buffer_load_dwordx4 a[136:139], v157, s[16:19], s27 offen offset:0 sc1
    v_mul_u32_u24 v183, 40, v183
    v_add_u32 v183, v183, v182
    v_add_u32 v183, 32, v183
    v_cvt_pk_bf16_f32 v112, v112, v113
    v_cvt_pk_bf16_f32 v113, v114, v115
    ds_write_b64 v183, v[112:113] offset:0
    v_cvt_pk_bf16_f32 v116, v116, v117
    v_cvt_pk_bf16_f32 v117, v118, v119
    ds_write_b64 v183, v[116:117] offset:2560
    ds_read_b64 a[232:233], v168 offset:8624
    ds_read_b64 a[234:235], v168 offset:9408
    ds_read_b64 a[236:237], v168 offset:10192
    ds_read_b64 a[238:239], v168 offset:10976
    ds_read_b64 a[240:241], v168 offset:7848
    ds_read_b64 a[242:243], v168 offset:8632
    ds_read_b64 a[244:245], v168 offset:9416
    ds_read_b64 a[246:247], v168 offset:10200
    ds_read_b64 a[248:249], v168 offset:10984
    ds_read_b64 a[250:251], v168 offset:7856
    ds_read_b64 a[252:253], v168 offset:8640
    ds_read_b64 a[254:255], v168 offset:9424
    ds_read_b64 v[96:97], v168 offset:10208
    ds_read_b64 v[98:99], v168 offset:10992
    v_mov_b32 v89, v190
    s_add_u32 s36, s46, 0
    s_lshl_b32 s36, s36, 10
    v_lshlrev_b32 v80, 4, v190
    v_add_u32 v80, s36, v80
    s_add_u32 s36, s46, 1
    s_sub_u32 s43, s36, 5
    s_cmp_ge_u32 s36, 5
    s_cselect_b32 s36, s43, s36
    s_lshl_b32 s36, s36, 10
    v_lshlrev_b32 v81, 4, v190
    v_add_u32 v81, s36, v81
    s_add_u32 s36, s46, 2
    s_sub_u32 s43, s36, 5
    s_cmp_ge_u32 s36, 5
    s_cselect_b32 s36, s43, s36
    s_lshl_b32 s36, s36, 10
    v_lshlrev_b32 v82, 4, v190
    v_add_u32 v82, s36, v82
    s_add_u32 s36, s46, 3
    s_sub_u32 s43, s36, 5
    s_cmp_ge_u32 s36, 5
    s_cselect_b32 s36, s43, s36
    s_lshl_b32 s36, s36, 10
    v_lshlrev_b32 v83, 4, v190
    v_add_u32 v83, s36, v83
    s_add_u32 s36, s46, 4
    s_sub_u32 s43, s36, 5
    buffer_load_dwordx4 a[140:143], v158, s[16:19], s26 offen offset:0 sc1
    s_cmp_ge_u32 s36, 5
    s_cselect_b32 s36, s43, s36
    s_lshl_b32 s36, s36, 10
    v_lshlrev_b32 v84, 4, v190
    v_add_u32 v84, s36, v84
    s_xor_b32 s36, s33, s47
    s_xor_b32 s36, s36, 0
    s_lshl_b32 s37, s44, 2
    s_add_u32 s36, s36, s37
    s_lshl_b32 s36, s36, 2
    s_add_u32 s36, s36, s33
    s_mul_i32 s36, s36, 0x1400
    s_add_u32 s4, s36, 0
    s_add_u32 s0, s36, 0x280000
    s_xor_b32 s36, s33, s47
    s_xor_b32 s36, s36, 1
    s_lshl_b32 s37, s44, 2
    s_add_u32 s36, s36, s37
    s_lshl_b32 s36, s36, 2
    s_add_u32 s36, s36, s33
    s_mul_i32 s36, s36, 0x1400
    s_add_u32 s5, s36, 0
    s_add_u32 s1, s36, 0x280000
    s_xor_b32 s36, s33, s47
    s_xor_b32 s36, s36, 2
    s_lshl_b32 s37, s44, 2
    s_add_u32 s36, s36, s37
    s_lshl_b32 s36, s36, 2
    s_add_u32 s36, s36, s33
    s_mul_i32 s36, s36, 0x1400
    s_add_u32 s6, s36, 0
    s_add_u32 s2, s36, 0x280000
    s_xor_b32 s36, s33, s47
    s_xor_b32 s36, s36, 3
    s_lshl_b32 s37, s44, 2
    s_add_u32 s36, s36, s37
    s_lshl_b32 s36, s36, 2
    s_add_u32 s36, s36, s33
    s_mul_i32 s36, s36, 0x1400
    s_add_u32 s7, s36, 0
    s_add_u32 s3, s36, 0x280000
    s_mov_b32 s8, s70
    s_mov_b32 s9, s71
    s_mov_b32 s10, 0x280000
    s_mov_b32 s11, 0x20000
    v_lshrrev_b32 v90, 2, v89
    v_lshlrev_b32 v90, 7, v90
    v_and_b32 v91, 3, v89
    v_lshlrev_b32 v91, 4, v91
    buffer_load_dwordx4 a[144:147], v158, s[16:19], s26 offen offset:1024 sc1
    v_add_u32 v90, v90, v91
    s_mov_b32 s14, 0xb01000
    buffer_load_dwordx4 v[92:95], v90, s[16:19], s14 offen sc1
    s_waitcnt vmcnt(20)
    v_cmp_eq_u32 vcc, -1, v176
    s_nop 4
    s_cbranch_vccz Lgkd_35
    s_mov_b32 s15, 0
Lgk_34:
    v_lshrrev_b32 v185, 4, v190
    v_lshlrev_b32 v185, 7, v185
    v_and_b32 v177, 15, v190
    v_lshlrev_b32 v177, 3, v177
    v_add_u32 v185, v185, v177
    s_lshl_b32 s36, s31, 7
    s_add_u32 s36, s36, s34
    s_lshl_b32 s36, s36, 2
    s_add_u32 s36, s36, 0x800000
    buffer_load_dword v176, v185, s[16:19], s36 offen sc1
    s_waitcnt vmcnt(0)
    v_cmp_eq_u32 vcc, -1, v176
    s_nop 4
    s_cbranch_vccz Lgkd_35
    s_add_u32 s15, s15, 1
    s_cmp_lt_u32 s15, 0x8000
    s_cbranch_scc1 Lgk_34
Lgkd_35:
    v_sub_f32 v176, 1.0, v176
    s_lshl_b32 s36, s35, 2
    s_add_u32 s36, s36, s34
    v_mul_u32_u24 v180, 40, v190
    s_mul_i32 s37, s36, 0xa00
    s_add_u32 s37, s37, 0
    v_add_u32 v180, s37, v180
    s_cmp_eq_u32 s31, 0
    s_cselect_b32 s36, 0xf149f2ca, 0
    v_mov_b32 v183, s36
    v_cmp_gt_u32 vcc, 8, v190
    s_nop 1
    v_cndmask_b32 v192, 0, v183, vcc
    v_cndmask_b32 v193, 0, v183, vcc
    v_cndmask_b32 v194, 0, v183, vcc
    v_cndmask_b32 v195, 0, v183, vcc
    v_cmp_gt_u32 vcc, 4, v190
    s_nop 1
    v_cndmask_b32 v196, 0, v183, vcc
    v_cndmask_b32 v197, 0, v183, vcc
    v_cndmask_b32 v198, 0, v183, vcc
    v_cndmask_b32 v199, 0, v183, vcc
    s_mov_b32 s92, 0x3ea52b5c
    s_mov_b32 s93, 0xbea52b5c
    s_lshl_b32 s36, s31, 3
    s_add_u32 s36, s36, s34
    s_lshl_b32 s36, s36, 2
    s_lshr_b32 s37, s32, 1
    s_add_u32 s36, s36, s37
    s_mul_i32 s36, s36, 0x1400
    s_add_u32 s36, s36, 0x280000
    v_lshrrev_b32 v185, 4, v190
    s_mov_b32 s37, 0xa000
    v_mul_lo_u32 v185, v185, s37
    v_add_u32 v185, s36, v185
    v_and_b32 v186, 15, v190
    v_lshlrev_b32 v186, 4, v186
    v_add_u32 v185, v185, v186
    s_and_b32 s36, s32, 1
    s_lshl_b32 s37, s36, 1
    s_add_u32 s37, s37, s35
    s_lshl_b32 s37, s37, 10
    v_add_u32 v183, s37, v185
    s_lshl_b32 s37, s35, 9
    s_lshl_b32 s36, s36, 8
    s_add_u32 s37, s37, s36
    s_add_u32 s37, s37, 0x1000
    buffer_load_dwordx4 a[148:151], v158, s[16:19], s26 offen offset:2048 sc1
    v_add_u32 v184, s37, v185
    s_waitcnt lgkmcnt(0)
    s_barrier
    ds_read_b64 v[0:1], v180 offset:0
    ds_read_b64 v[70:71], v180 offset:5120
    ds_read_b64 v[2:3], v180 offset:8
    ds_read_b64 v[72:73], v180 offset:5128
    ds_read_b64 v[4:5], v180 offset:16
    ds_read_b64 v[74:75], v180 offset:5136
    ds_read_b64 v[6:7], v180 offset:24
    ds_read_b64 v[76:77], v180 offset:5144
    ds_read_b64 v[8:9], v180 offset:32
    ds_read_b64 v[78:79], v180 offset:5152
    s_waitcnt lgkmcnt(9)
    v_mfma_f32_4x4x4_16b_bf16 v[200:203], v[10:11], v[0:1], v[192:195]
    v_mfma_f32_4x4x4_16b_bf16 v[204:207], v[20:21], v[0:1], v[196:199]
    v_mfma_f32_4x4x4_16b_bf16 v[208:211], v[30:31], v[0:1], 0
    s_waitcnt lgkmcnt(8)
    v_mfma_f32_4x4x4_16b_bf16 v[148:151], a[200:201], v[70:71], v[192:195]
    v_mfma_f32_4x4x4_16b_bf16 v[152:155], a[210:211], v[70:71], v[196:199]
    v_mfma_f32_4x4x4_16b_bf16 v[100:103], a[220:221], v[70:71], 0
    s_waitcnt lgkmcnt(7)
    v_mfma_f32_4x4x4_16b_bf16 v[200:203], v[12:13], v[2:3], v[200:203]
    v_mfma_f32_4x4x4_16b_bf16 v[204:207], v[22:23], v[2:3], v[204:207]
    v_mfma_f32_4x4x4_16b_bf16 v[208:211], v[32:33], v[2:3], v[208:211]
    buffer_load_dwordx4 a[152:155], v158, s[16:19], s26 offen offset:3072 sc1
    s_waitcnt lgkmcnt(6)
    v_mfma_f32_4x4x4_16b_bf16 v[148:151], a[202:203], v[72:73], v[148:151]
    v_mfma_f32_4x4x4_16b_bf16 v[152:155], a[212:213], v[72:73], v[152:155]
    v_mfma_f32_4x4x4_16b_bf16 v[100:103], a[222:223], v[72:73], v[100:103]
    s_waitcnt lgkmcnt(5)
    v_mfma_f32_4x4x4_16b_bf16 v[200:203], v[14:15], v[4:5], v[200:203]
    v_mfma_f32_4x4x4_16b_bf16 v[204:207], v[24:25], v[4:5], v[204:207]
    v_mfma_f32_4x4x4_16b_bf16 v[208:211], v[34:35], v[4:5], v[208:211]
    s_waitcnt lgkmcnt(4)
    v_mfma_f32_4x4x4_16b_bf16 v[148:151], a[204:205], v[74:75], v[148:151]
    v_mfma_f32_4x4x4_16b_bf16 v[152:155], a[214:215], v[74:75], v[152:155]
    v_mfma_f32_4x4x4_16b_bf16 v[100:103], a[224:225], v[74:75], v[100:103]
    s_waitcnt lgkmcnt(3)
    v_mfma_f32_4x4x4_16b_bf16 v[200:203], v[16:17], v[6:7], v[200:203]
    v_mfma_f32_4x4x4_16b_bf16 v[204:207], v[26:27], v[6:7], v[204:207]
    v_mfma_f32_4x4x4_16b_bf16 v[208:211], v[36:37], v[6:7], v[208:211]
    buffer_load_dwordx4 a[156:159], v158, s[16:19], s27 offen offset:0 sc1
    s_waitcnt lgkmcnt(2)
    v_mfma_f32_4x4x4_16b_bf16 v[148:151], a[206:207], v[76:77], v[148:151]
    v_mfma_f32_4x4x4_16b_bf16 v[152:155], a[216:217], v[76:77], v[152:155]
    v_mfma_f32_4x4x4_16b_bf16 v[100:103], a[226:227], v[76:77], v[100:103]
    s_waitcnt lgkmcnt(1)
    v_mfma_f32_4x4x4_16b_bf16 v[200:203], v[18:19], v[8:9], v[200:203]
    v_mfma_f32_4x4x4_16b_bf16 v[204:207], v[28:29], v[8:9], v[204:207]
    v_mfma_f32_4x4x4_16b_bf16 v[208:211], v[38:39], v[8:9], v[208:211]
    s_waitcnt lgkmcnt(0)
    v_mfma_f32_4x4x4_16b_bf16 v[148:151], a[208:209], v[78:79], v[148:151]
    v_mfma_f32_4x4x4_16b_bf16 v[152:155], a[218:219], v[78:79], v[152:155]
    v_mfma_f32_4x4x4_16b_bf16 v[100:103], a[228:229], v[78:79], v[100:103]
    s_nop 0
    v_cndmask_b32 v129, v201, v209, s[82:83]
    v_cndmask_b32 v130, v202, v210, s[84:85]
    v_cndmask_b32 v131, v203, v211, s[86:87]
    v_max3_f32 v144, v208, v129, v130
    v_max3_f32 v144, v144, v131, v204
    v_max3_f32 v144, v144, v205, v206
    v_max_f32 v144, v144, v207
    v_mul_f32 v144, s93, v144
    v_fma_f32 v128, v208, s92, v144
    v_fma_f32 v129, v129, s92, v144
    v_fma_f32 v130, v130, s92, v144
    v_fma_f32 v131, v131, s92, v144
    buffer_load_dwordx4 a[160:163], v159, s[16:19], s26 offen offset:0 sc1
    v_fma_f32 v132, v204, s92, v144
    v_fma_f32 v133, v205, s92, v144
    v_fma_f32 v134, v206, s92, v144
    v_fma_f32 v135, v207, s92, v144
    v_exp_f32 v128, v128
    v_exp_f32 v129, v129
    v_exp_f32 v130, v130
    v_exp_f32 v131, v131
    v_exp_f32 v132, v132
    v_exp_f32 v133, v133
    v_exp_f32 v134, v134
    v_exp_f32 v135, v135
    v_add_f32 v136, v128, v129
    v_add_f32 v137, v130, v131
    v_add_f32 v138, v132, v133
    v_add_f32 v139, v134, v135
    v_add_f32 v136, v136, v137
    v_add_f32 v138, v138, v139
    v_add_f32 v145, v136, v138
    v_rcp_f32 v145, v145
    s_nop 0
    v_mul_f32 v145, v145, v176
    v_mul_f32 v128, v128, v145
    v_mul_f32 v129, v129, v145
    v_mul_f32 v130, v130, v145
    v_mul_f32 v131, v131, v145
    v_mul_f32 v132, v132, v145
    v_mul_f32 v133, v133, v145
    v_mul_f32 v134, v134, v145
    v_mul_f32 v135, v135, v145
    v_cndmask_b32 v137, 0, v129, s[82:83]
    v_cndmask_b32 v141, v129, 0, s[82:83]
    v_cndmask_b32 v138, 0, v130, s[84:85]
    v_cndmask_b32 v142, v130, 0, s[84:85]
    v_cndmask_b32 v139, 0, v131, s[86:87]
    v_cndmask_b32 v143, v131, 0, s[86:87]
    v_cvt_pk_bf16_f32 v124, v128, v137
    v_cvt_pk_bf16_f32 v125, v138, v139
    v_cvt_pk_bf16_f32 v120, 0, v141
    v_cvt_pk_bf16_f32 v121, v142, v143
    v_cvt_pk_bf16_f32 v122, v132, v133
    v_cvt_pk_bf16_f32 v123, v134, v135
    v_cndmask_b32 v11, v149, v101, s[82:83]
    v_cndmask_b32 v12, v150, v102, s[84:85]
    v_cndmask_b32 v13, v151, v103, s[86:87]
    v_mfma_f32_4x4x4_16b_bf16 v[212:215], v[40:41], v[120:121], 0
    buffer_load_dwordx4 a[164:167], v159, s[16:19], s26 offen offset:1024 sc1
    v_max3_f32 v32, v100, v11, v12
    v_max3_f32 v32, v32, v13, v152
    v_max3_f32 v32, v32, v153, v154
    v_mfma_f32_4x4x4_16b_bf16 v[216:219], v[42:43], v[120:121], 0
    v_max_f32 v32, v32, v155
    v_mul_f32 v32, s93, v32
    v_fma_f32 v10, v100, s92, v32
    v_mfma_f32_4x4x4_16b_bf16 v[220:223], v[44:45], v[120:121], 0
    v_fma_f32 v11, v11, s92, v32
    v_fma_f32 v12, v12, s92, v32
    v_fma_f32 v13, v13, s92, v32
    v_fma_f32 v14, v152, s92, v32
    v_mfma_f32_4x4x4_16b_bf16 v[224:227], v[46:47], v[120:121], 0
    v_fma_f32 v15, v153, s92, v32
    v_fma_f32 v16, v154, s92, v32
    v_fma_f32 v17, v155, s92, v32
    v_mfma_f32_4x4x4_16b_bf16 v[228:231], v[48:49], v[120:121], 0
    v_exp_f32 v10, v10
    v_exp_f32 v11, v11
    v_exp_f32 v12, v12
    v_exp_f32 v13, v13
    v_mfma_f32_4x4x4_16b_bf16 v[212:215], v[50:51], v[122:123], v[212:215]
    v_exp_f32 v14, v14
    v_exp_f32 v15, v15
    v_exp_f32 v16, v16
    v_mfma_f32_4x4x4_16b_bf16 v[216:219], v[52:53], v[122:123], v[216:219]
    v_exp_f32 v17, v17
    v_add_f32 v18, v10, v11
    v_add_f32 v19, v12, v13
    v_mfma_f32_4x4x4_16b_bf16 v[220:223], v[54:55], v[122:123], v[220:223]
    buffer_load_dwordx4 a[168:171], v159, s[16:19], s26 offen offset:2048 sc1
    v_add_f32 v20, v14, v15
    v_add_f32 v21, v16, v17
    v_add_f32 v18, v18, v19
    v_add_f32 v20, v20, v21
    v_mfma_f32_4x4x4_16b_bf16 v[224:227], v[56:57], v[122:123], v[224:227]
    v_add_f32 v33, v18, v20
    v_rcp_f32 v33, v33
    s_nop 0
    v_mul_f32 v33, v33, v176
    v_mfma_f32_4x4x4_16b_bf16 v[228:231], v[58:59], v[122:123], v[228:231]
    v_mul_f32 v10, v10, v33
    v_mul_f32 v11, v11, v33
    v_mul_f32 v12, v12, v33
    v_mul_f32 v13, v13, v33
    v_mfma_f32_4x4x4_16b_bf16 v[212:215], v[60:61], v[124:125], v[212:215]
    v_mul_f32 v14, v14, v33
    v_mul_f32 v15, v15, v33
    v_mul_f32 v16, v16, v33
    v_mfma_f32_4x4x4_16b_bf16 v[216:219], v[62:63], v[124:125], v[216:219]
    v_mul_f32 v17, v17, v33
    v_cndmask_b32 v19, 0, v11, s[82:83]
    v_cndmask_b32 v23, v11, 0, s[82:83]
    v_mfma_f32_4x4x4_16b_bf16 v[220:223], v[64:65], v[124:125], v[220:223]
    v_cndmask_b32 v20, 0, v12, s[84:85]
    v_cndmask_b32 v24, v12, 0, s[84:85]
    v_cndmask_b32 v21, 0, v13, s[86:87]
    v_cndmask_b32 v25, v13, 0, s[86:87]
    v_mfma_f32_4x4x4_16b_bf16 v[224:227], v[66:67], v[124:125], v[224:227]
    v_cvt_pk_bf16_f32 v30, v10, v19
    v_cvt_pk_bf16_f32 v31, v20, v21
    v_cvt_pk_bf16_f32 v26, 0, v23
    buffer_load_dwordx4 a[172:175], v159, s[16:19], s26 offen offset:3072 sc1
    v_mfma_f32_4x4x4_16b_bf16 v[228:231], v[68:69], v[124:125], v[228:231]
    v_cvt_pk_bf16_f32 v27, v24, v25
    v_cvt_pk_bf16_f32 v28, v14, v15
    v_cvt_pk_bf16_f32 v29, v16, v17
    v_mfma_f32_4x4x4_16b_bf16 v[232:235], a[230:231], v[26:27], 0
    v_mfma_f32_4x4x4_16b_bf16 v[236:239], a[232:233], v[26:27], 0
    v_mfma_f32_4x4x4_16b_bf16 v[240:243], a[234:235], v[26:27], 0
    v_mfma_f32_4x4x4_16b_bf16 v[244:247], a[236:237], v[26:27], 0
    v_mfma_f32_4x4x4_16b_bf16 v[248:251], a[238:239], v[26:27], 0
    v_mfma_f32_4x4x4_16b_bf16 v[232:235], a[240:241], v[28:29], v[232:235]
    v_mfma_f32_4x4x4_16b_bf16 v[236:239], a[242:243], v[28:29], v[236:239]
    v_mfma_f32_4x4x4_16b_bf16 v[240:243], a[244:245], v[28:29], v[240:243]
    v_mfma_f32_4x4x4_16b_bf16 v[244:247], a[246:247], v[28:29], v[244:247]
    v_mfma_f32_4x4x4_16b_bf16 v[248:251], a[248:249], v[28:29], v[248:251]
    v_mfma_f32_4x4x4_16b_bf16 v[232:235], a[250:251], v[30:31], v[232:235]
    buffer_load_dwordx4 a[176:179], v159, s[16:19], s27 offen offset:0 sc1
    v_mfma_f32_4x4x4_16b_bf16 v[236:239], a[252:253], v[30:31], v[236:239]
    v_mfma_f32_4x4x4_16b_bf16 v[240:243], a[254:255], v[30:31], v[240:243]
    v_mfma_f32_4x4x4_16b_bf16 v[244:247], v[96:97], v[30:31], v[244:247]
    v_mfma_f32_4x4x4_16b_bf16 v[248:251], v[98:99], v[30:31], v[248:251]
    v_cvt_pk_bf16_f32 v0, v212, v213
    v_cvt_pk_bf16_f32 v1, v214, v215
    v_cvt_pk_bf16_f32 v2, v232, v233
    v_cvt_pk_bf16_f32 v3, v234, v235
    buffer_store_dwordx4 v[0:3], v183, s[16:19], 0 offen offset:0 sc1
    v_cvt_pk_bf16_f32 v4, v216, v217
    v_cvt_pk_bf16_f32 v5, v218, v219
    v_cvt_pk_bf16_f32 v6, v236, v237
    v_cvt_pk_bf16_f32 v7, v238, v239
    buffer_store_dwordx4 v[4:7], v183, s[16:19], 0 offen offset:256 sc1
    v_cvt_pk_bf16_f32 v8, v220, v221
    v_cvt_pk_bf16_f32 v9, v222, v223
    v_cvt_pk_bf16_f32 v10, v240, v241
    v_cvt_pk_bf16_f32 v11, v242, v243
    buffer_store_dwordx4 v[8:11], v183, s[16:19], 0 offen offset:512 sc1
    v_cvt_pk_bf16_f32 v12, v224, v225
    v_cvt_pk_bf16_f32 v13, v226, v227
    v_cvt_pk_bf16_f32 v14, v244, v245
    v_cvt_pk_bf16_f32 v15, v246, v247
    buffer_store_dwordx4 v[12:15], v183, s[16:19], 0 offen offset:768 sc1
    v_cvt_pk_bf16_f32 v16, v228, v229
    v_cvt_pk_bf16_f32 v17, v230, v231
    v_cvt_pk_bf16_f32 v18, v248, v249
    v_cvt_pk_bf16_f32 v19, v250, v251
    buffer_store_dwordx4 v[16:19], v184, s[16:19], 0 offen sc1
    s_waitcnt vmcnt(13)
    v_xor_b32 v92, s28, v92
    v_xor_b32 v93, s28, v93
    v_xor_b32 v94, s28, v94
    v_xor_b32 v95, s28, v95
    v_or3_b32 v92, v92, v93, v94
    v_or_b32 v92, v92, v95
    v_cmp_ne_u32 vcc, 0, v92
    buffer_load_dwordx4 a[180:183], v189, s[16:19], s26 offen offset:0 sc1
    s_nop 3
    s_cbranch_vccz Lf2d_37
    s_mov_b32 s15, 0
Lf2_36:
    buffer_load_dwordx4 v[92:95], v90, s[16:19], s14 offen sc1
    s_waitcnt vmcnt(0)
    v_xor_b32 v92, s28, v92
    v_xor_b32 v93, s28, v93
    v_xor_b32 v94, s28, v94
    v_xor_b32 v95, s28, v95
    v_or3_b32 v92, v92, v93, v94
    v_or_b32 v92, v92, v95
    v_cmp_ne_u32 vcc, 0, v92
    s_nop 4
    s_cbranch_vccz Lf2d_37
    s_add_u32 s15, s15, 1
    s_cmp_lt_u32 s15, 0x8000
    s_cbranch_scc1 Lf2_36
Lf2d_37:
    buffer_load_dwordx4 a[184:187], v189, s[16:19], s26 offen offset:1024 sc1
    buffer_load_dwordx4 a[188:191], v189, s[16:19], s26 offen offset:2048 sc1
    buffer_load_dwordx4 a[192:195], v189, s[16:19], s26 offen offset:3072 sc1
    buffer_load_dwordx4 a[196:199], v189, s[16:19], s27 offen offset:0 sc1
    buffer_load_dwordx4 a[204:207], v80, s[16:19], s1 offen sc1
    buffer_load_dwordx4 a[220:223], v81, s[16:19], s1 offen sc1
    buffer_load_dwordx4 a[236:239], v82, s[16:19], s1 offen sc1
    buffer_load_dwordx4 a[252:255], v83, s[16:19], s1 offen sc1
    buffer_load_dwordx4 v[244:247], v84, s[16:19], s1 offen sc1
    buffer_load_dwordx4 a[208:211], v80, s[16:19], s2 offen sc1
    buffer_load_dwordx4 a[224:227], v81, s[16:19], s2 offen sc1
    buffer_load_dwordx4 a[240:243], v82, s[16:19], s2 offen sc1
    buffer_load_dwordx4 v[232:235], v83, s[16:19], s2 offen sc1
    buffer_load_dwordx4 v[248:251], v84, s[16:19], s2 offen sc1
    s_mov_b32 s13, 0
    v_lshlrev_b32 v88, 4, v89
    s_xor_b32 s36, s33, 1
    s_lshr_b32 s37, s36, 1
    s_mul_i32 s37, s37, 0x11800
    s_mul_i32 s36, s36, 0x3c00
    s_add_u32 s36, s36, s37
    s_add_u32 s36, s36, 0x5000
    s_add_u32 s36, s36, 0
    v_add_u32 v91, s36, v88
    s_xor_b32 s36, s33, 2
    s_lshr_b32 s37, s36, 1
    s_mul_i32 s37, s37, 0x11800
    s_mul_i32 s36, s36, 0x3c00
    s_add_u32 s36, s36, s37
    s_add_u32 s36, s36, 0x5000
    s_add_u32 s36, s36, 0x1400
    v_add_u32 v92, s36, v88
    s_xor_b32 s36, s33, 3
    s_lshr_b32 s37, s36, 1
    s_mul_i32 s37, s37, 0x11800
    s_mul_i32 s36, s36, 0x3c00
    s_add_u32 s36, s36, s37
    s_add_u32 s36, s36, 0x5000
    s_add_u32 s36, s36, 0x2800
    v_add_u32 v93, s36, v88
    s_lshr_b32 s37, s33, 1
    s_mul_i32 s37, s37, 0x11800
    s_mul_i32 s36, s33, 0x3c00
    s_add_u32 s36, s36, s37
    s_add_u32 s36, s36, 0x5000
    v_add_u32 v87, s36, v88
    s_xor_b32 s36, s33, s47
    s_lshr_b32 s37, s36, 1
    s_lshl_b32 s37, s37, 5
    s_and_b32 s36, s36, 1
    s_add_u32 s36, s36, s37
    s_lshl_b32 s37, s44, 6
    s_add_u32 s36, s36, s37
    s_mul_i32 s36, s36, 0x500
    s_mul_i32 s37, s45, 0xa0
    s_add_u32 s12, s36, s37
    v_and_b32 v86, 15, v89
    v_mul_u32_u24 v86, 0xa00, v86
    v_lshrrev_b32 v90, 4, v89
    v_mul_u32_u24 v90, 40, v90
    v_add_u32 v90, v90, v86
    s_waitcnt vmcnt(9)
    v_accvgpr_read_b32 v176, a204
    v_accvgpr_read_b32 v177, a206
    s_waitcnt vmcnt(8)
    v_accvgpr_read_b32 v178, a220
    v_accvgpr_read_b32 v179, a222
    s_waitcnt vmcnt(7)
    v_accvgpr_read_b32 v180, a236
    v_accvgpr_read_b32 v181, a238
    s_waitcnt vmcnt(6)
    v_accvgpr_read_b32 v182, a252
    v_accvgpr_read_b32 v183, a254
    v_max3_u32 v85, v176, v177, v178
    v_max3_u32 v85, v85, v179, v180
    v_max3_u32 v85, v85, v181, v182
    s_waitcnt vmcnt(5)
    v_max3_u32 v85, v85, v183, v244
    v_max_u32 v85, v85, v246
    v_cmp_eq_u32 vcc, -1, v85
    s_nop 4
    s_cbranch_vccz Lok_39
Lsp_38:
    buffer_load_dwordx4 a[204:207], v80, s[16:19], s1 offen sc1
    buffer_load_dwordx4 a[220:223], v81, s[16:19], s1 offen sc1
    buffer_load_dwordx4 a[236:239], v82, s[16:19], s1 offen sc1
    buffer_load_dwordx4 a[252:255], v83, s[16:19], s1 offen sc1
    buffer_load_dwordx4 v[244:247], v84, s[16:19], s1 offen sc1
    buffer_load_dwordx4 a[208:211], v80, s[16:19], s2 offen sc1
    buffer_load_dwordx4 a[224:227], v81, s[16:19], s2 offen sc1
    buffer_load_dwordx4 a[240:243], v82, s[16:19], s2 offen sc1
    buffer_load_dwordx4 v[232:235], v83, s[16:19], s2 offen sc1
    buffer_load_dwordx4 v[248:251], v84, s[16:19], s2 offen sc1
    s_waitcnt vmcnt(9)
    v_accvgpr_read_b32 v176, a204
    v_accvgpr_read_b32 v177, a206
    s_waitcnt vmcnt(8)
    v_accvgpr_read_b32 v178, a220
    v_accvgpr_read_b32 v179, a222
    s_waitcnt vmcnt(7)
    v_accvgpr_read_b32 v180, a236
    v_accvgpr_read_b32 v181, a238
    s_waitcnt vmcnt(6)
    v_accvgpr_read_b32 v182, a252
    v_accvgpr_read_b32 v183, a254
    v_max3_u32 v85, v176, v177, v178
    v_max3_u32 v85, v85, v179, v180
    v_max3_u32 v85, v85, v181, v182
    s_waitcnt vmcnt(5)
    v_max3_u32 v85, v85, v183, v244
    v_max_u32 v85, v85, v246
    v_cmp_eq_u32 vcc, -1, v85
    s_nop 4
    s_cbranch_vccz Lok_39
    s_add_u32 s13, s13, 1
    s_cmp_lt_u32 s13, 0x8000
    s_cbranch_scc1 Lsp_38
Lok_39:
    v_mfma_f32_16x16x32_bf16 v[20:23], a[0:3], a[204:207], 0
    v_mfma_f32_16x16x32_bf16 v[24:27], a[4:7], a[204:207], 0
    v_mfma_f32_16x16x32_bf16 v[28:31], a[8:11], a[204:207], 0
    v_mfma_f32_16x16x32_bf16 v[32:35], a[12:15], a[204:207], 0
    v_mfma_f32_16x16x32_bf16 v[36:39], a[16:19], a[204:207], 0
    buffer_load_dwordx4 a[212:215], v80, s[16:19], s3 offen sc1
    v_mfma_f32_16x16x32_bf16 v[20:23], a[20:23], a[220:223], v[20:23]
    v_mfma_f32_16x16x32_bf16 v[24:27], a[24:27], a[220:223], v[24:27]
    buffer_load_dwordx4 a[228:231], v81, s[16:19], s3 offen sc1
    v_mfma_f32_16x16x32_bf16 v[28:31], a[28:31], a[220:223], v[28:31]
    v_mfma_f32_16x16x32_bf16 v[32:35], a[32:35], a[220:223], v[32:35]
    buffer_load_dwordx4 a[244:247], v82, s[16:19], s3 offen sc1
    v_mfma_f32_16x16x32_bf16 v[36:39], a[36:39], a[220:223], v[36:39]
    v_mfma_f32_16x16x32_bf16 v[20:23], a[40:43], a[236:239], v[20:23]
    buffer_load_dwordx4 v[236:239], v83, s[16:19], s3 offen sc1
    v_mfma_f32_16x16x32_bf16 v[24:27], a[44:47], a[236:239], v[24:27]
    v_mfma_f32_16x16x32_bf16 v[28:31], a[48:51], a[236:239], v[28:31]
    buffer_load_dwordx4 v[252:255], v84, s[16:19], s3 offen sc1
    v_mfma_f32_16x16x32_bf16 v[32:35], a[52:55], a[236:239], v[32:35]
    v_mfma_f32_16x16x32_bf16 v[36:39], a[56:59], a[236:239], v[36:39]
    s_waitcnt vmcnt(9)
    v_accvgpr_read_b32 v176, a208
    v_accvgpr_read_b32 v177, a210
    v_mfma_f32_16x16x32_bf16 v[20:23], a[60:63], a[252:255], v[20:23]
    s_waitcnt vmcnt(8)
    v_accvgpr_read_b32 v178, a224
    v_mfma_f32_16x16x32_bf16 v[24:27], a[64:67], a[252:255], v[24:27]
    v_accvgpr_read_b32 v179, a226
    s_waitcnt vmcnt(7)
    v_accvgpr_read_b32 v180, a240
    v_mfma_f32_16x16x32_bf16 v[28:31], a[68:71], a[252:255], v[28:31]
    v_accvgpr_read_b32 v181, a242
    v_mfma_f32_16x16x32_bf16 v[32:35], a[72:75], a[252:255], v[32:35]
    v_max3_u32 v85, v176, v177, v178
    v_max3_u32 v85, v85, v179, v180
    v_mfma_f32_16x16x32_bf16 v[36:39], a[76:79], a[252:255], v[36:39]
    s_waitcnt vmcnt(6)
    v_max3_u32 v85, v85, v181, v232
    v_mfma_f32_16x16x32_bf16 v[20:23], a[80:83], v[244:247], v[20:23]
    s_waitcnt vmcnt(5)
    v_max3_u32 v85, v85, v234, v248
    v_max_u32 v85, v85, v250
    v_mfma_f32_16x16x32_bf16 v[24:27], a[84:87], v[244:247], v[24:27]
    v_cmp_eq_u32 vcc, -1, v85
    v_mfma_f32_16x16x32_bf16 v[28:31], a[88:91], v[244:247], v[28:31]
    v_mfma_f32_16x16x32_bf16 v[32:35], a[92:95], v[244:247], v[32:35]
    v_mfma_f32_16x16x32_bf16 v[36:39], a[96:99], v[244:247], v[36:39]
    s_nop 1
    s_cbranch_vccz Lok_41
Lsp_40:
    buffer_load_dwordx4 a[208:211], v80, s[16:19], s2 offen sc1
    buffer_load_dwordx4 a[224:227], v81, s[16:19], s2 offen sc1
    buffer_load_dwordx4 a[240:243], v82, s[16:19], s2 offen sc1
    buffer_load_dwordx4 v[232:235], v83, s[16:19], s2 offen sc1
    buffer_load_dwordx4 v[248:251], v84, s[16:19], s2 offen sc1
    buffer_load_dwordx4 a[212:215], v80, s[16:19], s3 offen sc1
    buffer_load_dwordx4 a[228:231], v81, s[16:19], s3 offen sc1
    buffer_load_dwordx4 a[244:247], v82, s[16:19], s3 offen sc1
    buffer_load_dwordx4 v[236:239], v83, s[16:19], s3 offen sc1
    buffer_load_dwordx4 v[252:255], v84, s[16:19], s3 offen sc1
    s_waitcnt vmcnt(9)
    v_accvgpr_read_b32 v176, a208
    v_accvgpr_read_b32 v177, a210
    s_waitcnt vmcnt(8)
    v_accvgpr_read_b32 v178, a224
    v_accvgpr_read_b32 v179, a226
    s_waitcnt vmcnt(7)
    v_accvgpr_read_b32 v180, a240
    v_accvgpr_read_b32 v181, a242
    v_max3_u32 v85, v176, v177, v178
    v_max3_u32 v85, v85, v179, v180
    s_waitcnt vmcnt(6)
    v_max3_u32 v85, v85, v181, v232
    s_waitcnt vmcnt(5)
    v_max3_u32 v85, v85, v234, v248
    v_max_u32 v85, v85, v250
    v_cmp_eq_u32 vcc, -1, v85
    s_nop 4
    s_cbranch_vccz Lok_41
    s_add_u32 s13, s13, 1
    s_cmp_lt_u32 s13, 0x8000
    s_cbranch_scc1 Lsp_40
Lok_41:
    v_mfma_f32_16x16x32_bf16 v[40:43], a[0:3], a[208:211], 0
    v_mfma_f32_16x16x32_bf16 v[44:47], a[4:7], a[208:211], 0
    v_mfma_f32_16x16x32_bf16 v[48:51], a[8:11], a[208:211], 0
    v_mfma_f32_16x16x32_bf16 v[52:55], a[12:15], a[208:211], 0
    v_mfma_f32_16x16x32_bf16 v[56:59], a[16:19], a[208:211], 0
    buffer_load_dwordx4 a[200:203], v80, s[16:19], s0 offen sc1
    v_mfma_f32_16x16x32_bf16 v[40:43], a[20:23], a[224:227], v[40:43]
    v_mfma_f32_16x16x32_bf16 v[44:47], a[24:27], a[224:227], v[44:47]
    buffer_load_dwordx4 a[216:219], v81, s[16:19], s0 offen sc1
    v_mfma_f32_16x16x32_bf16 v[48:51], a[28:31], a[224:227], v[48:51]
    v_mfma_f32_16x16x32_bf16 v[52:55], a[32:35], a[224:227], v[52:55]
    buffer_load_dwordx4 a[232:235], v82, s[16:19], s0 offen sc1
    v_mfma_f32_16x16x32_bf16 v[56:59], a[36:39], a[224:227], v[56:59]
    v_mfma_f32_16x16x32_bf16 v[40:43], a[40:43], a[240:243], v[40:43]
    buffer_load_dwordx4 a[248:251], v83, s[16:19], s0 offen sc1
    v_mfma_f32_16x16x32_bf16 v[44:47], a[44:47], a[240:243], v[44:47]
    v_mfma_f32_16x16x32_bf16 v[48:51], a[48:51], a[240:243], v[48:51]
    buffer_load_dwordx4 v[240:243], v84, s[16:19], s0 offen sc1
    v_mfma_f32_16x16x32_bf16 v[52:55], a[52:55], a[240:243], v[52:55]
    v_mfma_f32_16x16x32_bf16 v[56:59], a[56:59], a[240:243], v[56:59]
    s_waitcnt vmcnt(9)
    v_accvgpr_read_b32 v176, a212
    v_accvgpr_read_b32 v177, a214
    v_mfma_f32_16x16x32_bf16 v[40:43], a[60:63], v[232:235], v[40:43]
    s_waitcnt vmcnt(8)
    v_accvgpr_read_b32 v178, a228
    v_mfma_f32_16x16x32_bf16 v[44:47], a[64:67], v[232:235], v[44:47]
    v_accvgpr_read_b32 v179, a230
    s_waitcnt vmcnt(7)
    v_accvgpr_read_b32 v180, a244
    v_mfma_f32_16x16x32_bf16 v[48:51], a[68:71], v[232:235], v[48:51]
    v_accvgpr_read_b32 v181, a246
    v_mfma_f32_16x16x32_bf16 v[52:55], a[72:75], v[232:235], v[52:55]
    v_max3_u32 v85, v176, v177, v178
    v_max3_u32 v85, v85, v179, v180
    v_mfma_f32_16x16x32_bf16 v[56:59], a[76:79], v[232:235], v[56:59]
    s_waitcnt vmcnt(6)
    v_max3_u32 v85, v85, v181, v236
    v_mfma_f32_16x16x32_bf16 v[40:43], a[80:83], v[248:251], v[40:43]
    s_waitcnt vmcnt(5)
    v_max3_u32 v85, v85, v238, v252
    v_max_u32 v85, v85, v254
    v_mfma_f32_16x16x32_bf16 v[44:47], a[84:87], v[248:251], v[44:47]
    v_cmp_eq_u32 vcc, -1, v85
    v_mfma_f32_16x16x32_bf16 v[48:51], a[88:91], v[248:251], v[48:51]
    v_mfma_f32_16x16x32_bf16 v[52:55], a[92:95], v[248:251], v[52:55]
    v_mfma_f32_16x16x32_bf16 v[56:59], a[96:99], v[248:251], v[56:59]
    s_nop 1
    s_cbranch_vccz Lok_43
Lsp_42:
    buffer_load_dwordx4 a[212:215], v80, s[16:19], s3 offen sc1
    buffer_load_dwordx4 a[228:231], v81, s[16:19], s3 offen sc1
    buffer_load_dwordx4 a[244:247], v82, s[16:19], s3 offen sc1
    buffer_load_dwordx4 v[236:239], v83, s[16:19], s3 offen sc1
    buffer_load_dwordx4 v[252:255], v84, s[16:19], s3 offen sc1
    buffer_load_dwordx4 a[200:203], v80, s[16:19], s0 offen sc1
    buffer_load_dwordx4 a[216:219], v81, s[16:19], s0 offen sc1
    buffer_load_dwordx4 a[232:235], v82, s[16:19], s0 offen sc1
    buffer_load_dwordx4 a[248:251], v83, s[16:19], s0 offen sc1
    buffer_load_dwordx4 v[240:243], v84, s[16:19], s0 offen sc1
    s_waitcnt vmcnt(9)
    v_accvgpr_read_b32 v176, a212
    v_accvgpr_read_b32 v177, a214
    s_waitcnt vmcnt(8)
    v_accvgpr_read_b32 v178, a228
    v_accvgpr_read_b32 v179, a230
    s_waitcnt vmcnt(7)
    v_accvgpr_read_b32 v180, a244
    v_accvgpr_read_b32 v181, a246
    v_max3_u32 v85, v176, v177, v178
    v_max3_u32 v85, v85, v179, v180
    s_waitcnt vmcnt(6)
    v_max3_u32 v85, v85, v181, v236
    s_waitcnt vmcnt(5)
    v_max3_u32 v85, v85, v238, v252
    v_max_u32 v85, v85, v254
    v_cmp_eq_u32 vcc, -1, v85
    s_nop 4
    s_cbranch_vccz Lok_43
    s_add_u32 s13, s13, 1
    s_cmp_lt_u32 s13, 0x8000
    s_cbranch_scc1 Lsp_42
Lok_43:
    v_mfma_f32_16x16x32_bf16 v[60:63], a[0:3], a[212:215], 0
    v_mfma_f32_16x16x32_bf16 v[64:67], a[4:7], a[212:215], 0
    v_mfma_f32_16x16x32_bf16 v[68:71], a[8:11], a[212:215], 0
    v_mfma_f32_16x16x32_bf16 v[72:75], a[12:15], a[212:215], 0
    v_mfma_f32_16x16x32_bf16 v[76:79], a[16:19], a[212:215], 0
    buffer_load_dwordx4 v[100:103], v80, s[16:19], s5 offen sc1
    v_mfma_f32_16x16x32_bf16 v[60:63], a[20:23], a[228:231], v[60:63]
    v_mfma_f32_16x16x32_bf16 v[64:67], a[24:27], a[228:231], v[64:67]
    buffer_load_dwordx4 v[116:119], v81, s[16:19], s5 offen sc1
    v_mfma_f32_16x16x32_bf16 v[68:71], a[28:31], a[228:231], v[68:71]
    v_mfma_f32_16x16x32_bf16 v[72:75], a[32:35], a[228:231], v[72:75]
    buffer_load_dwordx4 v[132:135], v82, s[16:19], s5 offen sc1
    v_mfma_f32_16x16x32_bf16 v[76:79], a[36:39], a[228:231], v[76:79]
    v_mfma_f32_16x16x32_bf16 v[60:63], a[40:43], a[244:247], v[60:63]
    buffer_load_dwordx4 v[148:151], v83, s[16:19], s5 offen sc1
    v_mfma_f32_16x16x32_bf16 v[64:67], a[44:47], a[244:247], v[64:67]
    v_mfma_f32_16x16x32_bf16 v[68:71], a[48:51], a[244:247], v[68:71]
    buffer_load_dwordx4 v[164:167], v84, s[16:19], s5 offen sc1
    v_mfma_f32_16x16x32_bf16 v[72:75], a[52:55], a[244:247], v[72:75]
    v_mfma_f32_16x16x32_bf16 v[76:79], a[56:59], a[244:247], v[76:79]
    s_waitcnt vmcnt(9)
    v_accvgpr_read_b32 v176, a200
    v_accvgpr_read_b32 v177, a202
    v_mfma_f32_16x16x32_bf16 v[60:63], a[60:63], v[236:239], v[60:63]
    s_waitcnt vmcnt(8)
    v_accvgpr_read_b32 v178, a216
    v_accvgpr_read_b32 v179, a218
    v_mfma_f32_16x16x32_bf16 v[64:67], a[64:67], v[236:239], v[64:67]
    s_waitcnt vmcnt(7)
    v_accvgpr_read_b32 v180, a232
    v_accvgpr_read_b32 v181, a234
    v_mfma_f32_16x16x32_bf16 v[68:71], a[68:71], v[236:239], v[68:71]
    s_waitcnt vmcnt(6)
    v_accvgpr_read_b32 v182, a248
    v_mfma_f32_16x16x32_bf16 v[72:75], a[72:75], v[236:239], v[72:75]
    v_accvgpr_read_b32 v183, a250
    v_max3_u32 v85, v176, v177, v178
    v_mfma_f32_16x16x32_bf16 v[76:79], a[76:79], v[236:239], v[76:79]
    v_max3_u32 v85, v85, v179, v180
    v_max3_u32 v85, v85, v181, v182
    v_mfma_f32_16x16x32_bf16 v[60:63], a[80:83], v[252:255], v[60:63]
    s_waitcnt vmcnt(5)
    v_max3_u32 v85, v85, v183, v240
    v_max_u32 v85, v85, v242
    v_mfma_f32_16x16x32_bf16 v[64:67], a[84:87], v[252:255], v[64:67]
    v_cmp_eq_u32 vcc, -1, v85
    v_mfma_f32_16x16x32_bf16 v[68:71], a[88:91], v[252:255], v[68:71]
    v_mfma_f32_16x16x32_bf16 v[72:75], a[92:95], v[252:255], v[72:75]
    v_mfma_f32_16x16x32_bf16 v[76:79], a[96:99], v[252:255], v[76:79]
    s_nop 1
    s_cbranch_vccz Lok_45
Lsp_44:
    buffer_load_dwordx4 a[200:203], v80, s[16:19], s0 offen sc1
    buffer_load_dwordx4 a[216:219], v81, s[16:19], s0 offen sc1
    buffer_load_dwordx4 a[232:235], v82, s[16:19], s0 offen sc1
    buffer_load_dwordx4 a[248:251], v83, s[16:19], s0 offen sc1
    buffer_load_dwordx4 v[240:243], v84, s[16:19], s0 offen sc1
    buffer_load_dwordx4 v[100:103], v80, s[16:19], s5 offen sc1
    buffer_load_dwordx4 v[116:119], v81, s[16:19], s5 offen sc1
    buffer_load_dwordx4 v[132:135], v82, s[16:19], s5 offen sc1
    buffer_load_dwordx4 v[148:151], v83, s[16:19], s5 offen sc1
    buffer_load_dwordx4 v[164:167], v84, s[16:19], s5 offen sc1
    s_waitcnt vmcnt(9)
    v_accvgpr_read_b32 v176, a200
    v_accvgpr_read_b32 v177, a202
    s_waitcnt vmcnt(8)
    v_accvgpr_read_b32 v178, a216
    v_accvgpr_read_b32 v179, a218
    s_waitcnt vmcnt(7)
    v_accvgpr_read_b32 v180, a232
    v_accvgpr_read_b32 v181, a234
    s_waitcnt vmcnt(6)
    v_accvgpr_read_b32 v182, a248
    v_accvgpr_read_b32 v183, a250
    v_max3_u32 v85, v176, v177, v178
    v_max3_u32 v85, v85, v179, v180
    v_max3_u32 v85, v85, v181, v182
    s_waitcnt vmcnt(5)
    v_max3_u32 v85, v85, v183, v240
    v_max_u32 v85, v85, v242
    v_cmp_eq_u32 vcc, -1, v85
    s_nop 4
    s_cbranch_vccz Lok_45
    s_add_u32 s13, s13, 1
    s_cmp_lt_u32 s13, 0x8000
    s_cbranch_scc1 Lsp_44
Lok_45:
    v_mfma_f32_16x16x32_bf16 v[0:3], a[0:3], a[200:203], 0
    v_mfma_f32_16x16x32_bf16 v[4:7], a[4:7], a[200:203], 0
    v_mfma_f32_16x16x32_bf16 v[8:11], a[8:11], a[200:203], 0
    v_mfma_f32_16x16x32_bf16 v[12:15], a[12:15], a[200:203], 0
    v_mfma_f32_16x16x32_bf16 v[16:19], a[16:19], a[200:203], 0
    buffer_load_dwordx4 v[104:107], v80, s[16:19], s6 offen sc1
    v_mfma_f32_16x16x32_bf16 v[0:3], a[20:23], a[216:219], v[0:3]
    v_mfma_f32_16x16x32_bf16 v[4:7], a[24:27], a[216:219], v[4:7]
    buffer_load_dwordx4 v[120:123], v81, s[16:19], s6 offen sc1
    v_mfma_f32_16x16x32_bf16 v[8:11], a[28:31], a[216:219], v[8:11]
    v_mfma_f32_16x16x32_bf16 v[12:15], a[32:35], a[216:219], v[12:15]
    buffer_load_dwordx4 v[136:139], v82, s[16:19], s6 offen sc1
    v_mfma_f32_16x16x32_bf16 v[16:19], a[36:39], a[216:219], v[16:19]
    v_mfma_f32_16x16x32_bf16 v[0:3], a[40:43], a[232:235], v[0:3]
    buffer_load_dwordx4 v[152:155], v83, s[16:19], s6 offen sc1
    v_mfma_f32_16x16x32_bf16 v[4:7], a[44:47], a[232:235], v[4:7]
    v_mfma_f32_16x16x32_bf16 v[8:11], a[48:51], a[232:235], v[8:11]
    buffer_load_dwordx4 v[168:171], v84, s[16:19], s6 offen sc1
    v_mfma_f32_16x16x32_bf16 v[12:15], a[52:55], a[232:235], v[12:15]
    v_mfma_f32_16x16x32_bf16 v[16:19], a[56:59], a[232:235], v[16:19]
    s_waitcnt vmcnt(8)
    v_max3_u32 v85, v100, v102, v116
    v_mfma_f32_16x16x32_bf16 v[0:3], a[60:63], a[248:251], v[0:3]
    s_waitcnt vmcnt(7)
    v_max3_u32 v85, v85, v118, v132
    v_mfma_f32_16x16x32_bf16 v[4:7], a[64:67], a[248:251], v[4:7]
    s_waitcnt vmcnt(6)
    v_max3_u32 v85, v85, v134, v148
    v_mfma_f32_16x16x32_bf16 v[8:11], a[68:71], a[248:251], v[8:11]
    v_mfma_f32_16x16x32_bf16 v[12:15], a[72:75], a[248:251], v[12:15]
    s_waitcnt vmcnt(5)
    v_max3_u32 v85, v85, v150, v164
    v_mfma_f32_16x16x32_bf16 v[16:19], a[76:79], a[248:251], v[16:19]
    v_max_u32 v85, v85, v166
    v_mfma_f32_16x16x32_bf16 v[0:3], a[80:83], v[240:243], v[0:3]
    v_cmp_eq_u32 vcc, -1, v85
    v_mfma_f32_16x16x32_bf16 v[4:7], a[84:87], v[240:243], v[4:7]
    v_mfma_f32_16x16x32_bf16 v[8:11], a[88:91], v[240:243], v[8:11]
    v_mfma_f32_16x16x32_bf16 v[12:15], a[92:95], v[240:243], v[12:15]
    v_mfma_f32_16x16x32_bf16 v[16:19], a[96:99], v[240:243], v[16:19]
    s_nop 0
    s_cbranch_vccz Lok_47
Lsp_46:
    buffer_load_dwordx4 v[100:103], v80, s[16:19], s5 offen sc1
    buffer_load_dwordx4 v[116:119], v81, s[16:19], s5 offen sc1
    buffer_load_dwordx4 v[132:135], v82, s[16:19], s5 offen sc1
    buffer_load_dwordx4 v[148:151], v83, s[16:19], s5 offen sc1
    buffer_load_dwordx4 v[164:167], v84, s[16:19], s5 offen sc1
    buffer_load_dwordx4 v[104:107], v80, s[16:19], s6 offen sc1
    buffer_load_dwordx4 v[120:123], v81, s[16:19], s6 offen sc1
    buffer_load_dwordx4 v[136:139], v82, s[16:19], s6 offen sc1
    buffer_load_dwordx4 v[152:155], v83, s[16:19], s6 offen sc1
    buffer_load_dwordx4 v[168:171], v84, s[16:19], s6 offen sc1
    s_waitcnt vmcnt(8)
    v_max3_u32 v85, v100, v102, v116
    s_waitcnt vmcnt(7)
    v_max3_u32 v85, v85, v118, v132
    s_waitcnt vmcnt(6)
    v_max3_u32 v85, v85, v134, v148
    s_waitcnt vmcnt(5)
    v_max3_u32 v85, v85, v150, v164
    v_max_u32 v85, v85, v166
    v_cmp_eq_u32 vcc, -1, v85
    s_nop 4
    s_cbranch_vccz Lok_47
    s_add_u32 s13, s13, 1
    s_cmp_lt_u32 s13, 0x8000
    s_cbranch_scc1 Lsp_46
Lok_47:
    v_mfma_f32_16x16x32_bf16 v[20:23], a[100:103], v[100:103], v[20:23]
    v_mfma_f32_16x16x32_bf16 v[24:27], a[104:107], v[100:103], v[24:27]
    v_mfma_f32_16x16x32_bf16 v[28:31], a[108:111], v[100:103], v[28:31]
    v_mfma_f32_16x16x32_bf16 v[32:35], a[112:115], v[100:103], v[32:35]
    v_mfma_f32_16x16x32_bf16 v[36:39], a[116:119], v[100:103], v[36:39]
    buffer_load_dwordx4 v[108:111], v80, s[16:19], s7 offen sc1
    v_mfma_f32_16x16x32_bf16 v[20:23], a[120:123], v[116:119], v[20:23]
    v_mfma_f32_16x16x32_bf16 v[24:27], a[124:127], v[116:119], v[24:27]
    buffer_load_dwordx4 v[124:127], v81, s[16:19], s7 offen sc1
    v_mfma_f32_16x16x32_bf16 v[28:31], a[128:131], v[116:119], v[28:31]
    v_mfma_f32_16x16x32_bf16 v[32:35], a[132:135], v[116:119], v[32:35]
    buffer_load_dwordx4 v[140:143], v82, s[16:19], s7 offen sc1
    v_mfma_f32_16x16x32_bf16 v[36:39], a[136:139], v[116:119], v[36:39]
    v_mfma_f32_16x16x32_bf16 v[20:23], a[140:143], v[132:135], v[20:23]
    buffer_load_dwordx4 v[156:159], v83, s[16:19], s7 offen sc1
    v_mfma_f32_16x16x32_bf16 v[24:27], a[144:147], v[132:135], v[24:27]
    v_mfma_f32_16x16x32_bf16 v[28:31], a[148:151], v[132:135], v[28:31]
    buffer_load_dwordx4 v[172:175], v84, s[16:19], s7 offen sc1
    v_mfma_f32_16x16x32_bf16 v[32:35], a[152:155], v[132:135], v[32:35]
    v_mfma_f32_16x16x32_bf16 v[36:39], a[156:159], v[132:135], v[36:39]
    s_waitcnt vmcnt(8)
    v_max3_u32 v85, v104, v106, v120
    v_mfma_f32_16x16x32_bf16 v[20:23], a[160:163], v[148:151], v[20:23]
    s_waitcnt vmcnt(7)
    v_max3_u32 v85, v85, v122, v136
    v_mfma_f32_16x16x32_bf16 v[24:27], a[164:167], v[148:151], v[24:27]
    s_waitcnt vmcnt(6)
    v_max3_u32 v85, v85, v138, v152
    v_mfma_f32_16x16x32_bf16 v[28:31], a[168:171], v[148:151], v[28:31]
    v_mfma_f32_16x16x32_bf16 v[32:35], a[172:175], v[148:151], v[32:35]
    s_waitcnt vmcnt(5)
    v_max3_u32 v85, v85, v154, v168
    v_mfma_f32_16x16x32_bf16 v[36:39], a[176:179], v[148:151], v[36:39]
    v_max_u32 v85, v85, v170
    v_mfma_f32_16x16x32_bf16 v[20:23], a[180:183], v[164:167], v[20:23]
    v_cmp_eq_u32 vcc, -1, v85
    v_mfma_f32_16x16x32_bf16 v[24:27], a[184:187], v[164:167], v[24:27]
    v_mfma_f32_16x16x32_bf16 v[28:31], a[188:191], v[164:167], v[28:31]
    v_mfma_f32_16x16x32_bf16 v[32:35], a[192:195], v[164:167], v[32:35]
    v_mfma_f32_16x16x32_bf16 v[36:39], a[196:199], v[164:167], v[36:39]
    s_nop 0
    s_cbranch_vccz Lok_49
Lsp_48:
    buffer_load_dwordx4 v[104:107], v80, s[16:19], s6 offen sc1
    buffer_load_dwordx4 v[120:123], v81, s[16:19], s6 offen sc1
    buffer_load_dwordx4 v[136:139], v82, s[16:19], s6 offen sc1
    buffer_load_dwordx4 v[152:155], v83, s[16:19], s6 offen sc1
    buffer_load_dwordx4 v[168:171], v84, s[16:19], s6 offen sc1
    buffer_load_dwordx4 v[108:111], v80, s[16:19], s7 offen sc1
    buffer_load_dwordx4 v[124:127], v81, s[16:19], s7 offen sc1
    buffer_load_dwordx4 v[140:143], v82, s[16:19], s7 offen sc1
    buffer_load_dwordx4 v[156:159], v83, s[16:19], s7 offen sc1
    buffer_load_dwordx4 v[172:175], v84, s[16:19], s7 offen sc1
    s_waitcnt vmcnt(8)
    v_max3_u32 v85, v104, v106, v120
    s_waitcnt vmcnt(7)
    v_max3_u32 v85, v85, v122, v136
    s_waitcnt vmcnt(6)
    v_max3_u32 v85, v85, v138, v152
    s_waitcnt vmcnt(5)
    v_max3_u32 v85, v85, v154, v168
    v_max_u32 v85, v85, v170
    v_cmp_eq_u32 vcc, -1, v85
    s_nop 4
    s_cbranch_vccz Lok_49
    s_add_u32 s13, s13, 1
    s_cmp_lt_u32 s13, 0x8000
    s_cbranch_scc1 Lsp_48
Lok_49:
    v_mfma_f32_16x16x32_bf16 v[40:43], a[100:103], v[104:107], v[40:43]
    v_mfma_f32_16x16x32_bf16 v[44:47], a[104:107], v[104:107], v[44:47]
    v_mfma_f32_16x16x32_bf16 v[48:51], a[108:111], v[104:107], v[48:51]
    v_mfma_f32_16x16x32_bf16 v[52:55], a[112:115], v[104:107], v[52:55]
    v_mfma_f32_16x16x32_bf16 v[56:59], a[116:119], v[104:107], v[56:59]
    buffer_load_dwordx4 v[96:99], v80, s[16:19], s4 offen sc1
    v_mfma_f32_16x16x32_bf16 v[40:43], a[120:123], v[120:123], v[40:43]
    ds_write_b128 v91, v[20:23] offset:0
    v_mfma_f32_16x16x32_bf16 v[44:47], a[124:127], v[120:123], v[44:47]
    buffer_load_dwordx4 v[112:115], v81, s[16:19], s4 offen sc1
    v_mfma_f32_16x16x32_bf16 v[48:51], a[128:131], v[120:123], v[48:51]
    ds_write_b128 v91, v[24:27] offset:1024
    v_mfma_f32_16x16x32_bf16 v[52:55], a[132:135], v[120:123], v[52:55]
    buffer_load_dwordx4 v[128:131], v82, s[16:19], s4 offen sc1
    v_mfma_f32_16x16x32_bf16 v[56:59], a[136:139], v[120:123], v[56:59]
    ds_write_b128 v91, v[28:31] offset:2048
    v_mfma_f32_16x16x32_bf16 v[40:43], a[140:143], v[136:139], v[40:43]
    buffer_load_dwordx4 v[144:147], v83, s[16:19], s4 offen sc1
    v_mfma_f32_16x16x32_bf16 v[44:47], a[144:147], v[136:139], v[44:47]
    ds_write_b128 v91, v[32:35] offset:3072
    v_mfma_f32_16x16x32_bf16 v[48:51], a[148:151], v[136:139], v[48:51]
    buffer_load_dwordx4 v[160:163], v84, s[16:19], s4 offen sc1
    v_mfma_f32_16x16x32_bf16 v[52:55], a[152:155], v[136:139], v[52:55]
    ds_write_b128 v91, v[36:39] offset:4096
    v_mfma_f32_16x16x32_bf16 v[56:59], a[156:159], v[136:139], v[56:59]
    s_waitcnt vmcnt(8)
    v_max3_u32 v85, v108, v110, v124
    v_mfma_f32_16x16x32_bf16 v[40:43], a[160:163], v[152:155], v[40:43]
    s_waitcnt vmcnt(7)
    v_max3_u32 v85, v85, v126, v140
    v_mfma_f32_16x16x32_bf16 v[44:47], a[164:167], v[152:155], v[44:47]
    s_waitcnt vmcnt(6)
    v_max3_u32 v85, v85, v142, v156
    v_mfma_f32_16x16x32_bf16 v[48:51], a[168:171], v[152:155], v[48:51]
    v_mfma_f32_16x16x32_bf16 v[52:55], a[172:175], v[152:155], v[52:55]
    s_waitcnt vmcnt(5)
    v_max3_u32 v85, v85, v158, v172
    v_mfma_f32_16x16x32_bf16 v[56:59], a[176:179], v[152:155], v[56:59]
    v_max_u32 v85, v85, v174
    v_mfma_f32_16x16x32_bf16 v[40:43], a[180:183], v[168:171], v[40:43]
    v_cmp_eq_u32 vcc, -1, v85
    v_mfma_f32_16x16x32_bf16 v[44:47], a[184:187], v[168:171], v[44:47]
    v_mfma_f32_16x16x32_bf16 v[48:51], a[188:191], v[168:171], v[48:51]
    v_mfma_f32_16x16x32_bf16 v[52:55], a[192:195], v[168:171], v[52:55]
    v_mfma_f32_16x16x32_bf16 v[56:59], a[196:199], v[168:171], v[56:59]
    s_nop 0
    s_cbranch_vccz Lok_51
Lsp_50:
    buffer_load_dwordx4 v[108:111], v80, s[16:19], s7 offen sc1
    buffer_load_dwordx4 v[124:127], v81, s[16:19], s7 offen sc1
    buffer_load_dwordx4 v[140:143], v82, s[16:19], s7 offen sc1
    buffer_load_dwordx4 v[156:159], v83, s[16:19], s7 offen sc1
    buffer_load_dwordx4 v[172:175], v84, s[16:19], s7 offen sc1
    buffer_load_dwordx4 v[96:99], v80, s[16:19], s4 offen sc1
    buffer_load_dwordx4 v[112:115], v81, s[16:19], s4 offen sc1
    buffer_load_dwordx4 v[128:131], v82, s[16:19], s4 offen sc1
    buffer_load_dwordx4 v[144:147], v83, s[16:19], s4 offen sc1
    buffer_load_dwordx4 v[160:163], v84, s[16:19], s4 offen sc1
    s_waitcnt vmcnt(8)
    v_max3_u32 v85, v108, v110, v124
    s_waitcnt vmcnt(7)
    v_max3_u32 v85, v85, v126, v140
    s_waitcnt vmcnt(6)
    v_max3_u32 v85, v85, v142, v156
    s_waitcnt vmcnt(5)
    v_max3_u32 v85, v85, v158, v172
    v_max_u32 v85, v85, v174
    v_cmp_eq_u32 vcc, -1, v85
    s_nop 4
    s_cbranch_vccz Lok_51
    s_add_u32 s13, s13, 1
    s_cmp_lt_u32 s13, 0x8000
    s_cbranch_scc1 Lsp_50
Lok_51:
    v_mfma_f32_16x16x32_bf16 v[60:63], a[100:103], v[108:111], v[60:63]
    v_mfma_f32_16x16x32_bf16 v[64:67], a[104:107], v[108:111], v[64:67]
    v_mfma_f32_16x16x32_bf16 v[68:71], a[108:111], v[108:111], v[68:71]
    v_mfma_f32_16x16x32_bf16 v[72:75], a[112:115], v[108:111], v[72:75]
    v_mfma_f32_16x16x32_bf16 v[76:79], a[116:119], v[108:111], v[76:79]
    ds_write_b128 v92, v[40:43] offset:0
    v_mfma_f32_16x16x32_bf16 v[60:63], a[120:123], v[124:127], v[60:63]
    v_mfma_f32_16x16x32_bf16 v[64:67], a[124:127], v[124:127], v[64:67]
    ds_write_b128 v92, v[44:47] offset:1024
    v_mfma_f32_16x16x32_bf16 v[68:71], a[128:131], v[124:127], v[68:71]
    v_mfma_f32_16x16x32_bf16 v[72:75], a[132:135], v[124:127], v[72:75]
    ds_write_b128 v92, v[48:51] offset:2048
    v_mfma_f32_16x16x32_bf16 v[76:79], a[136:139], v[124:127], v[76:79]
    v_mfma_f32_16x16x32_bf16 v[60:63], a[140:143], v[140:143], v[60:63]
    ds_write_b128 v92, v[52:55] offset:3072
    v_mfma_f32_16x16x32_bf16 v[64:67], a[144:147], v[140:143], v[64:67]
    v_mfma_f32_16x16x32_bf16 v[68:71], a[148:151], v[140:143], v[68:71]
    ds_write_b128 v92, v[56:59] offset:4096
    v_mfma_f32_16x16x32_bf16 v[72:75], a[152:155], v[140:143], v[72:75]
    v_mfma_f32_16x16x32_bf16 v[76:79], a[156:159], v[140:143], v[76:79]
    s_waitcnt vmcnt(3)
    v_max3_u32 v85, v96, v98, v112
    v_mfma_f32_16x16x32_bf16 v[60:63], a[160:163], v[156:159], v[60:63]
    s_waitcnt vmcnt(2)
    v_max3_u32 v85, v85, v114, v128
    v_mfma_f32_16x16x32_bf16 v[64:67], a[164:167], v[156:159], v[64:67]
    s_waitcnt vmcnt(1)
    v_max3_u32 v85, v85, v130, v144
    v_mfma_f32_16x16x32_bf16 v[68:71], a[168:171], v[156:159], v[68:71]
    v_mfma_f32_16x16x32_bf16 v[72:75], a[172:175], v[156:159], v[72:75]
    s_waitcnt vmcnt(0)
    v_max3_u32 v85, v85, v146, v160
    v_mfma_f32_16x16x32_bf16 v[76:79], a[176:179], v[156:159], v[76:79]
    v_max_u32 v85, v85, v162
    v_mfma_f32_16x16x32_bf16 v[60:63], a[180:183], v[172:175], v[60:63]
    v_cmp_eq_u32 vcc, -1, v85
    v_mfma_f32_16x16x32_bf16 v[64:67], a[184:187], v[172:175], v[64:67]
    v_mfma_f32_16x16x32_bf16 v[68:71], a[188:191], v[172:175], v[68:71]
    v_mfma_f32_16x16x32_bf16 v[72:75], a[192:195], v[172:175], v[72:75]
    v_mfma_f32_16x16x32_bf16 v[76:79], a[196:199], v[172:175], v[76:79]
    s_nop 0
    s_cbranch_vccz Lok_53
Lsp_52:
    buffer_load_dwordx4 v[96:99], v80, s[16:19], s4 offen sc1
    buffer_load_dwordx4 v[112:115], v81, s[16:19], s4 offen sc1
    buffer_load_dwordx4 v[128:131], v82, s[16:19], s4 offen sc1
    buffer_load_dwordx4 v[144:147], v83, s[16:19], s4 offen sc1
    buffer_load_dwordx4 v[160:163], v84, s[16:19], s4 offen sc1
    s_waitcnt vmcnt(3)
    v_max3_u32 v85, v96, v98, v112
    s_waitcnt vmcnt(2)
    v_max3_u32 v85, v85, v114, v128
    s_waitcnt vmcnt(1)
    v_max3_u32 v85, v85, v130, v144
    s_waitcnt vmcnt(0)
    v_max3_u32 v85, v85, v146, v160
    v_max_u32 v85, v85, v162
    v_cmp_eq_u32 vcc, -1, v85
    s_nop 4
    s_cbranch_vccz Lok_53
    s_add_u32 s13, s13, 1
    s_cmp_lt_u32 s13, 0x8000
    s_cbranch_scc1 Lsp_52
Lok_53:
    v_mfma_f32_16x16x32_bf16 v[0:3], a[100:103], v[96:99], v[0:3]
    v_mfma_f32_16x16x32_bf16 v[4:7], a[104:107], v[96:99], v[4:7]
    v_mfma_f32_16x16x32_bf16 v[8:11], a[108:111], v[96:99], v[8:11]
    ds_write_b128 v93, v[60:63] offset:0
    v_mfma_f32_16x16x32_bf16 v[12:15], a[112:115], v[96:99], v[12:15]
    ds_write_b128 v93, v[64:67] offset:1024
    v_mfma_f32_16x16x32_bf16 v[16:19], a[116:119], v[96:99], v[16:19]
    ds_write_b128 v93, v[68:71] offset:2048
    v_mfma_f32_16x16x32_bf16 v[0:3], a[120:123], v[112:115], v[0:3]
    ds_write_b128 v93, v[72:75] offset:3072
    v_mfma_f32_16x16x32_bf16 v[4:7], a[124:127], v[112:115], v[4:7]
    ds_write_b128 v93, v[76:79] offset:4096
    v_mfma_f32_16x16x32_bf16 v[8:11], a[128:131], v[112:115], v[8:11]
    s_waitcnt lgkmcnt(0)
    s_barrier
    v_mfma_f32_16x16x32_bf16 v[12:15], a[132:135], v[112:115], v[12:15]
    ds_read_b128 v[20:23], v87 offset:0
    ds_read_b128 v[24:27], v87 offset:1024
    v_mfma_f32_16x16x32_bf16 v[16:19], a[136:139], v[112:115], v[16:19]
    ds_read_b128 v[28:31], v87 offset:2048
    v_mfma_f32_16x16x32_bf16 v[0:3], a[140:143], v[128:131], v[0:3]
    ds_read_b128 v[32:35], v87 offset:3072
    ds_read_b128 v[36:39], v87 offset:4096
    v_mfma_f32_16x16x32_bf16 v[4:7], a[144:147], v[128:131], v[4:7]
    ds_read_b128 v[40:43], v87 offset:5120
    v_mfma_f32_16x16x32_bf16 v[8:11], a[148:151], v[128:131], v[8:11]
    ds_read_b128 v[44:47], v87 offset:6144
    ds_read_b128 v[48:51], v87 offset:7168
    v_mfma_f32_16x16x32_bf16 v[12:15], a[152:155], v[128:131], v[12:15]
    ds_read_b128 v[52:55], v87 offset:8192
    v_mfma_f32_16x16x32_bf16 v[16:19], a[156:159], v[128:131], v[16:19]
    ds_read_b128 v[56:59], v87 offset:9216
    ds_read_b128 v[60:63], v87 offset:10240
    v_mfma_f32_16x16x32_bf16 v[0:3], a[160:163], v[144:147], v[0:3]
    ds_read_b128 v[64:67], v87 offset:11264
    v_mfma_f32_16x16x32_bf16 v[4:7], a[164:167], v[144:147], v[4:7]
    ds_read_b128 v[68:71], v87 offset:12288
    ds_read_b128 v[72:75], v87 offset:13312
    v_mfma_f32_16x16x32_bf16 v[8:11], a[168:171], v[144:147], v[8:11]
    ds_read_b128 v[76:79], v87 offset:14336
    v_mfma_f32_16x16x32_bf16 v[12:15], a[172:175], v[144:147], v[12:15]
    v_mfma_f32_16x16x32_bf16 v[16:19], a[176:179], v[144:147], v[16:19]
    s_waitcnt lgkmcnt(9)
    v_add_f32 v20, v20, v40
    v_add_f32 v21, v21, v41
    v_add_f32 v22, v22, v42
    v_mfma_f32_16x16x32_bf16 v[0:3], a[180:183], v[160:163], v[0:3]
    v_add_f32 v23, v23, v43
    s_waitcnt lgkmcnt(8)
    v_add_f32 v24, v24, v44
    v_mfma_f32_16x16x32_bf16 v[4:7], a[184:187], v[160:163], v[4:7]
    v_add_f32 v25, v25, v45
    v_add_f32 v26, v26, v46
    v_mfma_f32_16x16x32_bf16 v[8:11], a[188:191], v[160:163], v[8:11]
    v_add_f32 v27, v27, v47
    s_waitcnt lgkmcnt(7)
    v_add_f32 v28, v28, v48
    v_add_f32 v29, v29, v49
    v_mfma_f32_16x16x32_bf16 v[12:15], a[192:195], v[160:163], v[12:15]
    v_add_f32 v30, v30, v50
    v_add_f32 v31, v31, v51
    v_mfma_f32_16x16x32_bf16 v[16:19], a[196:199], v[160:163], v[16:19]
    s_waitcnt lgkmcnt(6)
    v_add_f32 v32, v32, v52
    v_add_f32 v33, v33, v53
    v_add_f32 v34, v34, v54
    v_add_f32 v35, v35, v55
    s_waitcnt lgkmcnt(5)
    v_add_f32 v36, v36, v56
    v_add_f32 v37, v37, v57
    v_add_f32 v38, v38, v58
    v_add_f32 v39, v39, v59
    s_waitcnt lgkmcnt(4)
    v_add_f32 v20, v20, v60
    v_add_f32 v21, v21, v61
    v_add_f32 v22, v22, v62
    v_add_f32 v23, v23, v63
    s_waitcnt lgkmcnt(3)
    v_add_f32 v24, v24, v64
    v_add_f32 v25, v25, v65
    v_add_f32 v26, v26, v66
    v_add_f32 v27, v27, v67
    s_waitcnt lgkmcnt(2)
    v_add_f32 v28, v28, v68
    v_add_f32 v29, v29, v69
    v_add_f32 v30, v30, v70
    v_add_f32 v31, v31, v71
    s_waitcnt lgkmcnt(1)
    v_add_f32 v32, v32, v72
    v_add_f32 v33, v33, v73
    v_add_f32 v34, v34, v74
    v_add_f32 v35, v35, v75
    s_waitcnt lgkmcnt(0)
    v_add_f32 v36, v36, v76
    v_add_f32 v37, v37, v77
    v_add_f32 v38, v38, v78
    v_add_f32 v39, v39, v79
    v_add_f32 v0, v0, v20
    v_add_f32 v1, v1, v21
    v_add_f32 v2, v2, v22
    v_add_f32 v3, v3, v23
    v_cvt_pk_bf16_f32 v96, v0, v1
    v_cvt_pk_bf16_f32 v97, v2, v3
    v_add_f32 v4, v4, v24
    v_add_f32 v5, v5, v25
    v_add_f32 v6, v6, v26
    v_add_f32 v7, v7, v27
    v_cvt_pk_bf16_f32 v98, v4, v5
    v_cvt_pk_bf16_f32 v99, v6, v7
    v_add_f32 v8, v8, v28
    v_add_f32 v9, v9, v29
    v_add_f32 v10, v10, v30
    v_add_f32 v11, v11, v31
    v_cvt_pk_bf16_f32 v100, v8, v9
    v_cvt_pk_bf16_f32 v101, v10, v11
    v_add_f32 v12, v12, v32
    v_add_f32 v13, v13, v33
    v_add_f32 v14, v14, v34
    v_add_f32 v15, v15, v35
    v_cvt_pk_bf16_f32 v102, v12, v13
    v_cvt_pk_bf16_f32 v103, v14, v15
    v_add_f32 v16, v16, v36
    v_add_f32 v17, v17, v37
    v_add_f32 v18, v18, v38
    v_add_f32 v19, v19, v39
    v_cvt_pk_bf16_f32 v104, v16, v17
    v_cvt_pk_bf16_f32 v105, v18, v19
    buffer_store_dwordx4 v[96:99], v90, s[8:11], s12 offen
    buffer_store_dwordx4 v[100:103], v90, s[8:11], s12 offen offset:16
    buffer_store_dwordx2 v[104:105], v90, s[8:11], s12 offen offset:32
    s_branch K1_END
K1_END:
    s_endpgm
.section .rodata,"a"
.p2align 6
.amdhsa_kernel gated_mix__linear_attn_block__sliding_local_dilated__prompt_kernel
  .amdhsa_next_free_vgpr 512
  .amdhsa_next_free_sgpr 102
  .amdhsa_accum_offset 256
  .amdhsa_group_segment_fixed_size 0
  .amdhsa_kernarg_size 80
  .amdhsa_user_sgpr_count 2
  .amdhsa_user_sgpr_kernarg_segment_ptr 1
  .amdhsa_system_sgpr_workgroup_id_x 1
.end_amdhsa_kernel
```
